```python
import torch

def _softmax(x, axis=-1):
    return torch.softmax(x, dim=axis)
def _gelu(x):
    return torch.nn.functional.gelu(x, approximate="tanh")
def _silu(x):
    return torch.nn.functional.silu(x)
def _sigmoid(x):
    return torch.sigmoid(x)
def _layernorm(x, axis=-1, eps=1e-5):
    m = x.mean(dim=axis, keepdim=True)
    v = x.var(dim=axis, keepdim=True, unbiased=False)
    return (x - m) / torch.sqrt(v + eps)
def _scatter_add(tgt, idx, src, axis=0):
    return tgt.clone().index_add_(axis, idx, src)
def _segment_sum(src, seg, n):
    out = torch.zeros((n,) + src.shape[1:], dtype=src.dtype)
    return out.index_add_(0, seg, src)
def _pad(x, pw):
    flat = tuple(v for pair in reversed(pw) for v in pair)
    return torch.nn.functional.pad(x, flat)

kernel_name = 'standalone__mha_softmax__near_ridge'

def setup_inputs():

    _w = (lambda a: (lambda t: t.to(torch.bfloat16) if t.is_floating_point() else t)(torch.as_tensor(a)))
    B, H, Sq, Sk, D = 32, 32, 256, 256, 192
    return {
        "q": _w((lambda *s: torch.randn(*s, dtype=torch.bfloat16) * 0.8)(B, H, Sq, D)),
        "k": _w((lambda *s: torch.randn(*s, dtype=torch.bfloat16) * 0.8)(B, H, Sk, D)),
        "v": _w((lambda *s: torch.randn(*s, dtype=torch.bfloat16) * 0.05)(B, H, Sk, D)),
    }

def reference(q, k, v):
    scale = q.shape[-1] ** -0.5
    scores = torch.einsum("bhqd,bhkd->bhqk", q, k) * scale
    p = _softmax(scores, axis=-1)
    return torch.einsum("bhqk,bhkd->bhqd", p, v)
```

```asm
; @launch grid=(256,1,1) block=(512,1,1) lds=163840
.amdgcn_target "amdgcn-amd-amdhsa--gfx950"
.text
.globl standalone__mha_softmax__near_ridge_kernel
.p2align 8
.type standalone__mha_softmax__near_ridge_kernel,@function
standalone__mha_softmax__near_ridge_kernel:
    s_lshr_b32 s3, s2, 5
    s_and_b32 s3, s3, 1
    s_bitcmp1_b32 0x2, s3
    s_cbranch_scc1 LV1_entry
    s_cmp_ge_u32 s2, 256
    s_cbranch_scc1 L_end
    s_load_dwordx8 s[4:11], s[0:1], 0
    v_lshrrev_b32 v128, 6, v0
    v_and_b32 v0, 63, v0
    v_readfirstlane_b32 s38, v128
    v_lshrrev_b32 v129, 3, v0
    v_lshl_add_u32 v130, v128, 5, v129
    v_and_b32 v131, 7, v0
    v_xor_b32 v131, v131, v129
    v_mul_u32_u24 v130, 171, v130
    v_and_b32 v132, 0xff, v130
    v_mul_u32_u24 v132, 0x180, v132
    v_lshl_add_u32 v1, v131, 4, v132
    v_add_u32 v130, 1368, v130
    v_and_b32 v132, 0xff, v130
    v_mul_u32_u24 v132, 0x180, v132
    v_lshl_add_u32 v2, v131, 4, v132
    v_add_u32 v130, 1368, v130
    v_and_b32 v132, 0xff, v130
    v_mul_u32_u24 v132, 0x180, v132
    v_lshl_add_u32 v3, v131, 4, v132
    v_add_u32 v130, 1368, v130
    v_and_b32 v132, 0xff, v130
    v_mul_u32_u24 v132, 0x180, v132
    v_lshl_add_u32 v4, v131, 4, v132
    s_lshl_b32 s35, s38, 12
    s_xor_b32 s39, s2, 0
    s_and_b32 s32, s39, 7
    s_lshr_b32 s39, s39, 3
    s_mul_i32 s32, s32, 3145728
    s_mul_i32 s39, s39, 98304
    s_add_u32 s32, s32, s39
    s_and_b32 s30, s2, 7
    s_lshl_b32 s30, s30, 5
    s_lshr_b32 s31, s2, 3
    s_add_u32 s30, s30, s31
    s_mov_b32 s43, 100663296
    s_mov_b32 s40, s35
    s_add_u32 s41, s35, 163840
    s_waitcnt lgkmcnt(0)
    s_mov_b32 s12, s4
    s_and_b32 s13, s5, 0xffff
    s_mov_b32 s14, 100663296
    s_mov_b32 s15, 0x20000
    s_mov_b32 s16, s6
    s_and_b32 s17, s7, 0xffff
    s_mov_b32 s18, 100663296
    s_mov_b32 s19, 0x20000
    s_mov_b32 s20, s8
    s_and_b32 s21, s9, 0xffff
    s_mov_b32 s22, 100663296
    s_mov_b32 s23, 0x20000
    s_mov_b32 s24, s10
    s_and_b32 s25, s11, 0xffff
    s_mov_b32 s26, 100663296
    s_mov_b32 s27, 0x20000
    s_mov_b32 m0, s40
    s_add_u32 s40, s40, 32768
    s_cmp_eq_u32 s40, s41
    s_cselect_b32 s40, s35, s40
    buffer_load_dwordx4 v1, s[12:15], s32 offen offset:0 nt lds
    s_add_u32 m0, m0, 1024
    s_nop 0
    buffer_load_dwordx4 v2, s[12:15], s32 offen offset:0 nt lds
    s_add_u32 m0, m0, 1024
    s_nop 0
    buffer_load_dwordx4 v3, s[12:15], s32 offen offset:0 nt lds
    s_add_u32 m0, m0, 1024
    s_nop 0
    buffer_load_dwordx4 v4, s[12:15], s32 offen offset:0 nt lds
    s_mov_b32 m0, s40
    s_add_u32 s40, s40, 32768
    s_cmp_eq_u32 s40, s41
    s_cselect_b32 s40, s35, s40
    buffer_load_dwordx4 v1, s[16:19], s32 offen offset:0 nt lds
    s_add_u32 m0, m0, 1024
    s_nop 0
    buffer_load_dwordx4 v2, s[16:19], s32 offen offset:0 nt lds
    s_add_u32 m0, m0, 1024
    s_nop 0
    buffer_load_dwordx4 v3, s[16:19], s32 offen offset:0 nt lds
    s_add_u32 m0, m0, 1024
    s_nop 0
    buffer_load_dwordx4 v4, s[16:19], s32 offen offset:0 nt lds
    s_add_u32 s39, s32, 128
    s_mov_b32 m0, s40
    s_add_u32 s40, s40, 32768
    s_cmp_eq_u32 s40, s41
    s_cselect_b32 s40, s35, s40
    buffer_load_dwordx4 v1, s[12:15], s39 offen offset:0 nt lds
    s_add_u32 m0, m0, 1024
    s_nop 0
    buffer_load_dwordx4 v2, s[12:15], s39 offen offset:0 nt lds
    s_add_u32 m0, m0, 1024
    s_nop 0
    buffer_load_dwordx4 v3, s[12:15], s39 offen offset:0 nt lds
    s_add_u32 m0, m0, 1024
    s_nop 0
    buffer_load_dwordx4 v4, s[12:15], s39 offen offset:0 nt lds
    s_add_u32 s39, s32, 128
    s_mov_b32 m0, s40
    s_add_u32 s40, s40, 32768
    s_cmp_eq_u32 s40, s41
    s_cselect_b32 s40, s35, s40
    buffer_load_dwordx4 v1, s[16:19], s39 offen offset:0 nt lds
    s_add_u32 m0, m0, 1024
    s_nop 0
    buffer_load_dwordx4 v2, s[16:19], s39 offen offset:0 nt lds
    s_add_u32 m0, m0, 1024
    s_nop 0
    buffer_load_dwordx4 v3, s[16:19], s39 offen offset:0 nt lds
    s_add_u32 m0, m0, 1024
    s_nop 0
    buffer_load_dwordx4 v4, s[16:19], s39 offen offset:0 nt lds
    v_and_b32 v129, 15, v0
    v_lshrrev_b32 v130, 4, v0
    v_and_b32 v131, 7, v0
    v_xor_b32 v132, v130, v131
    v_lshlrev_b32 v133, 7, v129
    v_lshl_add_u32 v5, v132, 4, v133
    v_xor_b32 v6, 64, v5
    v_lshrrev_b32 v132, 1, v130
    v_xor_b32 v132, v132, v131
    v_lshl_add_u32 v132, v132, 4, v133
    v_and_b32 v134, 1, v130
    v_lshl_add_u32 v15, v134, 3, v132
    v_lshlrev_b32 v16, 4, v0
    v_lshrrev_b32 v129, 2, v0
    v_and_b32 v131, 7, v129
    v_bfe_u32 v132, v0, 1, 1
    v_xor_b32 v132, v132, v131
    v_lshlrev_b32 v133, 7, v129
    v_lshl_add_u32 v132, v132, 4, v133
    v_and_b32 v134, 1, v0
    v_lshl_add_u32 v7, v134, 3, v132
    v_xor_b32 v8, 32, v7
    v_xor_b32 v9, 64, v7
    v_xor_b32 v10, 96, v7
    v_mov_b32 v26, 0x3f803f80
    v_mov_b32 v27, 0x3f803f80
    v_mov_b32 v28, 0x3f803f80
    v_mov_b32 v29, 0x3f803f80
    s_mov_b32 s37, 0x3dd53b95
    s_mov_b32 s36, 0
    s_mov_b32 s42, 0
    s_mov_b32 s34, 0
    s_add_u32 s28, s42, s35
    s_add_u32 s42, s42, 32768
    s_cmp_eq_u32 s42, 163840
    s_cselect_b32 s42, 0, s42
    v_add_u32 v13, s28, v5
    v_add_u32 v11, s42, v5
    v_add_u32 v14, s28, v6
    v_add_u32 v12, s42, v6
    s_add_u32 s42, s42, 32768
    s_cmp_eq_u32 s42, 163840
    s_cselect_b32 s42, 0, s42
    s_waitcnt vmcnt(8)
    s_barrier
    ds_read_b128 v[96:99], v13 offset:0
    ds_read_b128 v[64:67], v11 offset:0
    ds_read_b128 v[100:103], v13 offset:2048
    ds_read_b128 v[68:71], v11 offset:2048
    ds_read_b128 v[72:75], v11 offset:4096
    ds_read_b128 v[76:79], v11 offset:6144
    ds_read_b128 v[80:83], v11 offset:8192
    ds_read_b128 v[84:87], v11 offset:10240
    ds_read_b128 v[88:91], v11 offset:12288
    ds_read_b128 v[92:95], v11 offset:14336
    ds_read_b128 v[104:107], v14 offset:0
    s_add_u32 s3, s36, 1
    s_mul_i32 s31, s3, 33
    s_xor_b32 s31, s31, s30
    s_lshl_b32 s3, s3, 8
    s_add_u32 s31, s31, s3
    s_mul_i32 s33, s31, 98304
    s_waitcnt lgkmcnt(9)
    v_mfma_f32_16x16x32_bf16 v[128:131], v[64:67], v[96:99], 0
    s_waitcnt lgkmcnt(8)
    v_mfma_f32_16x16x32_bf16 v[136:139], v[64:67], v[100:103], 0
    ds_read_b128 v[112:115], v12 offset:0
    ds_read_b128 v[108:111], v14 offset:2048
    s_add_u32 s39, s32, 256
    s_mov_b32 m0, s40
    s_add_u32 s40, s40, 32768
    s_cmp_eq_u32 s40, s41
    s_cselect_b32 s40, s35, s40
    buffer_load_dwordx4 v1, s[12:15], s39 offen offset:0 nt lds
    s_add_u32 m0, m0, 1024
    s_waitcnt lgkmcnt(9)
    v_mfma_f32_16x16x32_bf16 v[132:135], v[68:71], v[96:99], 0
    v_mfma_f32_16x16x32_bf16 v[140:143], v[68:71], v[100:103], 0
    ds_read_b128 v[116:119], v12 offset:2048
    s_waitcnt lgkmcnt(9)
    v_mfma_f32_16x16x32_bf16 v[144:147], v[72:75], v[96:99], 0
    v_mfma_f32_16x16x32_bf16 v[152:155], v[72:75], v[100:103], 0
    ds_read_b128 v[120:123], v12 offset:4096
    s_waitcnt lgkmcnt(9)
    v_mfma_f32_16x16x32_bf16 v[148:151], v[76:79], v[96:99], 0
    v_mfma_f32_16x16x32_bf16 v[156:159], v[76:79], v[100:103], 0
    ds_read_b128 v[124:127], v12 offset:6144
    s_waitcnt lgkmcnt(9)
    v_mfma_f32_16x16x32_bf16 v[160:163], v[80:83], v[96:99], 0
    v_mfma_f32_16x16x32_bf16 v[168:171], v[80:83], v[100:103], 0
    ds_read_b128 v[64:67], v12 offset:8192
    buffer_load_dwordx4 v2, s[12:15], s39 offen offset:0 nt lds
    s_add_u32 m0, m0, 1024
    s_waitcnt lgkmcnt(9)
    v_mfma_f32_16x16x32_bf16 v[164:167], v[84:87], v[96:99], 0
    v_mfma_f32_16x16x32_bf16 v[172:175], v[84:87], v[100:103], 0
    ds_read_b128 v[68:71], v12 offset:10240
    s_waitcnt lgkmcnt(9)
    v_mfma_f32_16x16x32_bf16 v[176:179], v[88:91], v[96:99], 0
    v_mfma_f32_16x16x32_bf16 v[184:187], v[88:91], v[100:103], 0
    ds_read_b128 v[72:75], v12 offset:12288
    s_waitcnt lgkmcnt(9)
    v_mfma_f32_16x16x32_bf16 v[180:183], v[92:95], v[96:99], 0
    v_mfma_f32_16x16x32_bf16 v[188:191], v[92:95], v[100:103], 0
    ds_read_b128 v[76:79], v12 offset:14336
    s_waitcnt lgkmcnt(8)
    v_mfma_f32_16x16x32_bf16 v[128:131], v[112:115], v[104:107], v[128:131]
    s_waitcnt lgkmcnt(7)
    v_mfma_f32_16x16x32_bf16 v[136:139], v[112:115], v[108:111], v[136:139]
    ds_read_b128 v[80:83], v11 offset:16384
    buffer_load_dwordx4 v3, s[12:15], s39 offen offset:0 nt lds
    s_add_u32 m0, m0, 1024
    s_waitcnt lgkmcnt(7)
    v_mfma_f32_16x16x32_bf16 v[132:135], v[116:119], v[104:107], v[132:135]
    v_mfma_f32_16x16x32_bf16 v[140:143], v[116:119], v[108:111], v[140:143]
    ds_read_b128 v[84:87], v11 offset:18432
    s_waitcnt lgkmcnt(7)
    v_mfma_f32_16x16x32_bf16 v[144:147], v[120:123], v[104:107], v[144:147]
    v_mfma_f32_16x16x32_bf16 v[152:155], v[120:123], v[108:111], v[152:155]
    ds_read_b128 v[88:91], v11 offset:20480
    s_waitcnt lgkmcnt(7)
    v_mfma_f32_16x16x32_bf16 v[148:151], v[124:127], v[104:107], v[148:151]
    v_mfma_f32_16x16x32_bf16 v[156:159], v[124:127], v[108:111], v[156:159]
    ds_read_b128 v[92:95], v11 offset:22528
    s_waitcnt lgkmcnt(7)
    v_mfma_f32_16x16x32_bf16 v[160:163], v[64:67], v[104:107], v[160:163]
    v_mfma_f32_16x16x32_bf16 v[168:171], v[64:67], v[108:111], v[168:171]
    ds_read_b128 v[112:115], v11 offset:24576
    s_waitcnt lgkmcnt(7)
    v_mfma_f32_16x16x32_bf16 v[164:167], v[68:71], v[104:107], v[164:167]
    buffer_load_dwordx4 v4, s[12:15], s39 offen offset:0 nt lds
    v_mfma_f32_16x16x32_bf16 v[172:175], v[68:71], v[108:111], v[172:175]
    ds_read_b128 v[116:119], v11 offset:26624
    s_waitcnt lgkmcnt(7)
    v_mfma_f32_16x16x32_bf16 v[176:179], v[72:75], v[104:107], v[176:179]
    v_mfma_f32_16x16x32_bf16 v[184:187], v[72:75], v[108:111], v[184:187]
    ds_read_b128 v[120:123], v11 offset:28672
    s_waitcnt lgkmcnt(7)
    v_mfma_f32_16x16x32_bf16 v[180:183], v[76:79], v[104:107], v[180:183]
    v_mfma_f32_16x16x32_bf16 v[188:191], v[76:79], v[108:111], v[188:191]
    ds_read_b128 v[124:127], v11 offset:30720
    s_waitcnt lgkmcnt(7)
    v_mfma_f32_16x16x32_bf16 v[192:195], v[80:83], v[96:99], 0
    v_mfma_f32_16x16x32_bf16 v[200:203], v[80:83], v[100:103], 0
    ds_read_b128 v[64:67], v12 offset:16384
    s_waitcnt lgkmcnt(7)
    v_mfma_f32_16x16x32_bf16 v[196:199], v[84:87], v[96:99], 0
    s_add_u32 s39, s32, 256
    s_mov_b32 m0, s40
    s_add_u32 s40, s40, 32768
    s_cmp_eq_u32 s40, s41
    s_cselect_b32 s40, s35, s40
    buffer_load_dwordx4 v1, s[16:19], s39 offen offset:0 nt lds
    s_add_u32 m0, m0, 1024
    v_mfma_f32_16x16x32_bf16 v[204:207], v[84:87], v[100:103], 0
    ds_read_b128 v[68:71], v12 offset:18432
    s_waitcnt lgkmcnt(7)
    v_mfma_f32_16x16x32_bf16 v[208:211], v[88:91], v[96:99], 0
    v_mfma_f32_16x16x32_bf16 v[216:219], v[88:91], v[100:103], 0
    ds_read_b128 v[72:75], v12 offset:20480
    s_waitcnt lgkmcnt(7)
    v_mfma_f32_16x16x32_bf16 v[212:215], v[92:95], v[96:99], 0
    v_mfma_f32_16x16x32_bf16 v[220:223], v[92:95], v[100:103], 0
    ds_read_b128 v[76:79], v12 offset:22528
    s_waitcnt lgkmcnt(7)
    v_mfma_f32_16x16x32_bf16 v[224:227], v[112:115], v[96:99], 0
    v_mfma_f32_16x16x32_bf16 v[232:235], v[112:115], v[100:103], 0
    ds_read_b128 v[80:83], v12 offset:24576
    s_waitcnt lgkmcnt(7)
    v_mfma_f32_16x16x32_bf16 v[228:231], v[116:119], v[96:99], 0
    v_mfma_f32_16x16x32_bf16 v[236:239], v[116:119], v[100:103], 0
    ds_read_b128 v[84:87], v12 offset:26624
    buffer_load_dwordx4 v2, s[16:19], s39 offen offset:0 nt lds
    s_add_u32 m0, m0, 1024
    s_waitcnt lgkmcnt(7)
    v_mfma_f32_16x16x32_bf16 v[240:243], v[120:123], v[96:99], 0
    v_mfma_f32_16x16x32_bf16 v[248:251], v[120:123], v[100:103], 0
    ds_read_b128 v[88:91], v12 offset:28672
    s_waitcnt lgkmcnt(7)
    v_mfma_f32_16x16x32_bf16 v[244:247], v[124:127], v[96:99], 0
    v_mfma_f32_16x16x32_bf16 v[252:255], v[124:127], v[100:103], 0
    ds_read_b128 v[92:95], v12 offset:30720
    s_waitcnt lgkmcnt(7)
    v_mfma_f32_16x16x32_bf16 v[192:195], v[64:67], v[104:107], v[192:195]
    v_mfma_f32_16x16x32_bf16 v[200:203], v[64:67], v[108:111], v[200:203]
    s_waitcnt lgkmcnt(6)
    v_mfma_f32_16x16x32_bf16 v[196:199], v[68:71], v[104:107], v[196:199]
    v_mfma_f32_16x16x32_bf16 v[204:207], v[68:71], v[108:111], v[204:207]
    buffer_load_dwordx4 v3, s[16:19], s39 offen offset:0 nt lds
    s_add_u32 m0, m0, 1024
    s_waitcnt lgkmcnt(5)
    v_mfma_f32_16x16x32_bf16 v[208:211], v[72:75], v[104:107], v[208:211]
    v_mfma_f32_16x16x32_bf16 v[216:219], v[72:75], v[108:111], v[216:219]
    s_waitcnt lgkmcnt(4)
    v_mfma_f32_16x16x32_bf16 v[212:215], v[76:79], v[104:107], v[212:215]
    v_mfma_f32_16x16x32_bf16 v[220:223], v[76:79], v[108:111], v[220:223]
    s_waitcnt lgkmcnt(3)
    v_mfma_f32_16x16x32_bf16 v[224:227], v[80:83], v[104:107], v[224:227]
    v_mfma_f32_16x16x32_bf16 v[232:235], v[80:83], v[108:111], v[232:235]
    s_waitcnt lgkmcnt(2)
    v_mfma_f32_16x16x32_bf16 v[228:231], v[84:87], v[104:107], v[228:231]
    v_mfma_f32_16x16x32_bf16 v[236:239], v[84:87], v[108:111], v[236:239]
    s_waitcnt lgkmcnt(1)
    v_mfma_f32_16x16x32_bf16 v[240:243], v[88:91], v[104:107], v[240:243]
    buffer_load_dwordx4 v4, s[16:19], s39 offen offset:0 nt lds
    v_mfma_f32_16x16x32_bf16 v[248:251], v[88:91], v[108:111], v[248:251]
    s_waitcnt lgkmcnt(0)
    v_mfma_f32_16x16x32_bf16 v[244:247], v[92:95], v[104:107], v[244:247]
    v_mfma_f32_16x16x32_bf16 v[252:255], v[92:95], v[108:111], v[252:255]
    s_add_u32 s28, s42, s35
    s_add_u32 s42, s42, 32768
    s_cmp_eq_u32 s42, 163840
    s_cselect_b32 s42, 0, s42
    v_add_u32 v13, s28, v5
    v_add_u32 v11, s42, v5
    v_add_u32 v14, s28, v6
    v_add_u32 v12, s42, v6
    s_add_u32 s42, s42, 32768
    s_cmp_eq_u32 s42, 163840
    s_cselect_b32 s42, 0, s42
    s_waitcnt vmcnt(8)
    s_barrier
    ds_read_b128 v[96:99], v13 offset:0
    ds_read_b128 v[112:115], v11 offset:0
    ds_read_b128 v[100:103], v13 offset:2048
    ds_read_b128 v[116:119], v11 offset:2048
    ds_read_b128 v[120:123], v11 offset:4096
    ds_read_b128 v[124:127], v11 offset:6144
    ds_read_b128 v[64:67], v11 offset:8192
    ds_read_b128 v[68:71], v11 offset:10240
    ds_read_b128 v[72:75], v11 offset:12288
    ds_read_b128 v[76:79], v11 offset:14336
    ds_read_b128 v[104:107], v14 offset:0
    s_waitcnt lgkmcnt(9)
    v_mfma_f32_16x16x32_bf16 v[128:131], v[112:115], v[96:99], v[128:131]
    s_waitcnt lgkmcnt(8)
    v_mfma_f32_16x16x32_bf16 v[136:139], v[112:115], v[100:103], v[136:139]
    ds_read_b128 v[80:83], v12 offset:0
    ds_read_b128 v[108:111], v14 offset:2048
    s_mov_b32 m0, s40
    s_add_u32 s40, s40, 32768
    s_cmp_eq_u32 s40, s41
    s_cselect_b32 s40, s35, s40
    buffer_load_dwordx4 v1, s[20:23], s32 offen offset:0 nt lds
    s_add_u32 m0, m0, 1024
    s_waitcnt lgkmcnt(9)
    v_mfma_f32_16x16x32_bf16 v[132:135], v[116:119], v[96:99], v[132:135]
    v_mfma_f32_16x16x32_bf16 v[140:143], v[116:119], v[100:103], v[140:143]
    ds_read_b128 v[84:87], v12 offset:2048
    s_waitcnt lgkmcnt(9)
    v_mfma_f32_16x16x32_bf16 v[144:147], v[120:123], v[96:99], v[144:147]
    v_mfma_f32_16x16x32_bf16 v[152:155], v[120:123], v[100:103], v[152:155]
    ds_read_b128 v[88:91], v12 offset:4096
    s_waitcnt lgkmcnt(9)
    v_mfma_f32_16x16x32_bf16 v[148:151], v[124:127], v[96:99], v[148:151]
    v_mfma_f32_16x16x32_bf16 v[156:159], v[124:127], v[100:103], v[156:159]
    ds_read_b128 v[92:95], v12 offset:6144
    s_waitcnt lgkmcnt(9)
    v_mfma_f32_16x16x32_bf16 v[160:163], v[64:67], v[96:99], v[160:163]
    v_mfma_f32_16x16x32_bf16 v[168:171], v[64:67], v[100:103], v[168:171]
    ds_read_b128 v[112:115], v12 offset:8192
    buffer_load_dwordx4 v2, s[20:23], s32 offen offset:0 nt lds
    s_add_u32 m0, m0, 1024
    s_waitcnt lgkmcnt(9)
    v_mfma_f32_16x16x32_bf16 v[164:167], v[68:71], v[96:99], v[164:167]
    v_mfma_f32_16x16x32_bf16 v[172:175], v[68:71], v[100:103], v[172:175]
    ds_read_b128 v[116:119], v12 offset:10240
    s_waitcnt lgkmcnt(9)
    v_mfma_f32_16x16x32_bf16 v[176:179], v[72:75], v[96:99], v[176:179]
    v_mfma_f32_16x16x32_bf16 v[184:187], v[72:75], v[100:103], v[184:187]
    ds_read_b128 v[120:123], v12 offset:12288
    s_waitcnt lgkmcnt(9)
    v_mfma_f32_16x16x32_bf16 v[180:183], v[76:79], v[96:99], v[180:183]
    v_mfma_f32_16x16x32_bf16 v[188:191], v[76:79], v[100:103], v[188:191]
    ds_read_b128 v[124:127], v12 offset:14336
    s_waitcnt lgkmcnt(8)
    v_mfma_f32_16x16x32_bf16 v[128:131], v[80:83], v[104:107], v[128:131]
    s_waitcnt lgkmcnt(7)
    v_mfma_f32_16x16x32_bf16 v[136:139], v[80:83], v[108:111], v[136:139]
    ds_read_b128 v[64:67], v11 offset:16384
    buffer_load_dwordx4 v3, s[20:23], s32 offen offset:0 nt lds
    s_add_u32 m0, m0, 1024
    s_waitcnt lgkmcnt(7)
    v_mfma_f32_16x16x32_bf16 v[132:135], v[84:87], v[104:107], v[132:135]
    v_mfma_f32_16x16x32_bf16 v[140:143], v[84:87], v[108:111], v[140:143]
    ds_read_b128 v[68:71], v11 offset:18432
    s_waitcnt lgkmcnt(7)
    v_mfma_f32_16x16x32_bf16 v[144:147], v[88:91], v[104:107], v[144:147]
    v_mfma_f32_16x16x32_bf16 v[152:155], v[88:91], v[108:111], v[152:155]
    ds_read_b128 v[72:75], v11 offset:20480
    s_waitcnt lgkmcnt(7)
    v_mfma_f32_16x16x32_bf16 v[148:151], v[92:95], v[104:107], v[148:151]
    v_mfma_f32_16x16x32_bf16 v[156:159], v[92:95], v[108:111], v[156:159]
    ds_read_b128 v[76:79], v11 offset:22528
    s_waitcnt lgkmcnt(7)
    v_mfma_f32_16x16x32_bf16 v[160:163], v[112:115], v[104:107], v[160:163]
    v_mfma_f32_16x16x32_bf16 v[168:171], v[112:115], v[108:111], v[168:171]
    ds_read_b128 v[80:83], v11 offset:24576
    s_waitcnt lgkmcnt(7)
    v_mfma_f32_16x16x32_bf16 v[164:167], v[116:119], v[104:107], v[164:167]
    buffer_load_dwordx4 v4, s[20:23], s32 offen offset:0 nt lds
    v_mfma_f32_16x16x32_bf16 v[172:175], v[116:119], v[108:111], v[172:175]
    ds_read_b128 v[84:87], v11 offset:26624
    s_waitcnt lgkmcnt(7)
    v_mfma_f32_16x16x32_bf16 v[176:179], v[120:123], v[104:107], v[176:179]
    v_mfma_f32_16x16x32_bf16 v[184:187], v[120:123], v[108:111], v[184:187]
    ds_read_b128 v[88:91], v11 offset:28672
    s_waitcnt lgkmcnt(7)
    v_mfma_f32_16x16x32_bf16 v[180:183], v[124:127], v[104:107], v[180:183]
    v_mfma_f32_16x16x32_bf16 v[188:191], v[124:127], v[108:111], v[188:191]
    ds_read_b128 v[92:95], v11 offset:30720
    s_waitcnt lgkmcnt(7)
    v_mfma_f32_16x16x32_bf16 v[192:195], v[64:67], v[96:99], v[192:195]
    v_mfma_f32_16x16x32_bf16 v[200:203], v[64:67], v[100:103], v[200:203]
    ds_read_b128 v[112:115], v12 offset:16384
    s_waitcnt lgkmcnt(7)
    v_mfma_f32_16x16x32_bf16 v[196:199], v[68:71], v[96:99], v[196:199]
    s_add_u32 s39, s32, 128
    s_mov_b32 m0, s40
    s_add_u32 s40, s40, 32768
    s_cmp_eq_u32 s40, s41
    s_cselect_b32 s40, s35, s40
    buffer_load_dwordx4 v1, s[20:23], s39 offen offset:0 nt lds
    s_add_u32 m0, m0, 1024
    v_mfma_f32_16x16x32_bf16 v[204:207], v[68:71], v[100:103], v[204:207]
    ds_read_b128 v[116:119], v12 offset:18432
    s_waitcnt lgkmcnt(7)
    v_mfma_f32_16x16x32_bf16 v[208:211], v[72:75], v[96:99], v[208:211]
    v_mfma_f32_16x16x32_bf16 v[216:219], v[72:75], v[100:103], v[216:219]
    ds_read_b128 v[120:123], v12 offset:20480
    s_waitcnt lgkmcnt(7)
    v_mfma_f32_16x16x32_bf16 v[212:215], v[76:79], v[96:99], v[212:215]
    v_mfma_f32_16x16x32_bf16 v[220:223], v[76:79], v[100:103], v[220:223]
    ds_read_b128 v[124:127], v12 offset:22528
    s_waitcnt lgkmcnt(7)
    v_mfma_f32_16x16x32_bf16 v[224:227], v[80:83], v[96:99], v[224:227]
    v_mfma_f32_16x16x32_bf16 v[232:235], v[80:83], v[100:103], v[232:235]
    ds_read_b128 v[64:67], v12 offset:24576
    s_waitcnt lgkmcnt(7)
    v_mfma_f32_16x16x32_bf16 v[228:231], v[84:87], v[96:99], v[228:231]
    v_mfma_f32_16x16x32_bf16 v[236:239], v[84:87], v[100:103], v[236:239]
    ds_read_b128 v[68:71], v12 offset:26624
    buffer_load_dwordx4 v2, s[20:23], s39 offen offset:0 nt lds
    s_add_u32 m0, m0, 1024
    s_waitcnt lgkmcnt(7)
    v_mfma_f32_16x16x32_bf16 v[240:243], v[88:91], v[96:99], v[240:243]
    v_mfma_f32_16x16x32_bf16 v[248:251], v[88:91], v[100:103], v[248:251]
    ds_read_b128 v[72:75], v12 offset:28672
    s_waitcnt lgkmcnt(7)
    v_mfma_f32_16x16x32_bf16 v[244:247], v[92:95], v[96:99], v[244:247]
    v_mfma_f32_16x16x32_bf16 v[252:255], v[92:95], v[100:103], v[252:255]
    ds_read_b128 v[76:79], v12 offset:30720
    s_waitcnt lgkmcnt(7)
    v_mfma_f32_16x16x32_bf16 v[192:195], v[112:115], v[104:107], v[192:195]
    v_mfma_f32_16x16x32_bf16 v[200:203], v[112:115], v[108:111], v[200:203]
    s_waitcnt lgkmcnt(6)
    v_mfma_f32_16x16x32_bf16 v[196:199], v[116:119], v[104:107], v[196:199]
    v_mfma_f32_16x16x32_bf16 v[204:207], v[116:119], v[108:111], v[204:207]
    buffer_load_dwordx4 v3, s[20:23], s39 offen offset:0 nt lds
    s_add_u32 m0, m0, 1024
    s_waitcnt lgkmcnt(5)
    v_mfma_f32_16x16x32_bf16 v[208:211], v[120:123], v[104:107], v[208:211]
    v_mfma_f32_16x16x32_bf16 v[216:219], v[120:123], v[108:111], v[216:219]
    s_waitcnt lgkmcnt(4)
    v_mfma_f32_16x16x32_bf16 v[212:215], v[124:127], v[104:107], v[212:215]
    v_mfma_f32_16x16x32_bf16 v[220:223], v[124:127], v[108:111], v[220:223]
    s_waitcnt lgkmcnt(3)
    v_mfma_f32_16x16x32_bf16 v[224:227], v[64:67], v[104:107], v[224:227]
    v_mfma_f32_16x16x32_bf16 v[232:235], v[64:67], v[108:111], v[232:235]
    s_waitcnt lgkmcnt(2)
    v_mfma_f32_16x16x32_bf16 v[228:231], v[68:71], v[104:107], v[228:231]
    v_mfma_f32_16x16x32_bf16 v[236:239], v[68:71], v[108:111], v[236:239]
    s_waitcnt lgkmcnt(1)
    v_mfma_f32_16x16x32_bf16 v[240:243], v[72:75], v[104:107], v[240:243]
    buffer_load_dwordx4 v4, s[20:23], s39 offen offset:0 nt lds
    v_mfma_f32_16x16x32_bf16 v[248:251], v[72:75], v[108:111], v[248:251]
    s_waitcnt lgkmcnt(0)
    v_mfma_f32_16x16x32_bf16 v[244:247], v[76:79], v[104:107], v[244:247]
    v_mfma_f32_16x16x32_bf16 v[252:255], v[76:79], v[108:111], v[252:255]
    s_add_u32 s28, s42, s35
    s_add_u32 s42, s42, 32768
    s_cmp_eq_u32 s42, 163840
    s_cselect_b32 s42, 0, s42
    v_add_u32 v13, s28, v5
    v_add_u32 v11, s42, v5
    v_add_u32 v14, s28, v6
    v_add_u32 v12, s42, v6
    s_add_u32 s42, s42, 32768
    s_cmp_eq_u32 s42, 163840
    s_cselect_b32 s42, 0, s42
    s_waitcnt vmcnt(8)
    s_barrier
    ds_read_b128 v[96:99], v13 offset:0
    ds_read_b128 v[80:83], v11 offset:0
    ds_read_b128 v[100:103], v13 offset:2048
    ds_read_b128 v[84:87], v11 offset:2048
    ds_read_b128 v[88:91], v11 offset:4096
    ds_read_b128 v[92:95], v11 offset:6144
    ds_read_b128 v[112:115], v11 offset:8192
    ds_read_b128 v[116:119], v11 offset:10240
    ds_read_b128 v[120:123], v11 offset:12288
    ds_read_b128 v[124:127], v11 offset:14336
    ds_read_b128 v[104:107], v14 offset:0
    s_waitcnt lgkmcnt(9)
    v_mfma_f32_16x16x32_bf16 v[128:131], v[80:83], v[96:99], v[128:131]
    s_waitcnt lgkmcnt(8)
    v_mfma_f32_16x16x32_bf16 v[136:139], v[80:83], v[100:103], v[136:139]
    ds_read_b128 v[64:67], v12 offset:0
    ds_read_b128 v[108:111], v14 offset:2048
    s_add_u32 s39, s32, 256
    s_mov_b32 m0, s40
    s_add_u32 s40, s40, 32768
    s_cmp_eq_u32 s40, s41
    s_cselect_b32 s40, s35, s40
    buffer_load_dwordx4 v1, s[20:23], s39 offen offset:0 nt lds
    s_add_u32 m0, m0, 1024
    s_waitcnt lgkmcnt(9)
    v_mfma_f32_16x16x32_bf16 v[132:135], v[84:87], v[96:99], v[132:135]
    v_mfma_f32_16x16x32_bf16 v[140:143], v[84:87], v[100:103], v[140:143]
    ds_read_b128 v[68:71], v12 offset:2048
    s_waitcnt lgkmcnt(9)
    v_mfma_f32_16x16x32_bf16 v[144:147], v[88:91], v[96:99], v[144:147]
    v_mfma_f32_16x16x32_bf16 v[152:155], v[88:91], v[100:103], v[152:155]
    ds_read_b128 v[72:75], v12 offset:4096
    s_waitcnt lgkmcnt(9)
    v_mfma_f32_16x16x32_bf16 v[148:151], v[92:95], v[96:99], v[148:151]
    v_mfma_f32_16x16x32_bf16 v[156:159], v[92:95], v[100:103], v[156:159]
    ds_read_b128 v[76:79], v12 offset:6144
    s_waitcnt lgkmcnt(9)
    v_mfma_f32_16x16x32_bf16 v[160:163], v[112:115], v[96:99], v[160:163]
    v_mfma_f32_16x16x32_bf16 v[168:171], v[112:115], v[100:103], v[168:171]
    ds_read_b128 v[80:83], v12 offset:8192
    s_waitcnt lgkmcnt(9)
    v_mfma_f32_16x16x32_bf16 v[164:167], v[116:119], v[96:99], v[164:167]
    v_mfma_f32_16x16x32_bf16 v[172:175], v[116:119], v[100:103], v[172:175]
    ds_read_b128 v[84:87], v12 offset:10240
    s_waitcnt lgkmcnt(9)
    v_mfma_f32_16x16x32_bf16 v[176:179], v[120:123], v[96:99], v[176:179]
    v_mfma_f32_16x16x32_bf16 v[184:187], v[120:123], v[100:103], v[184:187]
    ds_read_b128 v[88:91], v12 offset:12288
    s_waitcnt lgkmcnt(9)
    v_mfma_f32_16x16x32_bf16 v[180:183], v[124:127], v[96:99], v[180:183]
    v_mfma_f32_16x16x32_bf16 v[188:191], v[124:127], v[100:103], v[188:191]
    ds_read_b128 v[92:95], v12 offset:14336
    s_waitcnt lgkmcnt(8)
    v_mfma_f32_16x16x32_bf16 v[128:131], v[64:67], v[104:107], v[128:131]
    buffer_load_dwordx4 v2, s[20:23], s39 offen offset:0 nt lds
    s_add_u32 m0, m0, 1024
    s_waitcnt lgkmcnt(7)
    v_mfma_f32_16x16x32_bf16 v[136:139], v[64:67], v[108:111], v[136:139]
    ds_read_b128 v[112:115], v11 offset:16384
    s_waitcnt lgkmcnt(7)
    v_mfma_f32_16x16x32_bf16 v[132:135], v[68:71], v[104:107], v[132:135]
    v_mfma_f32_16x16x32_bf16 v[140:143], v[68:71], v[108:111], v[140:143]
    ds_read_b128 v[116:119], v12 offset:16384
    s_waitcnt lgkmcnt(7)
    v_mfma_f32_16x16x32_bf16 v[144:147], v[72:75], v[104:107], v[144:147]
    v_max_f32 v17, v128, v129
    v_mfma_f32_16x16x32_bf16 v[152:155], v[72:75], v[108:111], v[152:155]
    ds_read_b128 v[120:123], v11 offset:18432
    v_max3_f32 v17, v17, v130, v131
    s_waitcnt lgkmcnt(7)
    v_mfma_f32_16x16x32_bf16 v[148:151], v[76:79], v[104:107], v[148:151]
    v_max_f32 v18, v136, v137
    v_mfma_f32_16x16x32_bf16 v[156:159], v[76:79], v[108:111], v[156:159]
    ds_read_b128 v[124:127], v12 offset:18432
    v_max3_f32 v18, v18, v138, v139
    s_waitcnt lgkmcnt(7)
    v_mfma_f32_16x16x32_bf16 v[160:163], v[80:83], v[104:107], v[160:163]
    v_max3_f32 v17, v17, v132, v133
    v_mfma_f32_16x16x32_bf16 v[168:171], v[80:83], v[108:111], v[168:171]
    ds_read_b128 v[64:67], v11 offset:20480
    v_max3_f32 v17, v17, v134, v135
    s_waitcnt lgkmcnt(7)
    v_mfma_f32_16x16x32_bf16 v[164:167], v[84:87], v[104:107], v[164:167]
    v_max3_f32 v18, v18, v140, v141
    v_mfma_f32_16x16x32_bf16 v[172:175], v[84:87], v[108:111], v[172:175]
    ds_read_b128 v[68:71], v12 offset:20480
    v_max3_f32 v18, v18, v142, v143
    s_waitcnt lgkmcnt(7)
    v_mfma_f32_16x16x32_bf16 v[176:179], v[88:91], v[104:107], v[176:179]
    v_max3_f32 v17, v17, v144, v145
    v_mfma_f32_16x16x32_bf16 v[184:187], v[88:91], v[108:111], v[184:187]
    ds_read_b128 v[72:75], v11 offset:22528
    v_max3_f32 v17, v17, v146, v147
    s_waitcnt lgkmcnt(7)
    v_mfma_f32_16x16x32_bf16 v[180:183], v[92:95], v[104:107], v[180:183]
    v_max3_f32 v18, v18, v152, v153
    v_mfma_f32_16x16x32_bf16 v[188:191], v[92:95], v[108:111], v[188:191]
    ds_read_b128 v[76:79], v12 offset:22528
    v_max3_f32 v18, v18, v154, v155
    s_waitcnt lgkmcnt(7)
    v_mfma_f32_16x16x32_bf16 v[192:195], v[112:115], v[96:99], v[192:195]
    v_max3_f32 v17, v17, v148, v149
    buffer_load_dwordx4 v3, s[20:23], s39 offen offset:0 nt lds
    s_add_u32 m0, m0, 1024
    v_mfma_f32_16x16x32_bf16 v[200:203], v[112:115], v[100:103], v[200:203]
    ds_read_b128 v[80:83], v11 offset:24576
    v_max3_f32 v17, v17, v150, v151
    s_waitcnt lgkmcnt(7)
    v_mfma_f32_16x16x32_bf16 v[192:195], v[116:119], v[104:107], v[192:195]
    v_max3_f32 v18, v18, v156, v157
    v_mfma_f32_16x16x32_bf16 v[200:203], v[116:119], v[108:111], v[200:203]
    ds_read_b128 v[84:87], v12 offset:24576
    v_max3_f32 v18, v18, v158, v159
    s_waitcnt lgkmcnt(7)
    v_mfma_f32_16x16x32_bf16 v[196:199], v[120:123], v[96:99], v[196:199]
    v_max3_f32 v17, v17, v160, v161
    v_mfma_f32_16x16x32_bf16 v[204:207], v[120:123], v[100:103], v[204:207]
    ds_read_b128 v[88:91], v11 offset:26624
    v_max3_f32 v17, v17, v162, v163
    s_waitcnt lgkmcnt(7)
    v_mfma_f32_16x16x32_bf16 v[196:199], v[124:127], v[104:107], v[196:199]
    v_max3_f32 v18, v18, v168, v169
    v_mfma_f32_16x16x32_bf16 v[204:207], v[124:127], v[108:111], v[204:207]
    ds_read_b128 v[92:95], v12 offset:26624
    v_max3_f32 v18, v18, v170, v171
    v_max3_f32 v17, v17, v164, v165
    s_waitcnt lgkmcnt(7)
    v_mfma_f32_16x16x32_bf16 v[208:211], v[64:67], v[96:99], v[208:211]
    v_max3_f32 v17, v17, v166, v167
    v_mfma_f32_16x16x32_bf16 v[216:219], v[64:67], v[100:103], v[216:219]
    ds_read_b128 v[112:115], v11 offset:28672
    v_max3_f32 v18, v18, v172, v173
    s_waitcnt lgkmcnt(7)
    v_mfma_f32_16x16x32_bf16 v[208:211], v[68:71], v[104:107], v[208:211]
    v_max3_f32 v18, v18, v174, v175
    v_max3_f32 v17, v17, v176, v177
    v_mfma_f32_16x16x32_bf16 v[216:219], v[68:71], v[108:111], v[216:219]
    ds_read_b128 v[116:119], v12 offset:28672
    v_max3_f32 v17, v17, v178, v179
    v_max3_f32 v18, v18, v184, v185
    s_waitcnt lgkmcnt(7)
    v_mfma_f32_16x16x32_bf16 v[212:215], v[72:75], v[96:99], v[212:215]
    v_max3_f32 v18, v18, v186, v187
    v_mfma_f32_16x16x32_bf16 v[220:223], v[72:75], v[100:103], v[220:223]
    ds_read_b128 v[120:123], v11 offset:30720
    v_max3_f32 v17, v17, v180, v181
    s_waitcnt lgkmcnt(7)
    v_mfma_f32_16x16x32_bf16 v[212:215], v[76:79], v[104:107], v[212:215]
    v_max3_f32 v17, v17, v182, v183
    v_max3_f32 v18, v18, v188, v189
    v_mfma_f32_16x16x32_bf16 v[220:223], v[76:79], v[108:111], v[220:223]
    ds_read_b128 v[124:127], v12 offset:30720
    v_max3_f32 v18, v18, v190, v191
    v_max3_f32 v17, v17, v192, v193
    s_waitcnt lgkmcnt(7)
    v_mfma_f32_16x16x32_bf16 v[224:227], v[80:83], v[96:99], v[224:227]
    v_max3_f32 v17, v17, v194, v195
    v_max3_f32 v18, v18, v200, v201
    buffer_load_dwordx4 v4, s[20:23], s39 offen offset:0 nt lds
    v_mfma_f32_16x16x32_bf16 v[232:235], v[80:83], v[100:103], v[232:235]
    v_max3_f32 v18, v18, v202, v203
    s_waitcnt lgkmcnt(6)
    v_mfma_f32_16x16x32_bf16 v[224:227], v[84:87], v[104:107], v[224:227]
    v_max3_f32 v17, v17, v196, v197
    v_max3_f32 v17, v17, v198, v199
    v_mfma_f32_16x16x32_bf16 v[232:235], v[84:87], v[108:111], v[232:235]
    v_max3_f32 v18, v18, v204, v205
    v_max3_f32 v18, v18, v206, v207
    s_waitcnt lgkmcnt(5)
    v_mfma_f32_16x16x32_bf16 v[228:231], v[88:91], v[96:99], v[228:231]
    v_max3_f32 v17, v17, v208, v209
    v_mfma_f32_16x16x32_bf16 v[236:239], v[88:91], v[100:103], v[236:239]
    v_max3_f32 v17, v17, v210, v211
    s_waitcnt lgkmcnt(4)
    v_mfma_f32_16x16x32_bf16 v[228:231], v[92:95], v[104:107], v[228:231]
    v_max3_f32 v18, v18, v216, v217
    v_max3_f32 v18, v18, v218, v219
    v_mfma_f32_16x16x32_bf16 v[236:239], v[92:95], v[108:111], v[236:239]
    v_max3_f32 v17, v17, v212, v213
    v_max3_f32 v17, v17, v214, v215
    s_waitcnt lgkmcnt(3)
    v_mfma_f32_16x16x32_bf16 v[240:243], v[112:115], v[96:99], v[240:243]
    v_max3_f32 v18, v18, v220, v221
    v_max3_f32 v18, v18, v222, v223
    v_mfma_f32_16x16x32_bf16 v[248:251], v[112:115], v[100:103], v[248:251]
    v_max3_f32 v17, v17, v224, v225
    s_waitcnt lgkmcnt(2)
    v_mfma_f32_16x16x32_bf16 v[240:243], v[116:119], v[104:107], v[240:243]
    v_max3_f32 v17, v17, v226, v227
    v_max3_f32 v18, v18, v232, v233
    v_mfma_f32_16x16x32_bf16 v[248:251], v[116:119], v[108:111], v[248:251]
    v_max3_f32 v18, v18, v234, v235
    v_max3_f32 v17, v17, v228, v229
    s_waitcnt lgkmcnt(1)
    v_mfma_f32_16x16x32_bf16 v[244:247], v[120:123], v[96:99], v[244:247]
    v_max3_f32 v17, v17, v230, v231
    v_max3_f32 v18, v18, v236, v237
    v_mfma_f32_16x16x32_bf16 v[252:255], v[120:123], v[100:103], v[252:255]
    v_max3_f32 v18, v18, v238, v239
    s_waitcnt lgkmcnt(0)
    v_mfma_f32_16x16x32_bf16 v[244:247], v[124:127], v[104:107], v[244:247]
    v_max3_f32 v17, v17, v240, v241
    v_max3_f32 v17, v17, v242, v243
    v_mfma_f32_16x16x32_bf16 v[252:255], v[124:127], v[108:111], v[252:255]
    v_max3_f32 v18, v18, v248, v249
    v_max3_f32 v18, v18, v250, v251
    s_nop 2
    v_max3_f32 v17, v17, v244, v245
    v_max3_f32 v17, v17, v246, v247
    s_nop 0
    v_max3_f32 v18, v18, v252, v253
    v_max3_f32 v18, v18, v254, v255
    v_mov_b32 v25, v17
    s_nop 1
    v_permlane32_swap_b32 v17, v25
    v_max_f32 v17, v17, v25
    v_mov_b32 v25, v17
    s_nop 1
    v_permlane16_swap_b32 v17, v25
    v_max_f32 v17, v17, v25
    v_mul_f32 v17, s37, v17
    v_mov_b32 v25, v18
    s_nop 1
    v_permlane32_swap_b32 v18, v25
    v_max_f32 v18, v18, v25
    v_mov_b32 v25, v18
    s_nop 1
    v_permlane16_swap_b32 v18, v25
    v_max_f32 v18, v18, v25
    v_mul_f32 v18, s37, v18
    v_fma_f32 v128, v128, s37, -v17
    v_fma_f32 v129, v129, s37, -v17
    v_fma_f32 v130, v130, s37, -v17
    v_fma_f32 v131, v131, s37, -v17
    v_fma_f32 v132, v132, s37, -v17
    v_fma_f32 v133, v133, s37, -v17
    v_fma_f32 v134, v134, s37, -v17
    v_fma_f32 v135, v135, s37, -v17
    v_exp_f32 v128, v128
    v_exp_f32 v129, v129
    v_exp_f32 v130, v130
    v_exp_f32 v131, v131
    v_exp_f32 v132, v132
    v_exp_f32 v133, v133
    v_exp_f32 v134, v134
    v_exp_f32 v135, v135
    v_cvt_pk_bf16_f32 v128, v128, v129
    v_cvt_pk_bf16_f32 v129, v130, v131
    v_cvt_pk_bf16_f32 v130, v132, v133
    v_cvt_pk_bf16_f32 v131, v134, v135
    s_mov_b32 m0, s40
    s_add_u32 s40, s40, 32768
    s_cmp_eq_u32 s40, s41
    s_cselect_b32 s40, s35, s40
    buffer_load_dwordx4 v1, s[12:15], s33 offen offset:0 nt lds
    s_add_u32 m0, m0, 1024
    v_fma_f32 v136, v136, s37, -v18
    v_fma_f32 v137, v137, s37, -v18
    v_fma_f32 v138, v138, s37, -v18
    v_fma_f32 v139, v139, s37, -v18
    v_fma_f32 v140, v140, s37, -v18
    v_fma_f32 v141, v141, s37, -v18
    v_fma_f32 v142, v142, s37, -v18
    v_fma_f32 v143, v143, s37, -v18
    v_exp_f32 v136, v136
    v_exp_f32 v137, v137
    v_exp_f32 v138, v138
    v_exp_f32 v139, v139
    v_exp_f32 v140, v140
    v_exp_f32 v141, v141
    v_exp_f32 v142, v142
    v_exp_f32 v143, v143
    v_cvt_pk_bf16_f32 v136, v136, v137
    v_cvt_pk_bf16_f32 v137, v138, v139
    v_cvt_pk_bf16_f32 v138, v140, v141
    v_cvt_pk_bf16_f32 v139, v142, v143
    v_fma_f32 v144, v144, s37, -v17
    v_fma_f32 v145, v145, s37, -v17
    v_fma_f32 v146, v146, s37, -v17
    v_fma_f32 v147, v147, s37, -v17
    v_fma_f32 v148, v148, s37, -v17
    v_fma_f32 v149, v149, s37, -v17
    v_fma_f32 v150, v150, s37, -v17
    v_fma_f32 v151, v151, s37, -v17
    v_exp_f32 v144, v144
    v_exp_f32 v145, v145
    v_exp_f32 v146, v146
    v_exp_f32 v147, v147
    v_exp_f32 v148, v148
    v_exp_f32 v149, v149
    v_exp_f32 v150, v150
    v_exp_f32 v151, v151
    v_cvt_pk_bf16_f32 v144, v144, v145
    v_cvt_pk_bf16_f32 v145, v146, v147
    v_cvt_pk_bf16_f32 v146, v148, v149
    v_cvt_pk_bf16_f32 v147, v150, v151
    v_fma_f32 v152, v152, s37, -v18
    v_fma_f32 v153, v153, s37, -v18
    v_fma_f32 v154, v154, s37, -v18
    v_fma_f32 v155, v155, s37, -v18
    v_fma_f32 v156, v156, s37, -v18
    v_fma_f32 v157, v157, s37, -v18
    v_fma_f32 v158, v158, s37, -v18
    v_fma_f32 v159, v159, s37, -v18
    v_exp_f32 v152, v152
    v_exp_f32 v153, v153
    v_exp_f32 v154, v154
    v_exp_f32 v155, v155
    v_exp_f32 v156, v156
    v_exp_f32 v157, v157
    v_exp_f32 v158, v158
    v_exp_f32 v159, v159
    v_cvt_pk_bf16_f32 v152, v152, v153
    v_cvt_pk_bf16_f32 v153, v154, v155
    v_cvt_pk_bf16_f32 v154, v156, v157
    v_cvt_pk_bf16_f32 v155, v158, v159
    buffer_load_dwordx4 v2, s[12:15], s33 offen offset:0 nt lds
    s_add_u32 m0, m0, 1024
    v_fma_f32 v160, v160, s37, -v17
    v_fma_f32 v161, v161, s37, -v17
    v_fma_f32 v162, v162, s37, -v17
    v_fma_f32 v163, v163, s37, -v17
    v_fma_f32 v164, v164, s37, -v17
    v_fma_f32 v165, v165, s37, -v17
    v_fma_f32 v166, v166, s37, -v17
    v_fma_f32 v167, v167, s37, -v17
    v_exp_f32 v160, v160
    v_exp_f32 v161, v161
    v_exp_f32 v162, v162
    v_exp_f32 v163, v163
    v_exp_f32 v164, v164
    v_exp_f32 v165, v165
    v_exp_f32 v166, v166
    v_exp_f32 v167, v167
    v_cvt_pk_bf16_f32 v160, v160, v161
    v_cvt_pk_bf16_f32 v161, v162, v163
    v_cvt_pk_bf16_f32 v162, v164, v165
    v_cvt_pk_bf16_f32 v163, v166, v167
    v_fma_f32 v168, v168, s37, -v18
    v_fma_f32 v169, v169, s37, -v18
    v_fma_f32 v170, v170, s37, -v18
    v_fma_f32 v171, v171, s37, -v18
    v_fma_f32 v172, v172, s37, -v18
    v_fma_f32 v173, v173, s37, -v18
    v_fma_f32 v174, v174, s37, -v18
    v_fma_f32 v175, v175, s37, -v18
    v_exp_f32 v168, v168
    v_exp_f32 v169, v169
    v_exp_f32 v170, v170
    v_exp_f32 v171, v171
    v_exp_f32 v172, v172
    v_exp_f32 v173, v173
    v_exp_f32 v174, v174
    v_exp_f32 v175, v175
    v_cvt_pk_bf16_f32 v168, v168, v169
    v_cvt_pk_bf16_f32 v169, v170, v171
    v_cvt_pk_bf16_f32 v170, v172, v173
    v_cvt_pk_bf16_f32 v171, v174, v175
    v_fma_f32 v176, v176, s37, -v17
    v_fma_f32 v177, v177, s37, -v17
    v_fma_f32 v178, v178, s37, -v17
    v_fma_f32 v179, v179, s37, -v17
    v_fma_f32 v180, v180, s37, -v17
    v_fma_f32 v181, v181, s37, -v17
    v_fma_f32 v182, v182, s37, -v17
    v_fma_f32 v183, v183, s37, -v17
    v_exp_f32 v176, v176
    v_exp_f32 v177, v177
    v_exp_f32 v178, v178
    v_exp_f32 v179, v179
    v_exp_f32 v180, v180
    v_exp_f32 v181, v181
    v_exp_f32 v182, v182
    v_exp_f32 v183, v183
    v_cvt_pk_bf16_f32 v176, v176, v177
    v_cvt_pk_bf16_f32 v177, v178, v179
    v_cvt_pk_bf16_f32 v178, v180, v181
    v_cvt_pk_bf16_f32 v179, v182, v183
    buffer_load_dwordx4 v3, s[12:15], s33 offen offset:0 nt lds
    s_add_u32 m0, m0, 1024
    v_fma_f32 v184, v184, s37, -v18
    v_fma_f32 v185, v185, s37, -v18
    v_fma_f32 v186, v186, s37, -v18
    v_fma_f32 v187, v187, s37, -v18
    v_fma_f32 v188, v188, s37, -v18
    v_fma_f32 v189, v189, s37, -v18
    v_fma_f32 v190, v190, s37, -v18
    v_fma_f32 v191, v191, s37, -v18
    v_exp_f32 v184, v184
    v_exp_f32 v185, v185
    v_exp_f32 v186, v186
    v_exp_f32 v187, v187
    v_exp_f32 v188, v188
    v_exp_f32 v189, v189
    v_exp_f32 v190, v190
    v_exp_f32 v191, v191
    v_cvt_pk_bf16_f32 v184, v184, v185
    v_cvt_pk_bf16_f32 v185, v186, v187
    v_cvt_pk_bf16_f32 v186, v188, v189
    v_cvt_pk_bf16_f32 v187, v190, v191
    v_fma_f32 v192, v192, s37, -v17
    v_fma_f32 v193, v193, s37, -v17
    v_fma_f32 v194, v194, s37, -v17
    v_fma_f32 v195, v195, s37, -v17
    v_fma_f32 v196, v196, s37, -v17
    v_fma_f32 v197, v197, s37, -v17
    v_fma_f32 v198, v198, s37, -v17
    v_fma_f32 v199, v199, s37, -v17
    v_exp_f32 v192, v192
    v_exp_f32 v193, v193
    v_exp_f32 v194, v194
    v_exp_f32 v195, v195
    v_exp_f32 v196, v196
    v_exp_f32 v197, v197
    v_exp_f32 v198, v198
    v_exp_f32 v199, v199
    v_cvt_pk_bf16_f32 v192, v192, v193
    v_cvt_pk_bf16_f32 v193, v194, v195
    v_cvt_pk_bf16_f32 v194, v196, v197
    v_cvt_pk_bf16_f32 v195, v198, v199
    v_fma_f32 v200, v200, s37, -v18
    v_fma_f32 v201, v201, s37, -v18
    v_fma_f32 v202, v202, s37, -v18
    v_fma_f32 v203, v203, s37, -v18
    v_fma_f32 v204, v204, s37, -v18
    v_fma_f32 v205, v205, s37, -v18
    v_fma_f32 v206, v206, s37, -v18
    v_fma_f32 v207, v207, s37, -v18
    v_exp_f32 v200, v200
    v_exp_f32 v201, v201
    v_exp_f32 v202, v202
    v_exp_f32 v203, v203
    v_exp_f32 v204, v204
    v_exp_f32 v205, v205
    v_exp_f32 v206, v206
    v_exp_f32 v207, v207
    v_cvt_pk_bf16_f32 v200, v200, v201
    v_cvt_pk_bf16_f32 v201, v202, v203
    v_cvt_pk_bf16_f32 v202, v204, v205
    v_cvt_pk_bf16_f32 v203, v206, v207
    buffer_load_dwordx4 v4, s[12:15], s33 offen offset:0 nt lds
    v_add_u32 v11, s42, v7
    v_add_u32 v12, s42, v8
    v_add_u32 v13, s42, v9
    v_add_u32 v14, s42, v10
    s_add_u32 s42, s42, 32768
    s_cmp_eq_u32 s42, 163840
    s_cselect_b32 s42, 0, s42
    s_waitcnt vmcnt(12)
    s_barrier
    ds_read_b64_tr_b16 v[96:97], v11 offset:0
    ds_read_b64_tr_b16 v[98:99], v11 offset:2048
    ds_read_b64_tr_b16 v[100:101], v12 offset:0
    ds_read_b64_tr_b16 v[102:103], v12 offset:2048
    ds_read_b64_tr_b16 v[104:105], v13 offset:0
    ds_read_b64_tr_b16 v[106:107], v13 offset:2048
    ds_read_b64_tr_b16 v[108:109], v14 offset:0
    ds_read_b64_tr_b16 v[110:111], v14 offset:2048
    ds_read_b64_tr_b16 v[112:113], v11 offset:4096
    ds_read_b64_tr_b16 v[114:115], v11 offset:6144
    ds_read_b64_tr_b16 v[116:117], v12 offset:4096
    ds_read_b64_tr_b16 v[118:119], v12 offset:6144
    v_fma_f32 v208, v208, s37, -v17
    v_fma_f32 v209, v209, s37, -v17
    v_fma_f32 v210, v210, s37, -v17
    v_fma_f32 v211, v211, s37, -v17
    v_fma_f32 v212, v212, s37, -v17
    v_fma_f32 v213, v213, s37, -v17
    v_fma_f32 v214, v214, s37, -v17
    v_fma_f32 v215, v215, s37, -v17
    v_exp_f32 v208, v208
    v_exp_f32 v209, v209
    v_exp_f32 v210, v210
    v_exp_f32 v211, v211
    v_exp_f32 v212, v212
    v_exp_f32 v213, v213
    v_exp_f32 v214, v214
    v_exp_f32 v215, v215
    v_cvt_pk_bf16_f32 v208, v208, v209
    v_cvt_pk_bf16_f32 v209, v210, v211
    v_cvt_pk_bf16_f32 v210, v212, v213
    v_cvt_pk_bf16_f32 v211, v214, v215
    v_fma_f32 v216, v216, s37, -v18
    v_fma_f32 v217, v217, s37, -v18
    v_fma_f32 v218, v218, s37, -v18
    v_fma_f32 v219, v219, s37, -v18
    v_fma_f32 v220, v220, s37, -v18
    v_fma_f32 v221, v221, s37, -v18
    v_fma_f32 v222, v222, s37, -v18
    v_fma_f32 v223, v223, s37, -v18
    v_exp_f32 v216, v216
    v_exp_f32 v217, v217
    v_exp_f32 v218, v218
    v_exp_f32 v219, v219
    v_exp_f32 v220, v220
    v_exp_f32 v221, v221
    v_exp_f32 v222, v222
    v_exp_f32 v223, v223
    v_cvt_pk_bf16_f32 v216, v216, v217
    v_cvt_pk_bf16_f32 v217, v218, v219
    v_cvt_pk_bf16_f32 v218, v220, v221
    v_cvt_pk_bf16_f32 v219, v222, v223
    s_waitcnt lgkmcnt(10)
    v_mfma_f32_16x16x32_bf16 v[32:35], v[96:99], v[128:131], 0
    v_fma_f32 v224, v224, s37, -v17
    v_fma_f32 v225, v225, s37, -v17
    v_mfma_f32_16x16x32_bf16 v[36:39], v[96:99], v[136:139], 0
    ds_read_b64_tr_b16 v[120:121], v13 offset:4096
    ds_read_b64_tr_b16 v[122:123], v13 offset:6144
    s_mov_b32 m0, s40
    s_add_u32 s40, s40, 32768
    s_cmp_eq_u32 s40, s41
    s_cselect_b32 s40, s35, s40
    buffer_load_dwordx4 v1, s[16:19], s33 offen offset:0 nt lds
    s_add_u32 m0, m0, 1024
    v_fma_f32 v226, v226, s37, -v17
    s_waitcnt lgkmcnt(10)
    v_mfma_f32_16x16x32_bf16 v[40:43], v[100:103], v[128:131], 0
    v_fma_f32 v227, v227, s37, -v17
    v_fma_f32 v228, v228, s37, -v17
    v_mfma_f32_16x16x32_bf16 v[44:47], v[100:103], v[136:139], 0
    v_mfma_f32_16x16x32_bf16 v[132:135], v[26:29], v[128:131], 0
    ds_read_b64_tr_b16 v[124:125], v14 offset:4096
    ds_read_b64_tr_b16 v[126:127], v14 offset:6144
    v_fma_f32 v229, v229, s37, -v17
    s_waitcnt lgkmcnt(10)
    v_mfma_f32_16x16x32_bf16 v[48:51], v[104:107], v[128:131], 0
    v_fma_f32 v230, v230, s37, -v17
    v_fma_f32 v231, v231, s37, -v17
    v_mfma_f32_16x16x32_bf16 v[52:55], v[104:107], v[136:139], 0
    ds_read_b64_tr_b16 v[96:97], v11 offset:8192
    ds_read_b64_tr_b16 v[98:99], v11 offset:10240
    v_exp_f32 v224, v224
    s_waitcnt lgkmcnt(10)
    v_mfma_f32_16x16x32_bf16 v[56:59], v[108:111], v[128:131], 0
    v_exp_f32 v225, v225
    v_mfma_f32_16x16x32_bf16 v[60:63], v[108:111], v[136:139], 0
    v_mfma_f32_16x16x32_bf16 v[140:143], v[26:29], v[136:139], 0
    ds_read_b64_tr_b16 v[100:101], v12 offset:8192
    ds_read_b64_tr_b16 v[102:103], v12 offset:10240
    v_exp_f32 v226, v226
    v_exp_f32 v227, v227
    s_waitcnt lgkmcnt(10)
    v_mfma_f32_16x16x32_bf16 v[32:35], v[112:115], v[144:147], v[32:35]
    v_exp_f32 v228, v228
    v_mfma_f32_16x16x32_bf16 v[36:39], v[112:115], v[152:155], v[36:39]
    ds_read_b64_tr_b16 v[104:105], v13 offset:8192
    ds_read_b64_tr_b16 v[106:107], v13 offset:10240
    v_exp_f32 v229, v229
    v_exp_f32 v230, v230
    s_waitcnt lgkmcnt(10)
    v_mfma_f32_16x16x32_bf16 v[40:43], v[116:119], v[144:147], v[40:43]
    v_exp_f32 v231, v231
    v_mfma_f32_16x16x32_bf16 v[44:47], v[116:119], v[152:155], v[44:47]
    v_mfma_f32_16x16x32_bf16 v[132:135], v[26:29], v[144:147], v[132:135]
    ds_read_b64_tr_b16 v[108:109], v14 offset:8192
    ds_read_b64_tr_b16 v[110:111], v14 offset:10240
    v_cvt_pk_bf16_f32 v224, v224, v225
    v_cvt_pk_bf16_f32 v225, v226, v227
    s_waitcnt lgkmcnt(10)
    v_mfma_f32_16x16x32_bf16 v[48:51], v[120:123], v[144:147], v[48:51]
    v_cvt_pk_bf16_f32 v226, v228, v229
    v_mfma_f32_16x16x32_bf16 v[52:55], v[120:123], v[152:155], v[52:55]
    ds_read_b64_tr_b16 v[112:113], v11 offset:12288
    ds_read_b64_tr_b16 v[114:115], v11 offset:14336
    v_cvt_pk_bf16_f32 v227, v230, v231
    s_waitcnt lgkmcnt(10)
    v_mfma_f32_16x16x32_bf16 v[56:59], v[124:127], v[144:147], v[56:59]
    v_fma_f32 v232, v232, s37, -v18
    v_fma_f32 v233, v233, s37, -v18
    v_mfma_f32_16x16x32_bf16 v[60:63], v[124:127], v[152:155], v[60:63]
    v_mfma_f32_16x16x32_bf16 v[140:143], v[26:29], v[152:155], v[140:143]
    ds_read_b64_tr_b16 v[116:117], v12 offset:12288
    ds_read_b64_tr_b16 v[118:119], v12 offset:14336
    v_fma_f32 v234, v234, s37, -v18
    s_waitcnt lgkmcnt(10)
    v_mfma_f32_16x16x32_bf16 v[32:35], v[96:99], v[160:163], v[32:35]
    v_fma_f32 v235, v235, s37, -v18
    v_fma_f32 v236, v236, s37, -v18
    v_mfma_f32_16x16x32_bf16 v[36:39], v[96:99], v[168:171], v[36:39]
    ds_read_b64_tr_b16 v[120:121], v13 offset:12288
    ds_read_b64_tr_b16 v[122:123], v13 offset:14336
    v_fma_f32 v237, v237, s37, -v18
    s_waitcnt lgkmcnt(10)
    v_mfma_f32_16x16x32_bf16 v[40:43], v[100:103], v[160:163], v[40:43]
    v_fma_f32 v238, v238, s37, -v18
    v_fma_f32 v239, v239, s37, -v18
    v_mfma_f32_16x16x32_bf16 v[44:47], v[100:103], v[168:171], v[44:47]
    v_mfma_f32_16x16x32_bf16 v[132:135], v[26:29], v[160:163], v[132:135]
    ds_read_b64_tr_b16 v[124:125], v14 offset:12288
    ds_read_b64_tr_b16 v[126:127], v14 offset:14336
    v_exp_f32 v232, v232
    s_waitcnt lgkmcnt(10)
    v_mfma_f32_16x16x32_bf16 v[48:51], v[104:107], v[160:163], v[48:51]
    buffer_load_dwordx4 v2, s[16:19], s33 offen offset:0 nt lds
    s_add_u32 m0, m0, 1024
    v_exp_f32 v233, v233
    v_mfma_f32_16x16x32_bf16 v[52:55], v[104:107], v[168:171], v[52:55]
    ds_read_b64_tr_b16 v[96:97], v11 offset:16384
    ds_read_b64_tr_b16 v[98:99], v11 offset:18432
    v_exp_f32 v234, v234
    v_exp_f32 v235, v235
    s_waitcnt lgkmcnt(10)
    v_mfma_f32_16x16x32_bf16 v[56:59], v[108:111], v[160:163], v[56:59]
    v_exp_f32 v236, v236
    v_mfma_f32_16x16x32_bf16 v[60:63], v[108:111], v[168:171], v[60:63]
    v_mfma_f32_16x16x32_bf16 v[140:143], v[26:29], v[168:171], v[140:143]
    ds_read_b64_tr_b16 v[100:101], v12 offset:16384
    ds_read_b64_tr_b16 v[102:103], v12 offset:18432
    v_exp_f32 v237, v237
    v_exp_f32 v238, v238
    s_waitcnt lgkmcnt(10)
    v_mfma_f32_16x16x32_bf16 v[32:35], v[112:115], v[176:179], v[32:35]
    v_exp_f32 v239, v239
    v_mfma_f32_16x16x32_bf16 v[36:39], v[112:115], v[184:187], v[36:39]
    ds_read_b64_tr_b16 v[104:105], v13 offset:16384
    ds_read_b64_tr_b16 v[106:107], v13 offset:18432
    v_cvt_pk_bf16_f32 v232, v232, v233
    v_cvt_pk_bf16_f32 v233, v234, v235
    s_waitcnt lgkmcnt(10)
    v_mfma_f32_16x16x32_bf16 v[40:43], v[116:119], v[176:179], v[40:43]
    v_cvt_pk_bf16_f32 v234, v236, v237
    v_mfma_f32_16x16x32_bf16 v[44:47], v[116:119], v[184:187], v[44:47]
    v_mfma_f32_16x16x32_bf16 v[132:135], v[26:29], v[176:179], v[132:135]
    ds_read_b64_tr_b16 v[108:109], v14 offset:16384
    ds_read_b64_tr_b16 v[110:111], v14 offset:18432
    v_cvt_pk_bf16_f32 v235, v238, v239
    s_waitcnt lgkmcnt(10)
    v_mfma_f32_16x16x32_bf16 v[48:51], v[120:123], v[176:179], v[48:51]
    v_fma_f32 v240, v240, s37, -v17
    v_fma_f32 v241, v241, s37, -v17
    v_mfma_f32_16x16x32_bf16 v[52:55], v[120:123], v[184:187], v[52:55]
    ds_read_b64_tr_b16 v[112:113], v11 offset:20480
    ds_read_b64_tr_b16 v[114:115], v11 offset:22528
    v_fma_f32 v242, v242, s37, -v17
    s_waitcnt lgkmcnt(10)
    v_mfma_f32_16x16x32_bf16 v[56:59], v[124:127], v[176:179], v[56:59]
    v_fma_f32 v243, v243, s37, -v17
    v_fma_f32 v244, v244, s37, -v17
    v_mfma_f32_16x16x32_bf16 v[60:63], v[124:127], v[184:187], v[60:63]
    v_mfma_f32_16x16x32_bf16 v[140:143], v[26:29], v[184:187], v[140:143]
    ds_read_b64_tr_b16 v[116:117], v12 offset:20480
    ds_read_b64_tr_b16 v[118:119], v12 offset:22528
    v_fma_f32 v245, v245, s37, -v17
    s_waitcnt lgkmcnt(10)
    v_mfma_f32_16x16x32_bf16 v[32:35], v[96:99], v[192:195], v[32:35]
    v_fma_f32 v246, v246, s37, -v17
    v_fma_f32 v247, v247, s37, -v17
    v_mfma_f32_16x16x32_bf16 v[36:39], v[96:99], v[200:203], v[36:39]
    ds_read_b64_tr_b16 v[120:121], v13 offset:20480
    ds_read_b64_tr_b16 v[122:123], v13 offset:22528
    v_exp_f32 v240, v240
    s_waitcnt lgkmcnt(10)
    v_mfma_f32_16x16x32_bf16 v[40:43], v[100:103], v[192:195], v[40:43]
    v_exp_f32 v241, v241
    v_mfma_f32_16x16x32_bf16 v[44:47], v[100:103], v[200:203], v[44:47]
    v_mfma_f32_16x16x32_bf16 v[132:135], v[26:29], v[192:195], v[132:135]
    ds_read_b64_tr_b16 v[124:125], v14 offset:20480
    ds_read_b64_tr_b16 v[126:127], v14 offset:22528
    v_exp_f32 v242, v242
    v_exp_f32 v243, v243
    s_waitcnt lgkmcnt(10)
    v_mfma_f32_16x16x32_bf16 v[48:51], v[104:107], v[192:195], v[48:51]
    v_exp_f32 v244, v244
    v_mfma_f32_16x16x32_bf16 v[52:55], v[104:107], v[200:203], v[52:55]
    ds_read_b64_tr_b16 v[96:97], v11 offset:24576
    ds_read_b64_tr_b16 v[98:99], v11 offset:26624
    v_exp_f32 v245, v245
    v_exp_f32 v246, v246
    s_waitcnt lgkmcnt(10)
    v_mfma_f32_16x16x32_bf16 v[56:59], v[108:111], v[192:195], v[56:59]
    v_exp_f32 v247, v247
    v_mfma_f32_16x16x32_bf16 v[60:63], v[108:111], v[200:203], v[60:63]
    v_mfma_f32_16x16x32_bf16 v[140:143], v[26:29], v[200:203], v[140:143]
    ds_read_b64_tr_b16 v[100:101], v12 offset:24576
    ds_read_b64_tr_b16 v[102:103], v12 offset:26624
    v_cvt_pk_bf16_f32 v240, v240, v241
    v_cvt_pk_bf16_f32 v241, v242, v243
    s_waitcnt lgkmcnt(10)
    v_mfma_f32_16x16x32_bf16 v[32:35], v[112:115], v[208:211], v[32:35]
    buffer_load_dwordx4 v3, s[16:19], s33 offen offset:0 nt lds
    s_add_u32 m0, m0, 1024
    v_cvt_pk_bf16_f32 v242, v244, v245
    v_mfma_f32_16x16x32_bf16 v[36:39], v[112:115], v[216:219], v[36:39]
    ds_read_b64_tr_b16 v[104:105], v13 offset:24576
    ds_read_b64_tr_b16 v[106:107], v13 offset:26624
    v_cvt_pk_bf16_f32 v243, v246, v247
    s_waitcnt lgkmcnt(10)
    v_mfma_f32_16x16x32_bf16 v[40:43], v[116:119], v[208:211], v[40:43]
    v_fma_f32 v248, v248, s37, -v18
    v_fma_f32 v249, v249, s37, -v18
    v_mfma_f32_16x16x32_bf16 v[44:47], v[116:119], v[216:219], v[44:47]
    v_mfma_f32_16x16x32_bf16 v[132:135], v[26:29], v[208:211], v[132:135]
    ds_read_b64_tr_b16 v[108:109], v14 offset:24576
    ds_read_b64_tr_b16 v[110:111], v14 offset:26624
    v_fma_f32 v250, v250, s37, -v18
    s_waitcnt lgkmcnt(10)
    v_mfma_f32_16x16x32_bf16 v[48:51], v[120:123], v[208:211], v[48:51]
    v_fma_f32 v251, v251, s37, -v18
    v_fma_f32 v252, v252, s37, -v18
    v_mfma_f32_16x16x32_bf16 v[52:55], v[120:123], v[216:219], v[52:55]
    ds_read_b64_tr_b16 v[112:113], v11 offset:28672
    ds_read_b64_tr_b16 v[114:115], v11 offset:30720
    v_fma_f32 v253, v253, s37, -v18
    s_waitcnt lgkmcnt(10)
    v_mfma_f32_16x16x32_bf16 v[56:59], v[124:127], v[208:211], v[56:59]
    v_fma_f32 v254, v254, s37, -v18
    v_fma_f32 v255, v255, s37, -v18
    v_mfma_f32_16x16x32_bf16 v[60:63], v[124:127], v[216:219], v[60:63]
    v_mfma_f32_16x16x32_bf16 v[140:143], v[26:29], v[216:219], v[140:143]
    ds_read_b64_tr_b16 v[116:117], v12 offset:28672
    ds_read_b64_tr_b16 v[118:119], v12 offset:30720
    v_exp_f32 v248, v248
    s_waitcnt lgkmcnt(10)
    v_mfma_f32_16x16x32_bf16 v[32:35], v[96:99], v[224:227], v[32:35]
    v_exp_f32 v249, v249
    v_mfma_f32_16x16x32_bf16 v[36:39], v[96:99], v[232:235], v[36:39]
    ds_read_b64_tr_b16 v[120:121], v13 offset:28672
    ds_read_b64_tr_b16 v[122:123], v13 offset:30720
    v_exp_f32 v250, v250
    v_exp_f32 v251, v251
    s_waitcnt lgkmcnt(10)
    v_mfma_f32_16x16x32_bf16 v[40:43], v[100:103], v[224:227], v[40:43]
    v_exp_f32 v252, v252
    v_mfma_f32_16x16x32_bf16 v[44:47], v[100:103], v[232:235], v[44:47]
    v_mfma_f32_16x16x32_bf16 v[132:135], v[26:29], v[224:227], v[132:135]
    ds_read_b64_tr_b16 v[124:125], v14 offset:28672
    ds_read_b64_tr_b16 v[126:127], v14 offset:30720
    v_exp_f32 v253, v253
    v_exp_f32 v254, v254
    s_waitcnt lgkmcnt(10)
    v_mfma_f32_16x16x32_bf16 v[48:51], v[104:107], v[224:227], v[48:51]
    v_exp_f32 v255, v255
    v_mfma_f32_16x16x32_bf16 v[52:55], v[104:107], v[232:235], v[52:55]
    v_cvt_pk_bf16_f32 v248, v248, v249
    v_cvt_pk_bf16_f32 v249, v250, v251
    s_waitcnt lgkmcnt(8)
    v_mfma_f32_16x16x32_bf16 v[56:59], v[108:111], v[224:227], v[56:59]
    v_cvt_pk_bf16_f32 v250, v252, v253
    v_mfma_f32_16x16x32_bf16 v[60:63], v[108:111], v[232:235], v[60:63]
    v_mfma_f32_16x16x32_bf16 v[140:143], v[26:29], v[232:235], v[140:143]
    v_cvt_pk_bf16_f32 v251, v254, v255
    s_waitcnt lgkmcnt(6)
    v_mfma_f32_16x16x32_bf16 v[32:35], v[112:115], v[240:243], v[32:35]
    v_mfma_f32_16x16x32_bf16 v[36:39], v[112:115], v[248:251], v[36:39]
    s_waitcnt lgkmcnt(4)
    v_mfma_f32_16x16x32_bf16 v[40:43], v[116:119], v[240:243], v[40:43]
    v_mfma_f32_16x16x32_bf16 v[44:47], v[116:119], v[248:251], v[44:47]
    v_mfma_f32_16x16x32_bf16 v[132:135], v[26:29], v[240:243], v[132:135]
    s_waitcnt lgkmcnt(2)
    v_mfma_f32_16x16x32_bf16 v[48:51], v[120:123], v[240:243], v[48:51]
    buffer_load_dwordx4 v4, s[16:19], s33 offen offset:0 nt lds
    v_mfma_f32_16x16x32_bf16 v[52:55], v[120:123], v[248:251], v[52:55]
    s_waitcnt lgkmcnt(0)
    v_mfma_f32_16x16x32_bf16 v[56:59], v[124:127], v[240:243], v[56:59]
    v_mfma_f32_16x16x32_bf16 v[60:63], v[124:127], v[248:251], v[60:63]
    v_mfma_f32_16x16x32_bf16 v[140:143], v[26:29], v[248:251], v[140:143]
    v_add_u32 v11, s42, v7
    v_add_u32 v12, s42, v8
    v_add_u32 v13, s42, v9
    v_add_u32 v14, s42, v10
    s_add_u32 s42, s42, 32768
    s_cmp_eq_u32 s42, 163840
    s_cselect_b32 s42, 0, s42
    s_waitcnt vmcnt(12)
    s_barrier
    ds_read_b64_tr_b16 v[96:97], v11 offset:0
    ds_read_b64_tr_b16 v[98:99], v11 offset:2048
    ds_read_b64_tr_b16 v[100:101], v12 offset:0
    ds_read_b64_tr_b16 v[102:103], v12 offset:2048
    ds_read_b64_tr_b16 v[104:105], v13 offset:0
    ds_read_b64_tr_b16 v[106:107], v13 offset:2048
    ds_read_b64_tr_b16 v[108:109], v14 offset:0
    ds_read_b64_tr_b16 v[110:111], v14 offset:2048
    ds_read_b64_tr_b16 v[112:113], v11 offset:4096
    ds_read_b64_tr_b16 v[114:115], v11 offset:6144
    ds_read_b64_tr_b16 v[116:117], v12 offset:4096
    ds_read_b64_tr_b16 v[118:119], v12 offset:6144
    v_rcp_f32 v19, v132
    v_rcp_f32 v20, v140
    s_waitcnt lgkmcnt(10)
    v_mfma_f32_16x16x32_bf16 v[64:67], v[96:99], v[128:131], 0
    v_add_u32 v21, s40, v15
    v_add_u32 v25, s40, v16
    v_xor_b32 v22, 32, v21
    v_xor_b32 v23, 64, v21
    v_xor_b32 v24, 96, v21
    v_mfma_f32_16x16x32_bf16 v[68:71], v[96:99], v[136:139], 0
    ds_read_b64_tr_b16 v[120:121], v13 offset:4096
    ds_read_b64_tr_b16 v[122:123], v13 offset:6144
    v_mul_f32 v32, v32, v19
    v_mul_f32 v33, v33, v19
    v_mul_f32 v34, v34, v19
    v_mul_f32 v35, v35, v19
    v_cvt_pk_bf16_f32 v32, v32, v33
    s_waitcnt lgkmcnt(10)
    v_mfma_f32_16x16x32_bf16 v[72:75], v[100:103], v[128:131], 0
    v_cvt_pk_bf16_f32 v33, v34, v35
    ds_write_b64 v21, v[32:33] offset:0
    v_mul_f32 v36, v36, v20
    v_mul_f32 v37, v37, v20
    v_mul_f32 v38, v38, v20
    v_mfma_f32_16x16x32_bf16 v[76:79], v[100:103], v[136:139], 0
    ds_read_b64_tr_b16 v[124:125], v14 offset:4096
    ds_read_b64_tr_b16 v[126:127], v14 offset:6144
    v_mul_f32 v39, v39, v20
    v_cvt_pk_bf16_f32 v36, v36, v37
    v_cvt_pk_bf16_f32 v37, v38, v39
    ds_write_b64 v21, v[36:37] offset:2048
    v_mul_f32 v40, v40, v19
    s_waitcnt lgkmcnt(12)
    v_mfma_f32_16x16x32_bf16 v[80:83], v[104:107], v[128:131], 0
    v_mul_f32 v41, v41, v19
    v_mul_f32 v42, v42, v19
    v_mul_f32 v43, v43, v19
    v_cvt_pk_bf16_f32 v40, v40, v41
    v_cvt_pk_bf16_f32 v41, v42, v43
    v_mfma_f32_16x16x32_bf16 v[84:87], v[104:107], v[136:139], 0
    ds_read_b64_tr_b16 v[96:97], v11 offset:8192
    ds_read_b64_tr_b16 v[98:99], v11 offset:10240
    ds_write_b64 v22, v[40:41] offset:0
    v_mul_f32 v44, v44, v20
    v_mul_f32 v45, v45, v20
    v_mul_f32 v46, v46, v20
    v_mul_f32 v47, v47, v20
    s_waitcnt lgkmcnt(13)
    v_mfma_f32_16x16x32_bf16 v[88:91], v[108:111], v[128:131], 0
    v_cvt_pk_bf16_f32 v44, v44, v45
    v_cvt_pk_bf16_f32 v45, v46, v47
    ds_write_b64 v22, v[44:45] offset:2048
    v_mul_f32 v48, v48, v19
    v_mul_f32 v49, v49, v19
    v_mfma_f32_16x16x32_bf16 v[92:95], v[108:111], v[136:139], 0
    ds_read_b64_tr_b16 v[100:101], v12 offset:8192
    s_waitcnt lgkmcnt(14)
    ds_read_b64_tr_b16 v[102:103], v12 offset:10240
    v_mul_f32 v50, v50, v19
    v_mul_f32 v51, v51, v19
    v_cvt_pk_bf16_f32 v48, v48, v49
    v_cvt_pk_bf16_f32 v49, v50, v51
    s_waitcnt lgkmcnt(14)
    ds_write_b64 v23, v[48:49] offset:0
    v_mfma_f32_16x16x32_bf16 v[64:67], v[112:115], v[144:147], v[64:67]
    v_mul_f32 v52, v52, v20
    v_mul_f32 v53, v53, v20
    v_mul_f32 v54, v54, v20
    v_mul_f32 v55, v55, v20
    v_cvt_pk_bf16_f32 v52, v52, v53
    v_mfma_f32_16x16x32_bf16 v[68:71], v[112:115], v[152:155], v[68:71]
    s_waitcnt lgkmcnt(14)
    ds_read_b64_tr_b16 v[104:105], v13 offset:8192
    s_waitcnt lgkmcnt(14)
    ds_read_b64_tr_b16 v[106:107], v13 offset:10240
    v_cvt_pk_bf16_f32 v53, v54, v55
    s_waitcnt lgkmcnt(14)
    ds_write_b64 v23, v[52:53] offset:2048
    v_mul_f32 v56, v56, v19
    v_mul_f32 v57, v57, v19
    v_mul_f32 v58, v58, v19
    v_mfma_f32_16x16x32_bf16 v[72:75], v[116:119], v[144:147], v[72:75]
    v_mul_f32 v59, v59, v19
    v_cvt_pk_bf16_f32 v56, v56, v57
    v_cvt_pk_bf16_f32 v57, v58, v59
    s_waitcnt lgkmcnt(14)
    ds_write_b64 v24, v[56:57] offset:0
    v_mul_f32 v60, v60, v20
    v_mfma_f32_16x16x32_bf16 v[76:79], v[116:119], v[152:155], v[76:79]
    s_waitcnt lgkmcnt(14)
    ds_read_b64_tr_b16 v[108:109], v14 offset:8192
    s_waitcnt lgkmcnt(14)
    ds_read_b64_tr_b16 v[110:111], v14 offset:10240
    v_mul_f32 v61, v61, v20
    v_mul_f32 v62, v62, v20
    v_mul_f32 v63, v63, v20
    v_cvt_pk_bf16_f32 v60, v60, v61
    v_cvt_pk_bf16_f32 v61, v62, v63
    v_mfma_f32_16x16x32_bf16 v[80:83], v[120:123], v[144:147], v[80:83]
    s_waitcnt lgkmcnt(14)
    ds_write_b64 v24, v[60:61] offset:2048
    v_mfma_f32_16x16x32_bf16 v[84:87], v[120:123], v[152:155], v[84:87]
    s_waitcnt lgkmcnt(14)
    ds_read_b64_tr_b16 v[112:113], v11 offset:12288
    s_waitcnt lgkmcnt(14)
    ds_read_b64_tr_b16 v[114:115], v11 offset:14336
    s_waitcnt lgkmcnt(14)
    ds_read_b128 v[48:51], v25 offset:0
    s_waitcnt lgkmcnt(14)
    ds_read_b128 v[52:55], v25 offset:1024
    s_waitcnt lgkmcnt(14)
    ds_read_b128 v[56:59], v25 offset:2048
    s_waitcnt lgkmcnt(14)
    ds_read_b128 v[60:63], v25 offset:3072
    v_mfma_f32_16x16x32_bf16 v[88:91], v[124:127], v[144:147], v[88:91]
    v_mfma_f32_16x16x32_bf16 v[92:95], v[124:127], v[152:155], v[92:95]
    s_waitcnt lgkmcnt(14)
    ds_read_b64_tr_b16 v[116:117], v12 offset:12288
    s_waitcnt lgkmcnt(14)
    ds_read_b64_tr_b16 v[118:119], v12 offset:14336
    v_mfma_f32_16x16x32_bf16 v[64:67], v[96:99], v[160:163], v[64:67]
    s_waitcnt lgkmcnt(5)
    buffer_store_dwordx4 v[48:51], v1, s[24:27], s32 offen offset:0 sc1
    v_mfma_f32_16x16x32_bf16 v[68:71], v[96:99], v[168:171], v[68:71]
    ds_read_b64_tr_b16 v[120:121], v13 offset:12288
    ds_read_b64_tr_b16 v[122:123], v13 offset:14336
    v_mfma_f32_16x16x32_bf16 v[72:75], v[100:103], v[160:163], v[72:75]
    v_mfma_f32_16x16x32_bf16 v[76:79], v[100:103], v[168:171], v[76:79]
    ds_read_b64_tr_b16 v[124:125], v14 offset:12288
    ds_read_b64_tr_b16 v[126:127], v14 offset:14336
    v_mfma_f32_16x16x32_bf16 v[80:83], v[104:107], v[160:163], v[80:83]
    v_mfma_f32_16x16x32_bf16 v[84:87], v[104:107], v[168:171], v[84:87]
    ds_read_b64_tr_b16 v[96:97], v11 offset:16384
    ds_read_b64_tr_b16 v[98:99], v11 offset:18432
    v_mfma_f32_16x16x32_bf16 v[88:91], v[108:111], v[160:163], v[88:91]
    s_waitcnt lgkmcnt(10)
    buffer_store_dwordx4 v[52:55], v2, s[24:27], s32 offen offset:0 sc1
    v_mfma_f32_16x16x32_bf16 v[92:95], v[108:111], v[168:171], v[92:95]
    ds_read_b64_tr_b16 v[100:101], v12 offset:16384
    ds_read_b64_tr_b16 v[102:103], v12 offset:18432
    v_mfma_f32_16x16x32_bf16 v[64:67], v[112:115], v[176:179], v[64:67]
    v_mfma_f32_16x16x32_bf16 v[68:71], v[112:115], v[184:187], v[68:71]
    ds_read_b64_tr_b16 v[104:105], v13 offset:16384
    ds_read_b64_tr_b16 v[106:107], v13 offset:18432
    s_waitcnt lgkmcnt(10)
    v_mfma_f32_16x16x32_bf16 v[72:75], v[116:119], v[176:179], v[72:75]
    v_mfma_f32_16x16x32_bf16 v[76:79], v[116:119], v[184:187], v[76:79]
    ds_read_b64_tr_b16 v[108:109], v14 offset:16384
    ds_read_b64_tr_b16 v[110:111], v14 offset:18432
    s_waitcnt lgkmcnt(10)
    v_mfma_f32_16x16x32_bf16 v[80:83], v[120:123], v[176:179], v[80:83]
    buffer_store_dwordx4 v[56:59], v3, s[24:27], s32 offen offset:0 sc1
    v_mfma_f32_16x16x32_bf16 v[84:87], v[120:123], v[184:187], v[84:87]
    ds_read_b64_tr_b16 v[112:113], v11 offset:20480
    ds_read_b64_tr_b16 v[114:115], v11 offset:22528
    s_waitcnt lgkmcnt(10)
    v_mfma_f32_16x16x32_bf16 v[88:91], v[124:127], v[176:179], v[88:91]
    v_mfma_f32_16x16x32_bf16 v[92:95], v[124:127], v[184:187], v[92:95]
    ds_read_b64_tr_b16 v[116:117], v12 offset:20480
    ds_read_b64_tr_b16 v[118:119], v12 offset:22528
    s_waitcnt lgkmcnt(10)
    v_mfma_f32_16x16x32_bf16 v[64:67], v[96:99], v[192:195], v[64:67]
    v_mfma_f32_16x16x32_bf16 v[68:71], v[96:99], v[200:203], v[68:71]
    ds_read_b64_tr_b16 v[120:121], v13 offset:20480
    ds_read_b64_tr_b16 v[122:123], v13 offset:22528
    s_waitcnt lgkmcnt(10)
    v_mfma_f32_16x16x32_bf16 v[72:75], v[100:103], v[192:195], v[72:75]
    buffer_store_dwordx4 v[60:63], v4, s[24:27], s32 offen offset:0 sc1
    v_mfma_f32_16x16x32_bf16 v[76:79], v[100:103], v[200:203], v[76:79]
    ds_read_b64_tr_b16 v[124:125], v14 offset:20480
    ds_read_b64_tr_b16 v[126:127], v14 offset:22528
    s_waitcnt lgkmcnt(10)
    v_mfma_f32_16x16x32_bf16 v[80:83], v[104:107], v[192:195], v[80:83]
    v_mfma_f32_16x16x32_bf16 v[84:87], v[104:107], v[200:203], v[84:87]
    ds_read_b64_tr_b16 v[96:97], v11 offset:24576
    ds_read_b64_tr_b16 v[98:99], v11 offset:26624
    s_waitcnt lgkmcnt(10)
    v_mfma_f32_16x16x32_bf16 v[88:91], v[108:111], v[192:195], v[88:91]
    v_mfma_f32_16x16x32_bf16 v[92:95], v[108:111], v[200:203], v[92:95]
    ds_read_b64_tr_b16 v[100:101], v12 offset:24576
    ds_read_b64_tr_b16 v[102:103], v12 offset:26624
    s_waitcnt lgkmcnt(10)
    v_mfma_f32_16x16x32_bf16 v[64:67], v[112:115], v[208:211], v[64:67]
    v_mfma_f32_16x16x32_bf16 v[68:71], v[112:115], v[216:219], v[68:71]
    ds_read_b64_tr_b16 v[104:105], v13 offset:24576
    ds_read_b64_tr_b16 v[106:107], v13 offset:26624
    s_add_u32 s39, s33, 128
    s_mov_b32 m0, s40
    s_add_u32 s40, s40, 32768
    s_cmp_eq_u32 s40, s41
    s_cselect_b32 s40, s35, s40
    buffer_load_dwordx4 v1, s[12:15], s39 offen offset:0 nt lds
    s_add_u32 m0, m0, 1024
    s_waitcnt lgkmcnt(10)
    v_mfma_f32_16x16x32_bf16 v[72:75], v[116:119], v[208:211], v[72:75]
    v_mfma_f32_16x16x32_bf16 v[76:79], v[116:119], v[216:219], v[76:79]
    ds_read_b64_tr_b16 v[108:109], v14 offset:24576
    ds_read_b64_tr_b16 v[110:111], v14 offset:26624
    s_waitcnt lgkmcnt(10)
    v_mfma_f32_16x16x32_bf16 v[80:83], v[120:123], v[208:211], v[80:83]
    v_mfma_f32_16x16x32_bf16 v[84:87], v[120:123], v[216:219], v[84:87]
    ds_read_b64_tr_b16 v[112:113], v11 offset:28672
    ds_read_b64_tr_b16 v[114:115], v11 offset:30720
    s_waitcnt lgkmcnt(10)
    v_mfma_f32_16x16x32_bf16 v[88:91], v[124:127], v[208:211], v[88:91]
    v_mfma_f32_16x16x32_bf16 v[92:95], v[124:127], v[216:219], v[92:95]
    ds_read_b64_tr_b16 v[116:117], v12 offset:28672
    ds_read_b64_tr_b16 v[118:119], v12 offset:30720
    buffer_load_dwordx4 v2, s[12:15], s39 offen offset:0 nt lds
    s_add_u32 m0, m0, 1024
    s_waitcnt lgkmcnt(10)
    v_mfma_f32_16x16x32_bf16 v[64:67], v[96:99], v[224:227], v[64:67]
    v_mfma_f32_16x16x32_bf16 v[68:71], v[96:99], v[232:235], v[68:71]
    ds_read_b64_tr_b16 v[120:121], v13 offset:28672
    ds_read_b64_tr_b16 v[122:123], v13 offset:30720
    s_waitcnt lgkmcnt(10)
    v_mfma_f32_16x16x32_bf16 v[72:75], v[100:103], v[224:227], v[72:75]
    v_mfma_f32_16x16x32_bf16 v[76:79], v[100:103], v[232:235], v[76:79]
    ds_read_b64_tr_b16 v[124:125], v14 offset:28672
    ds_read_b64_tr_b16 v[126:127], v14 offset:30720
    s_waitcnt lgkmcnt(10)
    v_mfma_f32_16x16x32_bf16 v[80:83], v[104:107], v[224:227], v[80:83]
    v_mfma_f32_16x16x32_bf16 v[84:87], v[104:107], v[232:235], v[84:87]
    buffer_load_dwordx4 v3, s[12:15], s39 offen offset:0 nt lds
    s_add_u32 m0, m0, 1024
    s_waitcnt lgkmcnt(8)
    v_mfma_f32_16x16x32_bf16 v[88:91], v[108:111], v[224:227], v[88:91]
    v_mfma_f32_16x16x32_bf16 v[92:95], v[108:111], v[232:235], v[92:95]
    s_waitcnt lgkmcnt(6)
    v_mfma_f32_16x16x32_bf16 v[64:67], v[112:115], v[240:243], v[64:67]
    v_mfma_f32_16x16x32_bf16 v[68:71], v[112:115], v[248:251], v[68:71]
    s_waitcnt lgkmcnt(4)
    v_mfma_f32_16x16x32_bf16 v[72:75], v[116:119], v[240:243], v[72:75]
    v_mfma_f32_16x16x32_bf16 v[76:79], v[116:119], v[248:251], v[76:79]
    s_waitcnt lgkmcnt(2)
    v_mfma_f32_16x16x32_bf16 v[80:83], v[120:123], v[240:243], v[80:83]
    buffer_load_dwordx4 v4, s[12:15], s39 offen offset:0 nt lds
    v_mfma_f32_16x16x32_bf16 v[84:87], v[120:123], v[248:251], v[84:87]
    s_waitcnt lgkmcnt(0)
    v_mfma_f32_16x16x32_bf16 v[88:91], v[124:127], v[240:243], v[88:91]
    v_mfma_f32_16x16x32_bf16 v[92:95], v[124:127], v[248:251], v[92:95]
    v_add_u32 v11, s42, v7
    v_add_u32 v12, s42, v8
    v_add_u32 v13, s42, v9
    v_add_u32 v14, s42, v10
    s_add_u32 s42, s42, 32768
    s_cmp_eq_u32 s42, 163840
    s_cselect_b32 s42, 0, s42
    s_waitcnt vmcnt(16)
    s_barrier
    ds_read_b64_tr_b16 v[96:97], v11 offset:0
    ds_read_b64_tr_b16 v[98:99], v11 offset:2048
    ds_read_b64_tr_b16 v[100:101], v12 offset:0
    ds_read_b64_tr_b16 v[102:103], v12 offset:2048
    ds_read_b64_tr_b16 v[104:105], v13 offset:0
    ds_read_b64_tr_b16 v[106:107], v13 offset:2048
    ds_read_b64_tr_b16 v[108:109], v14 offset:0
    ds_read_b64_tr_b16 v[110:111], v14 offset:2048
    ds_read_b64_tr_b16 v[112:113], v11 offset:4096
    ds_read_b64_tr_b16 v[114:115], v11 offset:6144
    ds_read_b64_tr_b16 v[116:117], v12 offset:4096
    ds_read_b64_tr_b16 v[118:119], v12 offset:6144
    s_waitcnt lgkmcnt(10)
    v_mfma_f32_16x16x32_bf16 v[32:35], v[96:99], v[128:131], 0
    v_add_u32 v21, s40, v15
    v_add_u32 v25, s40, v16
    v_xor_b32 v22, 32, v21
    v_xor_b32 v23, 64, v21
    v_xor_b32 v24, 96, v21
    v_mfma_f32_16x16x32_bf16 v[36:39], v[96:99], v[136:139], 0
    ds_read_b64_tr_b16 v[120:121], v13 offset:4096
    ds_read_b64_tr_b16 v[122:123], v13 offset:6144
    v_mul_f32 v64, v64, v19
    v_mul_f32 v65, v65, v19
    v_mul_f32 v66, v66, v19
    v_mul_f32 v67, v67, v19
    v_cvt_pk_bf16_f32 v64, v64, v65
    s_waitcnt lgkmcnt(10)
    v_mfma_f32_16x16x32_bf16 v[40:43], v[100:103], v[128:131], 0
    v_cvt_pk_bf16_f32 v65, v66, v67
    ds_write_b64 v21, v[64:65] offset:0
    v_mul_f32 v68, v68, v20
    v_mul_f32 v69, v69, v20
    v_mul_f32 v70, v70, v20
    v_mfma_f32_16x16x32_bf16 v[44:47], v[100:103], v[136:139], 0
    ds_read_b64_tr_b16 v[124:125], v14 offset:4096
    ds_read_b64_tr_b16 v[126:127], v14 offset:6144
    v_mul_f32 v71, v71, v20
    v_cvt_pk_bf16_f32 v68, v68, v69
    v_cvt_pk_bf16_f32 v69, v70, v71
    ds_write_b64 v21, v[68:69] offset:2048
    v_mul_f32 v72, v72, v19
    s_waitcnt lgkmcnt(12)
    v_mfma_f32_16x16x32_bf16 v[48:51], v[104:107], v[128:131], 0
    v_mul_f32 v73, v73, v19
    v_mul_f32 v74, v74, v19
    v_mul_f32 v75, v75, v19
    v_cvt_pk_bf16_f32 v72, v72, v73
    v_cvt_pk_bf16_f32 v73, v74, v75
    v_mfma_f32_16x16x32_bf16 v[52:55], v[104:107], v[136:139], 0
    ds_read_b64_tr_b16 v[96:97], v11 offset:8192
    ds_read_b64_tr_b16 v[98:99], v11 offset:10240
    ds_write_b64 v22, v[72:73] offset:0
    v_mul_f32 v76, v76, v20
    v_mul_f32 v77, v77, v20
    v_mul_f32 v78, v78, v20
    v_mul_f32 v79, v79, v20
    s_waitcnt lgkmcnt(13)
    v_mfma_f32_16x16x32_bf16 v[56:59], v[108:111], v[128:131], 0
    v_cvt_pk_bf16_f32 v76, v76, v77
    v_cvt_pk_bf16_f32 v77, v78, v79
    ds_write_b64 v22, v[76:77] offset:2048
    v_mul_f32 v80, v80, v19
    v_mul_f32 v81, v81, v19
    v_mfma_f32_16x16x32_bf16 v[60:63], v[108:111], v[136:139], 0
    ds_read_b64_tr_b16 v[100:101], v12 offset:8192
    s_waitcnt lgkmcnt(14)
    ds_read_b64_tr_b16 v[102:103], v12 offset:10240
    v_mul_f32 v82, v82, v19
    v_mul_f32 v83, v83, v19
    v_cvt_pk_bf16_f32 v80, v80, v81
    v_cvt_pk_bf16_f32 v81, v82, v83
    s_waitcnt lgkmcnt(14)
    ds_write_b64 v23, v[80:81] offset:0
    v_mfma_f32_16x16x32_bf16 v[32:35], v[112:115], v[144:147], v[32:35]
    v_mul_f32 v84, v84, v20
    v_mul_f32 v85, v85, v20
    v_mul_f32 v86, v86, v20
    v_mul_f32 v87, v87, v20
    v_cvt_pk_bf16_f32 v84, v84, v85
    v_mfma_f32_16x16x32_bf16 v[36:39], v[112:115], v[152:155], v[36:39]
    s_waitcnt lgkmcnt(14)
    ds_read_b64_tr_b16 v[104:105], v13 offset:8192
    s_waitcnt lgkmcnt(14)
    ds_read_b64_tr_b16 v[106:107], v13 offset:10240
    v_cvt_pk_bf16_f32 v85, v86, v87
    s_waitcnt lgkmcnt(14)
    ds_write_b64 v23, v[84:85] offset:2048
    v_mul_f32 v88, v88, v19
    v_mul_f32 v89, v89, v19
    v_mul_f32 v90, v90, v19
    v_mfma_f32_16x16x32_bf16 v[40:43], v[116:119], v[144:147], v[40:43]
    v_mul_f32 v91, v91, v19
    v_cvt_pk_bf16_f32 v88, v88, v89
    v_cvt_pk_bf16_f32 v89, v90, v91
    s_waitcnt lgkmcnt(14)
    ds_write_b64 v24, v[88:89] offset:0
    v_mul_f32 v92, v92, v20
    v_mfma_f32_16x16x32_bf16 v[44:47], v[116:119], v[152:155], v[44:47]
    s_waitcnt lgkmcnt(14)
    ds_read_b64_tr_b16 v[108:109], v14 offset:8192
    s_waitcnt lgkmcnt(14)
    ds_read_b64_tr_b16 v[110:111], v14 offset:10240
    v_mul_f32 v93, v93, v20
    v_mul_f32 v94, v94, v20
    v_mul_f32 v95, v95, v20
    v_cvt_pk_bf16_f32 v92, v92, v93
    v_cvt_pk_bf16_f32 v93, v94, v95
    v_mfma_f32_16x16x32_bf16 v[48:51], v[120:123], v[144:147], v[48:51]
    s_waitcnt lgkmcnt(14)
    ds_write_b64 v24, v[92:93] offset:2048
    v_mfma_f32_16x16x32_bf16 v[52:55], v[120:123], v[152:155], v[52:55]
    s_waitcnt lgkmcnt(14)
    ds_read_b64_tr_b16 v[112:113], v11 offset:12288
    s_waitcnt lgkmcnt(14)
    ds_read_b64_tr_b16 v[114:115], v11 offset:14336
    s_waitcnt lgkmcnt(14)
    ds_read_b128 v[80:83], v25 offset:0
    s_waitcnt lgkmcnt(14)
    ds_read_b128 v[84:87], v25 offset:1024
    s_waitcnt lgkmcnt(14)
    ds_read_b128 v[88:91], v25 offset:2048
    s_waitcnt lgkmcnt(14)
    ds_read_b128 v[92:95], v25 offset:3072
    v_mfma_f32_16x16x32_bf16 v[56:59], v[124:127], v[144:147], v[56:59]
    v_mfma_f32_16x16x32_bf16 v[60:63], v[124:127], v[152:155], v[60:63]
    s_waitcnt lgkmcnt(14)
    ds_read_b64_tr_b16 v[116:117], v12 offset:12288
    s_waitcnt lgkmcnt(14)
    ds_read_b64_tr_b16 v[118:119], v12 offset:14336
    v_mfma_f32_16x16x32_bf16 v[32:35], v[96:99], v[160:163], v[32:35]
    s_waitcnt lgkmcnt(5)
    buffer_store_dwordx4 v[80:83], v1, s[24:27], s32 offen offset:128 sc1
    v_mfma_f32_16x16x32_bf16 v[36:39], v[96:99], v[168:171], v[36:39]
    ds_read_b64_tr_b16 v[120:121], v13 offset:12288
    ds_read_b64_tr_b16 v[122:123], v13 offset:14336
    v_mfma_f32_16x16x32_bf16 v[40:43], v[100:103], v[160:163], v[40:43]
    v_mfma_f32_16x16x32_bf16 v[44:47], v[100:103], v[168:171], v[44:47]
    ds_read_b64_tr_b16 v[124:125], v14 offset:12288
    ds_read_b64_tr_b16 v[126:127], v14 offset:14336
    v_mfma_f32_16x16x32_bf16 v[48:51], v[104:107], v[160:163], v[48:51]
    v_mfma_f32_16x16x32_bf16 v[52:55], v[104:107], v[168:171], v[52:55]
    ds_read_b64_tr_b16 v[96:97], v11 offset:16384
    ds_read_b64_tr_b16 v[98:99], v11 offset:18432
    v_mfma_f32_16x16x32_bf16 v[56:59], v[108:111], v[160:163], v[56:59]
    s_waitcnt lgkmcnt(10)
    buffer_store_dwordx4 v[84:87], v2, s[24:27], s32 offen offset:128 sc1
    v_mfma_f32_16x16x32_bf16 v[60:63], v[108:111], v[168:171], v[60:63]
    ds_read_b64_tr_b16 v[100:101], v12 offset:16384
    ds_read_b64_tr_b16 v[102:103], v12 offset:18432
    v_mfma_f32_16x16x32_bf16 v[32:35], v[112:115], v[176:179], v[32:35]
    v_mfma_f32_16x16x32_bf16 v[36:39], v[112:115], v[184:187], v[36:39]
    ds_read_b64_tr_b16 v[104:105], v13 offset:16384
    ds_read_b64_tr_b16 v[106:107], v13 offset:18432
    s_waitcnt lgkmcnt(10)
    v_mfma_f32_16x16x32_bf16 v[40:43], v[116:119], v[176:179], v[40:43]
    v_mfma_f32_16x16x32_bf16 v[44:47], v[116:119], v[184:187], v[44:47]
    ds_read_b64_tr_b16 v[108:109], v14 offset:16384
    ds_read_b64_tr_b16 v[110:111], v14 offset:18432
    s_waitcnt lgkmcnt(10)
    v_mfma_f32_16x16x32_bf16 v[48:51], v[120:123], v[176:179], v[48:51]
    buffer_store_dwordx4 v[88:91], v3, s[24:27], s32 offen offset:128 sc1
    v_mfma_f32_16x16x32_bf16 v[52:55], v[120:123], v[184:187], v[52:55]
    ds_read_b64_tr_b16 v[112:113], v11 offset:20480
    ds_read_b64_tr_b16 v[114:115], v11 offset:22528
    s_waitcnt lgkmcnt(10)
    v_mfma_f32_16x16x32_bf16 v[56:59], v[124:127], v[176:179], v[56:59]
    v_mfma_f32_16x16x32_bf16 v[60:63], v[124:127], v[184:187], v[60:63]
    ds_read_b64_tr_b16 v[116:117], v12 offset:20480
    ds_read_b64_tr_b16 v[118:119], v12 offset:22528
    s_waitcnt lgkmcnt(10)
    v_mfma_f32_16x16x32_bf16 v[32:35], v[96:99], v[192:195], v[32:35]
    v_mfma_f32_16x16x32_bf16 v[36:39], v[96:99], v[200:203], v[36:39]
    ds_read_b64_tr_b16 v[120:121], v13 offset:20480
    ds_read_b64_tr_b16 v[122:123], v13 offset:22528
    s_waitcnt lgkmcnt(10)
    v_mfma_f32_16x16x32_bf16 v[40:43], v[100:103], v[192:195], v[40:43]
    buffer_store_dwordx4 v[92:95], v4, s[24:27], s32 offen offset:128 sc1
    v_mfma_f32_16x16x32_bf16 v[44:47], v[100:103], v[200:203], v[44:47]
    ds_read_b64_tr_b16 v[124:125], v14 offset:20480
    ds_read_b64_tr_b16 v[126:127], v14 offset:22528
    s_waitcnt lgkmcnt(10)
    v_mfma_f32_16x16x32_bf16 v[48:51], v[104:107], v[192:195], v[48:51]
    v_mfma_f32_16x16x32_bf16 v[52:55], v[104:107], v[200:203], v[52:55]
    ds_read_b64_tr_b16 v[96:97], v11 offset:24576
    ds_read_b64_tr_b16 v[98:99], v11 offset:26624
    s_waitcnt lgkmcnt(10)
    v_mfma_f32_16x16x32_bf16 v[56:59], v[108:111], v[192:195], v[56:59]
    v_mfma_f32_16x16x32_bf16 v[60:63], v[108:111], v[200:203], v[60:63]
    ds_read_b64_tr_b16 v[100:101], v12 offset:24576
    ds_read_b64_tr_b16 v[102:103], v12 offset:26624
    s_waitcnt lgkmcnt(10)
    v_mfma_f32_16x16x32_bf16 v[32:35], v[112:115], v[208:211], v[32:35]
    v_mfma_f32_16x16x32_bf16 v[36:39], v[112:115], v[216:219], v[36:39]
    ds_read_b64_tr_b16 v[104:105], v13 offset:24576
    ds_read_b64_tr_b16 v[106:107], v13 offset:26624
    s_add_u32 s39, s33, 128
    s_mov_b32 m0, s40
    s_add_u32 s40, s40, 32768
    s_cmp_eq_u32 s40, s41
    s_cselect_b32 s40, s35, s40
    buffer_load_dwordx4 v1, s[16:19], s39 offen offset:0 nt lds
    s_add_u32 m0, m0, 1024
    s_waitcnt lgkmcnt(10)
    v_mfma_f32_16x16x32_bf16 v[40:43], v[116:119], v[208:211], v[40:43]
    v_mfma_f32_16x16x32_bf16 v[44:47], v[116:119], v[216:219], v[44:47]
    ds_read_b64_tr_b16 v[108:109], v14 offset:24576
    ds_read_b64_tr_b16 v[110:111], v14 offset:26624
    s_waitcnt lgkmcnt(10)
    v_mfma_f32_16x16x32_bf16 v[48:51], v[120:123], v[208:211], v[48:51]
    v_mfma_f32_16x16x32_bf16 v[52:55], v[120:123], v[216:219], v[52:55]
    ds_read_b64_tr_b16 v[112:113], v11 offset:28672
    ds_read_b64_tr_b16 v[114:115], v11 offset:30720
    s_waitcnt lgkmcnt(10)
    v_mfma_f32_16x16x32_bf16 v[56:59], v[124:127], v[208:211], v[56:59]
    v_mfma_f32_16x16x32_bf16 v[60:63], v[124:127], v[216:219], v[60:63]
    ds_read_b64_tr_b16 v[116:117], v12 offset:28672
    ds_read_b64_tr_b16 v[118:119], v12 offset:30720
    buffer_load_dwordx4 v2, s[16:19], s39 offen offset:0 nt lds
    s_add_u32 m0, m0, 1024
    s_waitcnt lgkmcnt(10)
    v_mfma_f32_16x16x32_bf16 v[32:35], v[96:99], v[224:227], v[32:35]
    v_mfma_f32_16x16x32_bf16 v[36:39], v[96:99], v[232:235], v[36:39]
    ds_read_b64_tr_b16 v[120:121], v13 offset:28672
    ds_read_b64_tr_b16 v[122:123], v13 offset:30720
    s_waitcnt lgkmcnt(10)
    v_mfma_f32_16x16x32_bf16 v[40:43], v[100:103], v[224:227], v[40:43]
    v_mfma_f32_16x16x32_bf16 v[44:47], v[100:103], v[232:235], v[44:47]
    ds_read_b64_tr_b16 v[124:125], v14 offset:28672
    ds_read_b64_tr_b16 v[126:127], v14 offset:30720
    s_waitcnt lgkmcnt(10)
    v_mfma_f32_16x16x32_bf16 v[48:51], v[104:107], v[224:227], v[48:51]
    v_mfma_f32_16x16x32_bf16 v[52:55], v[104:107], v[232:235], v[52:55]
    buffer_load_dwordx4 v3, s[16:19], s39 offen offset:0 nt lds
    s_add_u32 m0, m0, 1024
    s_waitcnt lgkmcnt(8)
    v_mfma_f32_16x16x32_bf16 v[56:59], v[108:111], v[224:227], v[56:59]
    v_mfma_f32_16x16x32_bf16 v[60:63], v[108:111], v[232:235], v[60:63]
    s_waitcnt lgkmcnt(6)
    v_mfma_f32_16x16x32_bf16 v[32:35], v[112:115], v[240:243], v[32:35]
    v_mfma_f32_16x16x32_bf16 v[36:39], v[112:115], v[248:251], v[36:39]
    s_waitcnt lgkmcnt(4)
    v_mfma_f32_16x16x32_bf16 v[40:43], v[116:119], v[240:243], v[40:43]
    v_mfma_f32_16x16x32_bf16 v[44:47], v[116:119], v[248:251], v[44:47]
    s_waitcnt lgkmcnt(2)
    v_mfma_f32_16x16x32_bf16 v[48:51], v[120:123], v[240:243], v[48:51]
    buffer_load_dwordx4 v4, s[16:19], s39 offen offset:0 nt lds
    v_mfma_f32_16x16x32_bf16 v[52:55], v[120:123], v[248:251], v[52:55]
    s_waitcnt lgkmcnt(0)
    v_mfma_f32_16x16x32_bf16 v[56:59], v[124:127], v[240:243], v[56:59]
    v_mfma_f32_16x16x32_bf16 v[60:63], v[124:127], v[248:251], v[60:63]
    s_add_u32 s28, s42, s35
    s_add_u32 s42, s42, 32768
    s_cmp_eq_u32 s42, 163840
    s_cselect_b32 s42, 0, s42
    v_add_u32 v13, s28, v5
    v_add_u32 v11, s42, v5
    v_add_u32 v14, s28, v6
    v_add_u32 v12, s42, v6
    s_add_u32 s42, s42, 32768
    s_cmp_eq_u32 s42, 163840
    s_cselect_b32 s42, 0, s42
    s_waitcnt vmcnt(16)
    s_barrier
    ds_read_b128 v[96:99], v13 offset:0
    ds_read_b128 v[64:67], v11 offset:0
    ds_read_b128 v[100:103], v13 offset:2048
    ds_read_b128 v[68:71], v11 offset:2048
    ds_read_b128 v[72:75], v11 offset:4096
    ds_read_b128 v[76:79], v11 offset:6144
    ds_read_b128 v[80:83], v11 offset:8192
    ds_read_b128 v[84:87], v11 offset:10240
    ds_read_b128 v[88:91], v11 offset:12288
    ds_read_b128 v[92:95], v11 offset:14336
    ds_read_b128 v[104:107], v14 offset:0
    s_mov_b32 s34, s32
    s_mov_b32 s32, s33
    s_add_u32 s36, s36, 1
L_head:
    s_add_u32 s3, s36, 1
    s_mul_i32 s31, s3, 33
    s_xor_b32 s31, s31, s30
    s_lshl_b32 s3, s3, 8
    s_add_u32 s31, s31, s3
    s_mul_i32 s33, s31, 98304
    s_waitcnt lgkmcnt(9)
    v_mfma_f32_16x16x32_bf16 v[128:131], v[64:67], v[96:99], 0
    v_add_u32 v21, s40, v15
    v_add_u32 v25, s40, v16
    v_xor_b32 v22, 32, v21
    v_xor_b32 v23, 64, v21
    v_xor_b32 v24, 96, v21
    s_waitcnt lgkmcnt(8)
    v_mfma_f32_16x16x32_bf16 v[136:139], v[64:67], v[100:103], 0
    ds_read_b128 v[112:115], v12 offset:0
    ds_read_b128 v[108:111], v14 offset:2048
    v_mul_f32 v32, v32, v19
    v_mul_f32 v33, v33, v19
    v_mul_f32 v34, v34, v19
    v_mul_f32 v35, v35, v19
    v_cvt_pk_bf16_f32 v32, v32, v33
    s_waitcnt lgkmcnt(9)
    v_mfma_f32_16x16x32_bf16 v[132:135], v[68:71], v[96:99], 0
    v_cvt_pk_bf16_f32 v33, v34, v35
    ds_write_b64 v21, v[32:33] offset:0
    v_mul_f32 v36, v36, v20
    v_mul_f32 v37, v37, v20
    v_mul_f32 v38, v38, v20
    v_mfma_f32_16x16x32_bf16 v[140:143], v[68:71], v[100:103], 0
    ds_read_b128 v[116:119], v12 offset:2048
    v_mul_f32 v39, v39, v20
    v_cvt_pk_bf16_f32 v36, v36, v37
    v_cvt_pk_bf16_f32 v37, v38, v39
    ds_write_b64 v21, v[36:37] offset:2048
    v_mul_f32 v40, v40, v19
    s_waitcnt lgkmcnt(11)
    v_mfma_f32_16x16x32_bf16 v[144:147], v[72:75], v[96:99], 0
    v_mul_f32 v41, v41, v19
    v_mul_f32 v42, v42, v19
    v_mul_f32 v43, v43, v19
    v_cvt_pk_bf16_f32 v40, v40, v41
    v_cvt_pk_bf16_f32 v41, v42, v43
    v_mfma_f32_16x16x32_bf16 v[152:155], v[72:75], v[100:103], 0
    ds_read_b128 v[120:123], v12 offset:4096
    ds_write_b64 v22, v[40:41] offset:0
    v_mul_f32 v44, v44, v20
    v_mul_f32 v45, v45, v20
    v_mul_f32 v46, v46, v20
    v_mul_f32 v47, v47, v20
    s_waitcnt lgkmcnt(12)
    v_mfma_f32_16x16x32_bf16 v[148:151], v[76:79], v[96:99], 0
    v_cvt_pk_bf16_f32 v44, v44, v45
    v_cvt_pk_bf16_f32 v45, v46, v47
    ds_write_b64 v22, v[44:45] offset:2048
    v_mul_f32 v48, v48, v19
    v_mul_f32 v49, v49, v19
    v_mfma_f32_16x16x32_bf16 v[156:159], v[76:79], v[100:103], 0
    ds_read_b128 v[124:127], v12 offset:6144
    v_mul_f32 v50, v50, v19
    v_mul_f32 v51, v51, v19
    v_cvt_pk_bf16_f32 v48, v48, v49
    v_cvt_pk_bf16_f32 v49, v50, v51
    ds_write_b64 v23, v[48:49] offset:0
    s_waitcnt lgkmcnt(14)
    v_mfma_f32_16x16x32_bf16 v[160:163], v[80:83], v[96:99], 0
    v_mul_f32 v52, v52, v20
    v_mul_f32 v53, v53, v20
    v_mul_f32 v54, v54, v20
    v_mul_f32 v55, v55, v20
    v_cvt_pk_bf16_f32 v52, v52, v53
    v_mfma_f32_16x16x32_bf16 v[168:171], v[80:83], v[100:103], 0
    ds_read_b128 v[64:67], v12 offset:8192
    v_cvt_pk_bf16_f32 v53, v54, v55
    s_waitcnt lgkmcnt(14)
    ds_write_b64 v23, v[52:53] offset:2048
    v_mul_f32 v56, v56, v19
    v_mul_f32 v57, v57, v19
    v_mul_f32 v58, v58, v19
    v_mfma_f32_16x16x32_bf16 v[164:167], v[84:87], v[96:99], 0
    v_mul_f32 v59, v59, v19
    v_cvt_pk_bf16_f32 v56, v56, v57
    v_cvt_pk_bf16_f32 v57, v58, v59
    s_waitcnt lgkmcnt(14)
    ds_write_b64 v24, v[56:57] offset:0
    v_mul_f32 v60, v60, v20
    v_mfma_f32_16x16x32_bf16 v[172:175], v[84:87], v[100:103], 0
    s_waitcnt lgkmcnt(14)
    ds_read_b128 v[68:71], v12 offset:10240
    v_mul_f32 v61, v61, v20
    v_mul_f32 v62, v62, v20
    v_mul_f32 v63, v63, v20
    v_cvt_pk_bf16_f32 v60, v60, v61
    v_cvt_pk_bf16_f32 v61, v62, v63
    v_mfma_f32_16x16x32_bf16 v[176:179], v[88:91], v[96:99], 0
    s_waitcnt lgkmcnt(14)
    ds_write_b64 v24, v[60:61] offset:2048
    v_mfma_f32_16x16x32_bf16 v[184:187], v[88:91], v[100:103], 0
    s_waitcnt lgkmcnt(14)
    ds_read_b128 v[72:75], v12 offset:12288
    s_waitcnt lgkmcnt(14)
    ds_read_b128 v[48:51], v25 offset:0
    s_waitcnt lgkmcnt(14)
    ds_read_b128 v[52:55], v25 offset:1024
    s_waitcnt lgkmcnt(14)
    ds_read_b128 v[56:59], v25 offset:2048
    s_waitcnt lgkmcnt(14)
    ds_read_b128 v[60:63], v25 offset:3072
    v_mfma_f32_16x16x32_bf16 v[180:183], v[92:95], v[96:99], 0
    v_mfma_f32_16x16x32_bf16 v[188:191], v[92:95], v[100:103], 0
    s_waitcnt lgkmcnt(14)
    ds_read_b128 v[76:79], v12 offset:14336
    v_mfma_f32_16x16x32_bf16 v[128:131], v[112:115], v[104:107], v[128:131]
    s_waitcnt lgkmcnt(1)
    s_add_u32 s39, s32, 256
    s_mov_b32 m0, s40
    s_add_u32 s40, s40, 32768
    s_cmp_eq_u32 s40, s41
    s_cselect_b32 s40, s35, s40
    buffer_load_dwordx4 v1, s[12:15], s39 offen offset:0 nt lds
    s_add_u32 m0, m0, 1024
    v_mfma_f32_16x16x32_bf16 v[136:139], v[112:115], v[108:111], v[136:139]
    ds_read_b128 v[80:83], v11 offset:16384
    v_mfma_f32_16x16x32_bf16 v[132:135], v[116:119], v[104:107], v[132:135]
    v_mfma_f32_16x16x32_bf16 v[140:143], v[116:119], v[108:111], v[140:143]
    ds_read_b128 v[84:87], v11 offset:18432
    v_mfma_f32_16x16x32_bf16 v[144:147], v[120:123], v[104:107], v[144:147]
    v_mfma_f32_16x16x32_bf16 v[152:155], v[120:123], v[108:111], v[152:155]
    ds_read_b128 v[88:91], v11 offset:20480
    v_mfma_f32_16x16x32_bf16 v[148:151], v[124:127], v[104:107], v[148:151]
    buffer_load_dwordx4 v2, s[12:15], s39 offen offset:0 nt lds
    s_add_u32 m0, m0, 1024
    v_mfma_f32_16x16x32_bf16 v[156:159], v[124:127], v[108:111], v[156:159]
    ds_read_b128 v[92:95], v11 offset:22528
    v_mfma_f32_16x16x32_bf16 v[160:163], v[64:67], v[104:107], v[160:163]
    v_mfma_f32_16x16x32_bf16 v[168:171], v[64:67], v[108:111], v[168:171]
    ds_read_b128 v[112:115], v11 offset:24576
    v_mfma_f32_16x16x32_bf16 v[164:167], v[68:71], v[104:107], v[164:167]
    v_mfma_f32_16x16x32_bf16 v[172:175], v[68:71], v[108:111], v[172:175]
    ds_read_b128 v[116:119], v11 offset:26624
    v_mfma_f32_16x16x32_bf16 v[176:179], v[72:75], v[104:107], v[176:179]
    buffer_load_dwordx4 v3, s[12:15], s39 offen offset:0 nt lds
    s_add_u32 m0, m0, 1024
    v_mfma_f32_16x16x32_bf16 v[184:187], v[72:75], v[108:111], v[184:187]
    ds_read_b128 v[120:123], v11 offset:28672
    s_waitcnt lgkmcnt(7)
    v_mfma_f32_16x16x32_bf16 v[180:183], v[76:79], v[104:107], v[180:183]
    v_mfma_f32_16x16x32_bf16 v[188:191], v[76:79], v[108:111], v[188:191]
    ds_read_b128 v[124:127], v11 offset:30720
    s_waitcnt lgkmcnt(7)
    v_mfma_f32_16x16x32_bf16 v[192:195], v[80:83], v[96:99], 0
    v_mfma_f32_16x16x32_bf16 v[200:203], v[80:83], v[100:103], 0
    ds_read_b128 v[64:67], v12 offset:16384
    s_waitcnt lgkmcnt(7)
    v_mfma_f32_16x16x32_bf16 v[196:199], v[84:87], v[96:99], 0
    buffer_load_dwordx4 v4, s[12:15], s39 offen offset:0 nt lds
    v_mfma_f32_16x16x32_bf16 v[204:207], v[84:87], v[100:103], 0
    ds_read_b128 v[68:71], v12 offset:18432
    s_waitcnt lgkmcnt(7)
    v_mfma_f32_16x16x32_bf16 v[208:211], v[88:91], v[96:99], 0
    v_mfma_f32_16x16x32_bf16 v[216:219], v[88:91], v[100:103], 0
    ds_read_b128 v[72:75], v12 offset:20480
    s_waitcnt lgkmcnt(7)
    v_mfma_f32_16x16x32_bf16 v[212:215], v[92:95], v[96:99], 0
    v_mfma_f32_16x16x32_bf16 v[220:223], v[92:95], v[100:103], 0
    ds_read_b128 v[76:79], v12 offset:22528
    s_waitcnt lgkmcnt(7)
    v_mfma_f32_16x16x32_bf16 v[224:227], v[112:115], v[96:99], 0
    v_mfma_f32_16x16x32_bf16 v[232:235], v[112:115], v[100:103], 0
    ds_read_b128 v[80:83], v12 offset:24576
    s_add_u32 s39, s32, 256
    s_mov_b32 m0, s40
    s_add_u32 s40, s40, 32768
    s_cmp_eq_u32 s40, s41
    s_cselect_b32 s40, s35, s40
    buffer_load_dwordx4 v1, s[16:19], s39 offen offset:0 nt lds
    s_add_u32 m0, m0, 1024
    s_waitcnt lgkmcnt(7)
    v_mfma_f32_16x16x32_bf16 v[228:231], v[116:119], v[96:99], 0
    v_mfma_f32_16x16x32_bf16 v[236:239], v[116:119], v[100:103], 0
    ds_read_b128 v[84:87], v12 offset:26624
    s_waitcnt lgkmcnt(7)
    v_mfma_f32_16x16x32_bf16 v[240:243], v[120:123], v[96:99], 0
    v_mfma_f32_16x16x32_bf16 v[248:251], v[120:123], v[100:103], 0
    ds_read_b128 v[88:91], v12 offset:28672
    s_waitcnt lgkmcnt(7)
    v_mfma_f32_16x16x32_bf16 v[244:247], v[124:127], v[96:99], 0
    v_mfma_f32_16x16x32_bf16 v[252:255], v[124:127], v[100:103], 0
    ds_read_b128 v[92:95], v12 offset:30720
    buffer_load_dwordx4 v2, s[16:19], s39 offen offset:0 nt lds
    s_add_u32 m0, m0, 1024
    s_waitcnt lgkmcnt(7)
    v_mfma_f32_16x16x32_bf16 v[192:195], v[64:67], v[104:107], v[192:195]
    v_mfma_f32_16x16x32_bf16 v[200:203], v[64:67], v[108:111], v[200:203]
    s_waitcnt lgkmcnt(6)
    v_mfma_f32_16x16x32_bf16 v[196:199], v[68:71], v[104:107], v[196:199]
    v_mfma_f32_16x16x32_bf16 v[204:207], v[68:71], v[108:111], v[204:207]
    s_waitcnt lgkmcnt(5)
    v_mfma_f32_16x16x32_bf16 v[208:211], v[72:75], v[104:107], v[208:211]
    v_mfma_f32_16x16x32_bf16 v[216:219], v[72:75], v[108:111], v[216:219]
    buffer_load_dwordx4 v3, s[16:19], s39 offen offset:0 nt lds
    s_add_u32 m0, m0, 1024
    s_waitcnt lgkmcnt(4)
    v_mfma_f32_16x16x32_bf16 v[212:215], v[76:79], v[104:107], v[212:215]
    v_mfma_f32_16x16x32_bf16 v[220:223], v[76:79], v[108:111], v[220:223]
    s_waitcnt lgkmcnt(3)
    v_mfma_f32_16x16x32_bf16 v[224:227], v[80:83], v[104:107], v[224:227]
    v_mfma_f32_16x16x32_bf16 v[232:235], v[80:83], v[108:111], v[232:235]
    s_waitcnt lgkmcnt(2)
    v_mfma_f32_16x16x32_bf16 v[228:231], v[84:87], v[104:107], v[228:231]
    v_mfma_f32_16x16x32_bf16 v[236:239], v[84:87], v[108:111], v[236:239]
    s_waitcnt lgkmcnt(1)
    v_mfma_f32_16x16x32_bf16 v[240:243], v[88:91], v[104:107], v[240:243]
    buffer_load_dwordx4 v4, s[16:19], s39 offen offset:0 nt lds
    v_mfma_f32_16x16x32_bf16 v[248:251], v[88:91], v[108:111], v[248:251]
    s_waitcnt lgkmcnt(0)
    v_mfma_f32_16x16x32_bf16 v[244:247], v[92:95], v[104:107], v[244:247]
    v_mfma_f32_16x16x32_bf16 v[252:255], v[92:95], v[108:111], v[252:255]
    s_add_u32 s28, s42, s35
    s_add_u32 s42, s42, 32768
    s_cmp_eq_u32 s42, 163840
    s_cselect_b32 s42, 0, s42
    v_add_u32 v13, s28, v5
    v_add_u32 v11, s42, v5
    v_add_u32 v14, s28, v6
    v_add_u32 v12, s42, v6
    s_add_u32 s42, s42, 32768
    s_cmp_eq_u32 s42, 163840
    s_cselect_b32 s42, 0, s42
    s_waitcnt vmcnt(8)
    s_barrier
    ds_read_b128 v[96:99], v13 offset:0
    ds_read_b128 v[112:115], v11 offset:0
    ds_read_b128 v[100:103], v13 offset:2048
    ds_read_b128 v[116:119], v11 offset:2048
    ds_read_b128 v[120:123], v11 offset:4096
    ds_read_b128 v[124:127], v11 offset:6144
    ds_read_b128 v[64:67], v11 offset:8192
    ds_read_b128 v[68:71], v11 offset:10240
    ds_read_b128 v[72:75], v11 offset:12288
    ds_read_b128 v[76:79], v11 offset:14336
    ds_read_b128 v[104:107], v14 offset:0
    s_waitcnt lgkmcnt(9)
    v_mfma_f32_16x16x32_bf16 v[128:131], v[112:115], v[96:99], v[128:131]
    s_waitcnt lgkmcnt(8)
    v_mfma_f32_16x16x32_bf16 v[136:139], v[112:115], v[100:103], v[136:139]
    ds_read_b128 v[80:83], v12 offset:0
    ds_read_b128 v[108:111], v14 offset:2048
    buffer_store_dwordx4 v[48:51], v1, s[24:27], s34 offen offset:256 sc1
    s_waitcnt lgkmcnt(9)
    v_mfma_f32_16x16x32_bf16 v[132:135], v[116:119], v[96:99], v[132:135]
    v_mfma_f32_16x16x32_bf16 v[140:143], v[116:119], v[100:103], v[140:143]
    ds_read_b128 v[84:87], v12 offset:2048
    s_waitcnt lgkmcnt(9)
    v_mfma_f32_16x16x32_bf16 v[144:147], v[120:123], v[96:99], v[144:147]
    v_mfma_f32_16x16x32_bf16 v[152:155], v[120:123], v[100:103], v[152:155]
    ds_read_b128 v[88:91], v12 offset:4096
    s_waitcnt lgkmcnt(9)
    v_mfma_f32_16x16x32_bf16 v[148:151], v[124:127], v[96:99], v[148:151]
    v_mfma_f32_16x16x32_bf16 v[156:159], v[124:127], v[100:103], v[156:159]
    ds_read_b128 v[92:95], v12 offset:6144
    s_waitcnt lgkmcnt(9)
    v_mfma_f32_16x16x32_bf16 v[160:163], v[64:67], v[96:99], v[160:163]
    v_mfma_f32_16x16x32_bf16 v[168:171], v[64:67], v[100:103], v[168:171]
    ds_read_b128 v[112:115], v12 offset:8192
    buffer_store_dwordx4 v[52:55], v2, s[24:27], s34 offen offset:256 sc1
    s_waitcnt lgkmcnt(9)
    v_mfma_f32_16x16x32_bf16 v[164:167], v[68:71], v[96:99], v[164:167]
    v_mfma_f32_16x16x32_bf16 v[172:175], v[68:71], v[100:103], v[172:175]
    ds_read_b128 v[116:119], v12 offset:10240
    s_waitcnt lgkmcnt(9)
    v_mfma_f32_16x16x32_bf16 v[176:179], v[72:75], v[96:99], v[176:179]
    v_mfma_f32_16x16x32_bf16 v[184:187], v[72:75], v[100:103], v[184:187]
    ds_read_b128 v[120:123], v12 offset:12288
    s_waitcnt lgkmcnt(9)
    v_mfma_f32_16x16x32_bf16 v[180:183], v[76:79], v[96:99], v[180:183]
    v_mfma_f32_16x16x32_bf16 v[188:191], v[76:79], v[100:103], v[188:191]
    ds_read_b128 v[124:127], v12 offset:14336
    s_waitcnt lgkmcnt(8)
    v_mfma_f32_16x16x32_bf16 v[128:131], v[80:83], v[104:107], v[128:131]
    s_waitcnt lgkmcnt(7)
    v_mfma_f32_16x16x32_bf16 v[136:139], v[80:83], v[108:111], v[136:139]
    ds_read_b128 v[64:67], v11 offset:16384
    buffer_store_dwordx4 v[56:59], v3, s[24:27], s34 offen offset:256 sc1
    s_waitcnt lgkmcnt(7)
    v_mfma_f32_16x16x32_bf16 v[132:135], v[84:87], v[104:107], v[132:135]
    v_mfma_f32_16x16x32_bf16 v[140:143], v[84:87], v[108:111], v[140:143]
    ds_read_b128 v[68:71], v11 offset:18432
    s_waitcnt lgkmcnt(7)
    v_mfma_f32_16x16x32_bf16 v[144:147], v[88:91], v[104:107], v[144:147]
    v_mfma_f32_16x16x32_bf16 v[152:155], v[88:91], v[108:111], v[152:155]
    ds_read_b128 v[72:75], v11 offset:20480
    s_waitcnt lgkmcnt(7)
    v_mfma_f32_16x16x32_bf16 v[148:151], v[92:95], v[104:107], v[148:151]
    v_mfma_f32_16x16x32_bf16 v[156:159], v[92:95], v[108:111], v[156:159]
    ds_read_b128 v[76:79], v11 offset:22528
    s_waitcnt lgkmcnt(7)
    v_mfma_f32_16x16x32_bf16 v[160:163], v[112:115], v[104:107], v[160:163]
    v_mfma_f32_16x16x32_bf16 v[168:171], v[112:115], v[108:111], v[168:171]
    ds_read_b128 v[80:83], v11 offset:24576
    s_waitcnt lgkmcnt(7)
    v_mfma_f32_16x16x32_bf16 v[164:167], v[116:119], v[104:107], v[164:167]
    buffer_store_dwordx4 v[60:63], v4, s[24:27], s34 offen offset:256 sc1
    v_mfma_f32_16x16x32_bf16 v[172:175], v[116:119], v[108:111], v[172:175]
    ds_read_b128 v[84:87], v11 offset:26624
    s_waitcnt lgkmcnt(7)
    v_mfma_f32_16x16x32_bf16 v[176:179], v[120:123], v[104:107], v[176:179]
    v_mfma_f32_16x16x32_bf16 v[184:187], v[120:123], v[108:111], v[184:187]
    ds_read_b128 v[88:91], v11 offset:28672
    s_waitcnt lgkmcnt(7)
    v_mfma_f32_16x16x32_bf16 v[180:183], v[124:127], v[104:107], v[180:183]
    v_mfma_f32_16x16x32_bf16 v[188:191], v[124:127], v[108:111], v[188:191]
    ds_read_b128 v[92:95], v11 offset:30720
    s_waitcnt lgkmcnt(7)
    v_mfma_f32_16x16x32_bf16 v[192:195], v[64:67], v[96:99], v[192:195]
    v_mfma_f32_16x16x32_bf16 v[200:203], v[64:67], v[100:103], v[200:203]
    ds_read_b128 v[112:115], v12 offset:16384
    s_waitcnt lgkmcnt(7)
    v_mfma_f32_16x16x32_bf16 v[196:199], v[68:71], v[96:99], v[196:199]
    s_mov_b32 m0, s40
    s_add_u32 s40, s40, 32768
    s_cmp_eq_u32 s40, s41
    s_cselect_b32 s40, s35, s40
    buffer_load_dwordx4 v1, s[20:23], s32 offen offset:0 nt lds
    s_add_u32 m0, m0, 1024
    v_mfma_f32_16x16x32_bf16 v[204:207], v[68:71], v[100:103], v[204:207]
    ds_read_b128 v[116:119], v12 offset:18432
    s_waitcnt lgkmcnt(7)
    v_mfma_f32_16x16x32_bf16 v[208:211], v[72:75], v[96:99], v[208:211]
    v_mfma_f32_16x16x32_bf16 v[216:219], v[72:75], v[100:103], v[216:219]
    ds_read_b128 v[120:123], v12 offset:20480
    s_waitcnt lgkmcnt(7)
    v_mfma_f32_16x16x32_bf16 v[212:215], v[76:79], v[96:99], v[212:215]
    v_mfma_f32_16x16x32_bf16 v[220:223], v[76:79], v[100:103], v[220:223]
    ds_read_b128 v[124:127], v12 offset:22528
    s_waitcnt lgkmcnt(7)
    v_mfma_f32_16x16x32_bf16 v[224:227], v[80:83], v[96:99], v[224:227]
    v_mfma_f32_16x16x32_bf16 v[232:235], v[80:83], v[100:103], v[232:235]
    ds_read_b128 v[64:67], v12 offset:24576
    s_waitcnt lgkmcnt(7)
    v_mfma_f32_16x16x32_bf16 v[228:231], v[84:87], v[96:99], v[228:231]
    v_mfma_f32_16x16x32_bf16 v[236:239], v[84:87], v[100:103], v[236:239]
    ds_read_b128 v[68:71], v12 offset:26624
    buffer_load_dwordx4 v2, s[20:23], s32 offen offset:0 nt lds
    s_add_u32 m0, m0, 1024
    s_waitcnt lgkmcnt(7)
    v_mfma_f32_16x16x32_bf16 v[240:243], v[88:91], v[96:99], v[240:243]
    v_mfma_f32_16x16x32_bf16 v[248:251], v[88:91], v[100:103], v[248:251]
    ds_read_b128 v[72:75], v12 offset:28672
    s_waitcnt lgkmcnt(7)
    v_mfma_f32_16x16x32_bf16 v[244:247], v[92:95], v[96:99], v[244:247]
    v_mfma_f32_16x16x32_bf16 v[252:255], v[92:95], v[100:103], v[252:255]
    ds_read_b128 v[76:79], v12 offset:30720
    s_waitcnt lgkmcnt(7)
    v_mfma_f32_16x16x32_bf16 v[192:195], v[112:115], v[104:107], v[192:195]
    v_mfma_f32_16x16x32_bf16 v[200:203], v[112:115], v[108:111], v[200:203]
    s_waitcnt lgkmcnt(6)
    v_mfma_f32_16x16x32_bf16 v[196:199], v[116:119], v[104:107], v[196:199]
    v_mfma_f32_16x16x32_bf16 v[204:207], v[116:119], v[108:111], v[204:207]
    buffer_load_dwordx4 v3, s[20:23], s32 offen offset:0 nt lds
    s_add_u32 m0, m0, 1024
    s_waitcnt lgkmcnt(5)
    v_mfma_f32_16x16x32_bf16 v[208:211], v[120:123], v[104:107], v[208:211]
    v_mfma_f32_16x16x32_bf16 v[216:219], v[120:123], v[108:111], v[216:219]
    s_waitcnt lgkmcnt(4)
    v_mfma_f32_16x16x32_bf16 v[212:215], v[124:127], v[104:107], v[212:215]
    v_mfma_f32_16x16x32_bf16 v[220:223], v[124:127], v[108:111], v[220:223]
    s_waitcnt lgkmcnt(3)
    v_mfma_f32_16x16x32_bf16 v[224:227], v[64:67], v[104:107], v[224:227]
    v_mfma_f32_16x16x32_bf16 v[232:235], v[64:67], v[108:111], v[232:235]
    s_waitcnt lgkmcnt(2)
    v_mfma_f32_16x16x32_bf16 v[228:231], v[68:71], v[104:107], v[228:231]
    v_mfma_f32_16x16x32_bf16 v[236:239], v[68:71], v[108:111], v[236:239]
    s_waitcnt lgkmcnt(1)
    v_mfma_f32_16x16x32_bf16 v[240:243], v[72:75], v[104:107], v[240:243]
    buffer_load_dwordx4 v4, s[20:23], s32 offen offset:0 nt lds
    v_mfma_f32_16x16x32_bf16 v[248:251], v[72:75], v[108:111], v[248:251]
    s_waitcnt lgkmcnt(0)
    v_mfma_f32_16x16x32_bf16 v[244:247], v[76:79], v[104:107], v[244:247]
    v_mfma_f32_16x16x32_bf16 v[252:255], v[76:79], v[108:111], v[252:255]
    s_add_u32 s28, s42, s35
    s_add_u32 s42, s42, 32768
    s_cmp_eq_u32 s42, 163840
    s_cselect_b32 s42, 0, s42
    v_add_u32 v13, s28, v5
    v_add_u32 v11, s42, v5
    v_add_u32 v14, s28, v6
    v_add_u32 v12, s42, v6
    s_add_u32 s42, s42, 32768
    s_cmp_eq_u32 s42, 163840
    s_cselect_b32 s42, 0, s42
    s_waitcnt vmcnt(8)
    s_barrier
    ds_read_b128 v[96:99], v13 offset:0
    ds_read_b128 v[80:83], v11 offset:0
    ds_read_b128 v[100:103], v13 offset:2048
    ds_read_b128 v[84:87], v11 offset:2048
    ds_read_b128 v[88:91], v11 offset:4096
    ds_read_b128 v[92:95], v11 offset:6144
    ds_read_b128 v[112:115], v11 offset:8192
    ds_read_b128 v[116:119], v11 offset:10240
    ds_read_b128 v[120:123], v11 offset:12288
    ds_read_b128 v[124:127], v11 offset:14336
    ds_read_b128 v[104:107], v14 offset:0
    s_waitcnt lgkmcnt(9)
    v_mfma_f32_16x16x32_bf16 v[128:131], v[80:83], v[96:99], v[128:131]
    s_waitcnt lgkmcnt(8)
    v_mfma_f32_16x16x32_bf16 v[136:139], v[80:83], v[100:103], v[136:139]
    ds_read_b128 v[64:67], v12 offset:0
    ds_read_b128 v[108:111], v14 offset:2048
    s_add_u32 s39, s32, 128
    s_mov_b32 m0, s40
    s_add_u32 s40, s40, 32768
    s_cmp_eq_u32 s40, s41
    s_cselect_b32 s40, s35, s40
    buffer_load_dwordx4 v1, s[20:23], s39 offen offset:0 nt lds
    s_add_u32 m0, m0, 1024
    s_waitcnt lgkmcnt(9)
    v_mfma_f32_16x16x32_bf16 v[132:135], v[84:87], v[96:99], v[132:135]
    v_mfma_f32_16x16x32_bf16 v[140:143], v[84:87], v[100:103], v[140:143]
    ds_read_b128 v[68:71], v12 offset:2048
    s_waitcnt lgkmcnt(9)
    v_mfma_f32_16x16x32_bf16 v[144:147], v[88:91], v[96:99], v[144:147]
    v_mfma_f32_16x16x32_bf16 v[152:155], v[88:91], v[100:103], v[152:155]
    ds_read_b128 v[72:75], v12 offset:4096
    s_waitcnt lgkmcnt(9)
    v_mfma_f32_16x16x32_bf16 v[148:151], v[92:95], v[96:99], v[148:151]
    v_mfma_f32_16x16x32_bf16 v[156:159], v[92:95], v[100:103], v[156:159]
    ds_read_b128 v[76:79], v12 offset:6144
    s_waitcnt lgkmcnt(9)
    v_mfma_f32_16x16x32_bf16 v[160:163], v[112:115], v[96:99], v[160:163]
    v_mfma_f32_16x16x32_bf16 v[168:171], v[112:115], v[100:103], v[168:171]
    ds_read_b128 v[80:83], v12 offset:8192
    s_waitcnt lgkmcnt(9)
    v_mfma_f32_16x16x32_bf16 v[164:167], v[116:119], v[96:99], v[164:167]
    v_mfma_f32_16x16x32_bf16 v[172:175], v[116:119], v[100:103], v[172:175]
    ds_read_b128 v[84:87], v12 offset:10240
    s_waitcnt lgkmcnt(9)
    v_mfma_f32_16x16x32_bf16 v[176:179], v[120:123], v[96:99], v[176:179]
    v_mfma_f32_16x16x32_bf16 v[184:187], v[120:123], v[100:103], v[184:187]
    ds_read_b128 v[88:91], v12 offset:12288
    s_waitcnt lgkmcnt(9)
    v_mfma_f32_16x16x32_bf16 v[180:183], v[124:127], v[96:99], v[180:183]
    v_mfma_f32_16x16x32_bf16 v[188:191], v[124:127], v[100:103], v[188:191]
    ds_read_b128 v[92:95], v12 offset:14336
    s_waitcnt lgkmcnt(8)
    v_mfma_f32_16x16x32_bf16 v[128:131], v[64:67], v[104:107], v[128:131]
    buffer_load_dwordx4 v2, s[20:23], s39 offen offset:0 nt lds
    s_add_u32 m0, m0, 1024
    s_waitcnt lgkmcnt(7)
    v_mfma_f32_16x16x32_bf16 v[136:139], v[64:67], v[108:111], v[136:139]
    ds_read_b128 v[112:115], v11 offset:16384
    s_waitcnt lgkmcnt(7)
    v_mfma_f32_16x16x32_bf16 v[132:135], v[68:71], v[104:107], v[132:135]
    v_mfma_f32_16x16x32_bf16 v[140:143], v[68:71], v[108:111], v[140:143]
    ds_read_b128 v[116:119], v12 offset:16384
    s_waitcnt lgkmcnt(7)
    v_mfma_f32_16x16x32_bf16 v[144:147], v[72:75], v[104:107], v[144:147]
    v_max_f32 v17, v128, v129
    v_mfma_f32_16x16x32_bf16 v[152:155], v[72:75], v[108:111], v[152:155]
    ds_read_b128 v[120:123], v11 offset:18432
    v_max3_f32 v17, v17, v130, v131
    s_waitcnt lgkmcnt(7)
    v_mfma_f32_16x16x32_bf16 v[148:151], v[76:79], v[104:107], v[148:151]
    v_max_f32 v18, v136, v137
    v_mfma_f32_16x16x32_bf16 v[156:159], v[76:79], v[108:111], v[156:159]
    ds_read_b128 v[124:127], v12 offset:18432
    v_max3_f32 v18, v18, v138, v139
    s_waitcnt lgkmcnt(7)
    v_mfma_f32_16x16x32_bf16 v[160:163], v[80:83], v[104:107], v[160:163]
    v_max3_f32 v17, v17, v132, v133
    v_mfma_f32_16x16x32_bf16 v[168:171], v[80:83], v[108:111], v[168:171]
    ds_read_b128 v[64:67], v11 offset:20480
    v_max3_f32 v17, v17, v134, v135
    s_waitcnt lgkmcnt(7)
    v_mfma_f32_16x16x32_bf16 v[164:167], v[84:87], v[104:107], v[164:167]
    v_max3_f32 v18, v18, v140, v141
    v_mfma_f32_16x16x32_bf16 v[172:175], v[84:87], v[108:111], v[172:175]
    ds_read_b128 v[68:71], v12 offset:20480
    v_max3_f32 v18, v18, v142, v143
    s_waitcnt lgkmcnt(7)
    v_mfma_f32_16x16x32_bf16 v[176:179], v[88:91], v[104:107], v[176:179]
    v_max3_f32 v17, v17, v144, v145
    v_mfma_f32_16x16x32_bf16 v[184:187], v[88:91], v[108:111], v[184:187]
    ds_read_b128 v[72:75], v11 offset:22528
    v_max3_f32 v17, v17, v146, v147
    s_waitcnt lgkmcnt(7)
    v_mfma_f32_16x16x32_bf16 v[180:183], v[92:95], v[104:107], v[180:183]
    v_max3_f32 v18, v18, v152, v153
    v_mfma_f32_16x16x32_bf16 v[188:191], v[92:95], v[108:111], v[188:191]
    ds_read_b128 v[76:79], v12 offset:22528
    v_max3_f32 v18, v18, v154, v155
    s_waitcnt lgkmcnt(7)
    v_mfma_f32_16x16x32_bf16 v[192:195], v[112:115], v[96:99], v[192:195]
    v_max3_f32 v17, v17, v148, v149
    buffer_load_dwordx4 v3, s[20:23], s39 offen offset:0 nt lds
    s_add_u32 m0, m0, 1024
    v_mfma_f32_16x16x32_bf16 v[200:203], v[112:115], v[100:103], v[200:203]
    ds_read_b128 v[80:83], v11 offset:24576
    v_max3_f32 v17, v17, v150, v151
    s_waitcnt lgkmcnt(7)
    v_mfma_f32_16x16x32_bf16 v[192:195], v[116:119], v[104:107], v[192:195]
    v_max3_f32 v18, v18, v156, v157
    v_mfma_f32_16x16x32_bf16 v[200:203], v[116:119], v[108:111], v[200:203]
    ds_read_b128 v[84:87], v12 offset:24576
    v_max3_f32 v18, v18, v158, v159
    s_waitcnt lgkmcnt(7)
    v_mfma_f32_16x16x32_bf16 v[196:199], v[120:123], v[96:99], v[196:199]
    v_max3_f32 v17, v17, v160, v161
    v_mfma_f32_16x16x32_bf16 v[204:207], v[120:123], v[100:103], v[204:207]
    ds_read_b128 v[88:91], v11 offset:26624
    v_max3_f32 v17, v17, v162, v163
    s_waitcnt lgkmcnt(7)
    v_mfma_f32_16x16x32_bf16 v[196:199], v[124:127], v[104:107], v[196:199]
    v_max3_f32 v18, v18, v168, v169
    v_mfma_f32_16x16x32_bf16 v[204:207], v[124:127], v[108:111], v[204:207]
    ds_read_b128 v[92:95], v12 offset:26624
    v_max3_f32 v18, v18, v170, v171
    v_max3_f32 v17, v17, v164, v165
    s_waitcnt lgkmcnt(7)
    v_mfma_f32_16x16x32_bf16 v[208:211], v[64:67], v[96:99], v[208:211]
    v_max3_f32 v17, v17, v166, v167
    v_mfma_f32_16x16x32_bf16 v[216:219], v[64:67], v[100:103], v[216:219]
    ds_read_b128 v[112:115], v11 offset:28672
    v_max3_f32 v18, v18, v172, v173
    s_waitcnt lgkmcnt(7)
    v_mfma_f32_16x16x32_bf16 v[208:211], v[68:71], v[104:107], v[208:211]
    v_max3_f32 v18, v18, v174, v175
    v_max3_f32 v17, v17, v176, v177
    v_mfma_f32_16x16x32_bf16 v[216:219], v[68:71], v[108:111], v[216:219]
    ds_read_b128 v[116:119], v12 offset:28672
    v_max3_f32 v17, v17, v178, v179
    v_max3_f32 v18, v18, v184, v185
    s_waitcnt lgkmcnt(7)
    v_mfma_f32_16x16x32_bf16 v[212:215], v[72:75], v[96:99], v[212:215]
    v_max3_f32 v18, v18, v186, v187
    v_mfma_f32_16x16x32_bf16 v[220:223], v[72:75], v[100:103], v[220:223]
    ds_read_b128 v[120:123], v11 offset:30720
    v_max3_f32 v17, v17, v180, v181
    s_waitcnt lgkmcnt(7)
    v_mfma_f32_16x16x32_bf16 v[212:215], v[76:79], v[104:107], v[212:215]
    v_max3_f32 v17, v17, v182, v183
    v_max3_f32 v18, v18, v188, v189
    v_mfma_f32_16x16x32_bf16 v[220:223], v[76:79], v[108:111], v[220:223]
    ds_read_b128 v[124:127], v12 offset:30720
    v_max3_f32 v18, v18, v190, v191
    v_max3_f32 v17, v17, v192, v193
    s_waitcnt lgkmcnt(7)
    v_mfma_f32_16x16x32_bf16 v[224:227], v[80:83], v[96:99], v[224:227]
    v_max3_f32 v17, v17, v194, v195
    v_max3_f32 v18, v18, v200, v201
    buffer_load_dwordx4 v4, s[20:23], s39 offen offset:0 nt lds
    v_mfma_f32_16x16x32_bf16 v[232:235], v[80:83], v[100:103], v[232:235]
    v_max3_f32 v18, v18, v202, v203
    s_waitcnt lgkmcnt(6)
    v_mfma_f32_16x16x32_bf16 v[224:227], v[84:87], v[104:107], v[224:227]
    v_max3_f32 v17, v17, v196, v197
    v_max3_f32 v17, v17, v198, v199
    v_mfma_f32_16x16x32_bf16 v[232:235], v[84:87], v[108:111], v[232:235]
    v_max3_f32 v18, v18, v204, v205
    v_max3_f32 v18, v18, v206, v207
    s_waitcnt lgkmcnt(5)
    v_mfma_f32_16x16x32_bf16 v[228:231], v[88:91], v[96:99], v[228:231]
    v_max3_f32 v17, v17, v208, v209
    v_mfma_f32_16x16x32_bf16 v[236:239], v[88:91], v[100:103], v[236:239]
    v_max3_f32 v17, v17, v210, v211
    s_waitcnt lgkmcnt(4)
    v_mfma_f32_16x16x32_bf16 v[228:231], v[92:95], v[104:107], v[228:231]
    v_max3_f32 v18, v18, v216, v217
    v_max3_f32 v18, v18, v218, v219
    v_mfma_f32_16x16x32_bf16 v[236:239], v[92:95], v[108:111], v[236:239]
    v_max3_f32 v17, v17, v212, v213
    v_max3_f32 v17, v17, v214, v215
    s_waitcnt lgkmcnt(3)
    v_mfma_f32_16x16x32_bf16 v[240:243], v[112:115], v[96:99], v[240:243]
    v_max3_f32 v18, v18, v220, v221
    v_max3_f32 v18, v18, v222, v223
    v_mfma_f32_16x16x32_bf16 v[248:251], v[112:115], v[100:103], v[248:251]
    v_max3_f32 v17, v17, v224, v225
    s_waitcnt lgkmcnt(2)
    v_mfma_f32_16x16x32_bf16 v[240:243], v[116:119], v[104:107], v[240:243]
    v_max3_f32 v17, v17, v226, v227
    v_max3_f32 v18, v18, v232, v233
    v_mfma_f32_16x16x32_bf16 v[248:251], v[116:119], v[108:111], v[248:251]
    v_max3_f32 v18, v18, v234, v235
    v_max3_f32 v17, v17, v228, v229
    s_waitcnt lgkmcnt(1)
    v_mfma_f32_16x16x32_bf16 v[244:247], v[120:123], v[96:99], v[244:247]
    v_max3_f32 v17, v17, v230, v231
    v_max3_f32 v18, v18, v236, v237
    v_mfma_f32_16x16x32_bf16 v[252:255], v[120:123], v[100:103], v[252:255]
    v_max3_f32 v18, v18, v238, v239
    s_waitcnt lgkmcnt(0)
    v_mfma_f32_16x16x32_bf16 v[244:247], v[124:127], v[104:107], v[244:247]
    v_max3_f32 v17, v17, v240, v241
    v_max3_f32 v17, v17, v242, v243
    v_mfma_f32_16x16x32_bf16 v[252:255], v[124:127], v[108:111], v[252:255]
    v_max3_f32 v18, v18, v248, v249
    v_max3_f32 v18, v18, v250, v251
    s_nop 2
    v_max3_f32 v17, v17, v244, v245
    v_max3_f32 v17, v17, v246, v247
    s_nop 0
    v_max3_f32 v18, v18, v252, v253
    v_max3_f32 v18, v18, v254, v255
    v_mov_b32 v25, v17
    s_nop 1
    v_permlane32_swap_b32 v17, v25
    v_max_f32 v17, v17, v25
    v_mov_b32 v25, v17
    s_nop 1
    v_permlane16_swap_b32 v17, v25
    v_max_f32 v17, v17, v25
    v_mul_f32 v17, s37, v17
    v_mov_b32 v25, v18
    s_nop 1
    v_permlane32_swap_b32 v18, v25
    v_max_f32 v18, v18, v25
    v_mov_b32 v25, v18
    s_nop 1
    v_permlane16_swap_b32 v18, v25
    v_max_f32 v18, v18, v25
    v_mul_f32 v18, s37, v18
    v_fma_f32 v128, v128, s37, -v17
    v_fma_f32 v129, v129, s37, -v17
    v_fma_f32 v130, v130, s37, -v17
    v_fma_f32 v131, v131, s37, -v17
    v_fma_f32 v132, v132, s37, -v17
    v_fma_f32 v133, v133, s37, -v17
    v_fma_f32 v134, v134, s37, -v17
    v_fma_f32 v135, v135, s37, -v17
    v_exp_f32 v128, v128
    v_exp_f32 v129, v129
    v_exp_f32 v130, v130
    v_exp_f32 v131, v131
    v_exp_f32 v132, v132
    v_exp_f32 v133, v133
    v_exp_f32 v134, v134
    v_exp_f32 v135, v135
    v_cvt_pk_bf16_f32 v128, v128, v129
    v_cvt_pk_bf16_f32 v129, v130, v131
    v_cvt_pk_bf16_f32 v130, v132, v133
    v_cvt_pk_bf16_f32 v131, v134, v135
    s_add_u32 s39, s32, 256
    s_mov_b32 m0, s40
    s_add_u32 s40, s40, 32768
    s_cmp_eq_u32 s40, s41
    s_cselect_b32 s40, s35, s40
    buffer_load_dwordx4 v1, s[20:23], s39 offen offset:0 nt lds
    s_add_u32 m0, m0, 1024
    v_fma_f32 v136, v136, s37, -v18
    v_fma_f32 v137, v137, s37, -v18
    v_fma_f32 v138, v138, s37, -v18
    v_fma_f32 v139, v139, s37, -v18
    v_fma_f32 v140, v140, s37, -v18
    v_fma_f32 v141, v141, s37, -v18
    v_fma_f32 v142, v142, s37, -v18
    v_fma_f32 v143, v143, s37, -v18
    v_exp_f32 v136, v136
    v_exp_f32 v137, v137
    v_exp_f32 v138, v138
    v_exp_f32 v139, v139
    v_exp_f32 v140, v140
    v_exp_f32 v141, v141
    v_exp_f32 v142, v142
    v_exp_f32 v143, v143
    v_cvt_pk_bf16_f32 v136, v136, v137
    v_cvt_pk_bf16_f32 v137, v138, v139
    v_cvt_pk_bf16_f32 v138, v140, v141
    v_cvt_pk_bf16_f32 v139, v142, v143
    v_fma_f32 v144, v144, s37, -v17
    v_fma_f32 v145, v145, s37, -v17
    v_fma_f32 v146, v146, s37, -v17
    v_fma_f32 v147, v147, s37, -v17
    v_fma_f32 v148, v148, s37, -v17
    v_fma_f32 v149, v149, s37, -v17
    v_fma_f32 v150, v150, s37, -v17
    v_fma_f32 v151, v151, s37, -v17
    v_exp_f32 v144, v144
    v_exp_f32 v145, v145
    v_exp_f32 v146, v146
    v_exp_f32 v147, v147
    v_exp_f32 v148, v148
    v_exp_f32 v149, v149
    v_exp_f32 v150, v150
    v_exp_f32 v151, v151
    v_cvt_pk_bf16_f32 v144, v144, v145
    v_cvt_pk_bf16_f32 v145, v146, v147
    v_cvt_pk_bf16_f32 v146, v148, v149
    v_cvt_pk_bf16_f32 v147, v150, v151
    v_fma_f32 v152, v152, s37, -v18
    v_fma_f32 v153, v153, s37, -v18
    v_fma_f32 v154, v154, s37, -v18
    v_fma_f32 v155, v155, s37, -v18
    v_fma_f32 v156, v156, s37, -v18
    v_fma_f32 v157, v157, s37, -v18
    v_fma_f32 v158, v158, s37, -v18
    v_fma_f32 v159, v159, s37, -v18
    v_exp_f32 v152, v152
    v_exp_f32 v153, v153
    v_exp_f32 v154, v154
    v_exp_f32 v155, v155
    v_exp_f32 v156, v156
    v_exp_f32 v157, v157
    v_exp_f32 v158, v158
    v_exp_f32 v159, v159
    v_cvt_pk_bf16_f32 v152, v152, v153
    v_cvt_pk_bf16_f32 v153, v154, v155
    v_cvt_pk_bf16_f32 v154, v156, v157
    v_cvt_pk_bf16_f32 v155, v158, v159
    buffer_load_dwordx4 v2, s[20:23], s39 offen offset:0 nt lds
    s_add_u32 m0, m0, 1024
    v_fma_f32 v160, v160, s37, -v17
    v_fma_f32 v161, v161, s37, -v17
    v_fma_f32 v162, v162, s37, -v17
    v_fma_f32 v163, v163, s37, -v17
    v_fma_f32 v164, v164, s37, -v17
    v_fma_f32 v165, v165, s37, -v17
    v_fma_f32 v166, v166, s37, -v17
    v_fma_f32 v167, v167, s37, -v17
    v_exp_f32 v160, v160
    v_exp_f32 v161, v161
    v_exp_f32 v162, v162
    v_exp_f32 v163, v163
    v_exp_f32 v164, v164
    v_exp_f32 v165, v165
    v_exp_f32 v166, v166
    v_exp_f32 v167, v167
    v_cvt_pk_bf16_f32 v160, v160, v161
    v_cvt_pk_bf16_f32 v161, v162, v163
    v_cvt_pk_bf16_f32 v162, v164, v165
    v_cvt_pk_bf16_f32 v163, v166, v167
    v_fma_f32 v168, v168, s37, -v18
    v_fma_f32 v169, v169, s37, -v18
    v_fma_f32 v170, v170, s37, -v18
    v_fma_f32 v171, v171, s37, -v18
    v_fma_f32 v172, v172, s37, -v18
    v_fma_f32 v173, v173, s37, -v18
    v_fma_f32 v174, v174, s37, -v18
    v_fma_f32 v175, v175, s37, -v18
    v_exp_f32 v168, v168
    v_exp_f32 v169, v169
    v_exp_f32 v170, v170
    v_exp_f32 v171, v171
    v_exp_f32 v172, v172
    v_exp_f32 v173, v173
    v_exp_f32 v174, v174
    v_exp_f32 v175, v175
    v_cvt_pk_bf16_f32 v168, v168, v169
    v_cvt_pk_bf16_f32 v169, v170, v171
    v_cvt_pk_bf16_f32 v170, v172, v173
    v_cvt_pk_bf16_f32 v171, v174, v175
    v_fma_f32 v176, v176, s37, -v17
    v_fma_f32 v177, v177, s37, -v17
    v_fma_f32 v178, v178, s37, -v17
    v_fma_f32 v179, v179, s37, -v17
    v_fma_f32 v180, v180, s37, -v17
    v_fma_f32 v181, v181, s37, -v17
    v_fma_f32 v182, v182, s37, -v17
    v_fma_f32 v183, v183, s37, -v17
    v_exp_f32 v176, v176
    v_exp_f32 v177, v177
    v_exp_f32 v178, v178
    v_exp_f32 v179, v179
    v_exp_f32 v180, v180
    v_exp_f32 v181, v181
    v_exp_f32 v182, v182
    v_exp_f32 v183, v183
    v_cvt_pk_bf16_f32 v176, v176, v177
    v_cvt_pk_bf16_f32 v177, v178, v179
    v_cvt_pk_bf16_f32 v178, v180, v181
    v_cvt_pk_bf16_f32 v179, v182, v183
    buffer_load_dwordx4 v3, s[20:23], s39 offen offset:0 nt lds
    s_add_u32 m0, m0, 1024
    v_fma_f32 v184, v184, s37, -v18
    v_fma_f32 v185, v185, s37, -v18
    v_fma_f32 v186, v186, s37, -v18
    v_fma_f32 v187, v187, s37, -v18
    v_fma_f32 v188, v188, s37, -v18
    v_fma_f32 v189, v189, s37, -v18
    v_fma_f32 v190, v190, s37, -v18
    v_fma_f32 v191, v191, s37, -v18
    v_exp_f32 v184, v184
    v_exp_f32 v185, v185
    v_exp_f32 v186, v186
    v_exp_f32 v187, v187
    v_exp_f32 v188, v188
    v_exp_f32 v189, v189
    v_exp_f32 v190, v190
    v_exp_f32 v191, v191
    v_cvt_pk_bf16_f32 v184, v184, v185
    v_cvt_pk_bf16_f32 v185, v186, v187
    v_cvt_pk_bf16_f32 v186, v188, v189
    v_cvt_pk_bf16_f32 v187, v190, v191
    v_fma_f32 v192, v192, s37, -v17
    v_fma_f32 v193, v193, s37, -v17
    v_fma_f32 v194, v194, s37, -v17
    v_fma_f32 v195, v195, s37, -v17
    v_fma_f32 v196, v196, s37, -v17
    v_fma_f32 v197, v197, s37, -v17
    v_fma_f32 v198, v198, s37, -v17
    v_fma_f32 v199, v199, s37, -v17
    v_exp_f32 v192, v192
    v_exp_f32 v193, v193
    v_exp_f32 v194, v194
    v_exp_f32 v195, v195
    v_exp_f32 v196, v196
    v_exp_f32 v197, v197
    v_exp_f32 v198, v198
    v_exp_f32 v199, v199
    v_cvt_pk_bf16_f32 v192, v192, v193
    v_cvt_pk_bf16_f32 v193, v194, v195
    v_cvt_pk_bf16_f32 v194, v196, v197
    v_cvt_pk_bf16_f32 v195, v198, v199
    v_fma_f32 v200, v200, s37, -v18
    v_fma_f32 v201, v201, s37, -v18
    v_fma_f32 v202, v202, s37, -v18
    v_fma_f32 v203, v203, s37, -v18
    v_fma_f32 v204, v204, s37, -v18
    v_fma_f32 v205, v205, s37, -v18
    v_fma_f32 v206, v206, s37, -v18
    v_fma_f32 v207, v207, s37, -v18
    v_exp_f32 v200, v200
    v_exp_f32 v201, v201
    v_exp_f32 v202, v202
    v_exp_f32 v203, v203
    v_exp_f32 v204, v204
    v_exp_f32 v205, v205
    v_exp_f32 v206, v206
    v_exp_f32 v207, v207
    v_cvt_pk_bf16_f32 v200, v200, v201
    v_cvt_pk_bf16_f32 v201, v202, v203
    v_cvt_pk_bf16_f32 v202, v204, v205
    v_cvt_pk_bf16_f32 v203, v206, v207
    buffer_load_dwordx4 v4, s[20:23], s39 offen offset:0 nt lds
    v_add_u32 v11, s42, v7
    v_add_u32 v12, s42, v8
    v_add_u32 v13, s42, v9
    v_add_u32 v14, s42, v10
    s_add_u32 s42, s42, 32768
    s_cmp_eq_u32 s42, 163840
    s_cselect_b32 s42, 0, s42
    s_waitcnt vmcnt(8)
    s_barrier
    ds_read_b64_tr_b16 v[96:97], v11 offset:0
    ds_read_b64_tr_b16 v[98:99], v11 offset:2048
    ds_read_b64_tr_b16 v[100:101], v12 offset:0
    ds_read_b64_tr_b16 v[102:103], v12 offset:2048
    ds_read_b64_tr_b16 v[104:105], v13 offset:0
    ds_read_b64_tr_b16 v[106:107], v13 offset:2048
    ds_read_b64_tr_b16 v[108:109], v14 offset:0
    ds_read_b64_tr_b16 v[110:111], v14 offset:2048
    ds_read_b64_tr_b16 v[112:113], v11 offset:4096
    ds_read_b64_tr_b16 v[114:115], v11 offset:6144
    ds_read_b64_tr_b16 v[116:117], v12 offset:4096
    ds_read_b64_tr_b16 v[118:119], v12 offset:6144
    v_fma_f32 v208, v208, s37, -v17
    v_fma_f32 v209, v209, s37, -v17
    v_fma_f32 v210, v210, s37, -v17
    v_fma_f32 v211, v211, s37, -v17
    v_fma_f32 v212, v212, s37, -v17
    v_fma_f32 v213, v213, s37, -v17
    v_fma_f32 v214, v214, s37, -v17
    v_fma_f32 v215, v215, s37, -v17
    v_exp_f32 v208, v208
    v_exp_f32 v209, v209
    v_exp_f32 v210, v210
    v_exp_f32 v211, v211
    v_exp_f32 v212, v212
    v_exp_f32 v213, v213
    v_exp_f32 v214, v214
    v_exp_f32 v215, v215
    v_cvt_pk_bf16_f32 v208, v208, v209
    v_cvt_pk_bf16_f32 v209, v210, v211
    v_cvt_pk_bf16_f32 v210, v212, v213
    v_cvt_pk_bf16_f32 v211, v214, v215
    v_fma_f32 v216, v216, s37, -v18
    v_fma_f32 v217, v217, s37, -v18
    v_fma_f32 v218, v218, s37, -v18
    v_fma_f32 v219, v219, s37, -v18
    v_fma_f32 v220, v220, s37, -v18
    v_fma_f32 v221, v221, s37, -v18
    v_fma_f32 v222, v222, s37, -v18
    v_fma_f32 v223, v223, s37, -v18
    v_exp_f32 v216, v216
    v_exp_f32 v217, v217
    v_exp_f32 v218, v218
    v_exp_f32 v219, v219
    v_exp_f32 v220, v220
    v_exp_f32 v221, v221
    v_exp_f32 v222, v222
    v_exp_f32 v223, v223
    v_cvt_pk_bf16_f32 v216, v216, v217
    v_cvt_pk_bf16_f32 v217, v218, v219
    v_cvt_pk_bf16_f32 v218, v220, v221
    v_cvt_pk_bf16_f32 v219, v222, v223
    s_waitcnt lgkmcnt(10)
    v_mfma_f32_16x16x32_bf16 v[32:35], v[96:99], v[128:131], 0
    v_fma_f32 v224, v224, s37, -v17
    v_fma_f32 v225, v225, s37, -v17
    v_mfma_f32_16x16x32_bf16 v[36:39], v[96:99], v[136:139], 0
    ds_read_b64_tr_b16 v[120:121], v13 offset:4096
    ds_read_b64_tr_b16 v[122:123], v13 offset:6144
    s_mov_b32 m0, s40
    s_add_u32 s40, s40, 32768
    s_cmp_eq_u32 s40, s41
    s_cselect_b32 s40, s35, s40
    buffer_load_dwordx4 v1, s[12:15], s33 offen offset:0 nt lds
    s_add_u32 m0, m0, 1024
    v_fma_f32 v226, v226, s37, -v17
    s_waitcnt lgkmcnt(10)
    v_mfma_f32_16x16x32_bf16 v[40:43], v[100:103], v[128:131], 0
    v_fma_f32 v227, v227, s37, -v17
    v_fma_f32 v228, v228, s37, -v17
    v_mfma_f32_16x16x32_bf16 v[44:47], v[100:103], v[136:139], 0
    v_mfma_f32_16x16x32_bf16 v[132:135], v[26:29], v[128:131], 0
    ds_read_b64_tr_b16 v[124:125], v14 offset:4096
    ds_read_b64_tr_b16 v[126:127], v14 offset:6144
    v_fma_f32 v229, v229, s37, -v17
    s_waitcnt lgkmcnt(10)
    v_mfma_f32_16x16x32_bf16 v[48:51], v[104:107], v[128:131], 0
    v_fma_f32 v230, v230, s37, -v17
    v_fma_f32 v231, v231, s37, -v17
    v_mfma_f32_16x16x32_bf16 v[52:55], v[104:107], v[136:139], 0
    ds_read_b64_tr_b16 v[96:97], v11 offset:8192
    ds_read_b64_tr_b16 v[98:99], v11 offset:10240
    v_exp_f32 v224, v224
    s_waitcnt lgkmcnt(10)
    v_mfma_f32_16x16x32_bf16 v[56:59], v[108:111], v[128:131], 0
    v_exp_f32 v225, v225
    v_mfma_f32_16x16x32_bf16 v[60:63], v[108:111], v[136:139], 0
    v_mfma_f32_16x16x32_bf16 v[140:143], v[26:29], v[136:139], 0
    ds_read_b64_tr_b16 v[100:101], v12 offset:8192
    ds_read_b64_tr_b16 v[102:103], v12 offset:10240
    v_exp_f32 v226, v226
    v_exp_f32 v227, v227
    s_waitcnt lgkmcnt(10)
    v_mfma_f32_16x16x32_bf16 v[32:35], v[112:115], v[144:147], v[32:35]
    v_exp_f32 v228, v228
    v_mfma_f32_16x16x32_bf16 v[36:39], v[112:115], v[152:155], v[36:39]
    ds_read_b64_tr_b16 v[104:105], v13 offset:8192
    ds_read_b64_tr_b16 v[106:107], v13 offset:10240
    buffer_load_dwordx4 v2, s[12:15], s33 offen offset:0 nt lds
    s_add_u32 m0, m0, 1024
    v_exp_f32 v229, v229
    v_exp_f32 v230, v230
    s_waitcnt lgkmcnt(10)
    v_mfma_f32_16x16x32_bf16 v[40:43], v[116:119], v[144:147], v[40:43]
    v_exp_f32 v231, v231
    v_mfma_f32_16x16x32_bf16 v[44:47], v[116:119], v[152:155], v[44:47]
    v_mfma_f32_16x16x32_bf16 v[132:135], v[26:29], v[144:147], v[132:135]
    ds_read_b64_tr_b16 v[108:109], v14 offset:8192
    ds_read_b64_tr_b16 v[110:111], v14 offset:10240
    v_cvt_pk_bf16_f32 v224, v224, v225
    v_cvt_pk_bf16_f32 v225, v226, v227
    s_waitcnt lgkmcnt(10)
    v_mfma_f32_16x16x32_bf16 v[48:51], v[120:123], v[144:147], v[48:51]
    v_cvt_pk_bf16_f32 v226, v228, v229
    v_mfma_f32_16x16x32_bf16 v[52:55], v[120:123], v[152:155], v[52:55]
    ds_read_b64_tr_b16 v[112:113], v11 offset:12288
    ds_read_b64_tr_b16 v[114:115], v11 offset:14336
    v_cvt_pk_bf16_f32 v227, v230, v231
    s_waitcnt lgkmcnt(10)
    v_mfma_f32_16x16x32_bf16 v[56:59], v[124:127], v[144:147], v[56:59]
    v_fma_f32 v232, v232, s37, -v18
    v_fma_f32 v233, v233, s37, -v18
    v_mfma_f32_16x16x32_bf16 v[60:63], v[124:127], v[152:155], v[60:63]
    v_mfma_f32_16x16x32_bf16 v[140:143], v[26:29], v[152:155], v[140:143]
    ds_read_b64_tr_b16 v[116:117], v12 offset:12288
    ds_read_b64_tr_b16 v[118:119], v12 offset:14336
    v_fma_f32 v234, v234, s37, -v18
    s_waitcnt lgkmcnt(10)
    v_mfma_f32_16x16x32_bf16 v[32:35], v[96:99], v[160:163], v[32:35]
    v_fma_f32 v235, v235, s37, -v18
    v_fma_f32 v236, v236, s37, -v18
    v_mfma_f32_16x16x32_bf16 v[36:39], v[96:99], v[168:171], v[36:39]
    ds_read_b64_tr_b16 v[120:121], v13 offset:12288
    ds_read_b64_tr_b16 v[122:123], v13 offset:14336
    buffer_load_dwordx4 v3, s[12:15], s33 offen offset:0 nt lds
    s_add_u32 m0, m0, 1024
    v_fma_f32 v237, v237, s37, -v18
    s_waitcnt lgkmcnt(10)
    v_mfma_f32_16x16x32_bf16 v[40:43], v[100:103], v[160:163], v[40:43]
    v_fma_f32 v238, v238, s37, -v18
    v_fma_f32 v239, v239, s37, -v18
    v_mfma_f32_16x16x32_bf16 v[44:47], v[100:103], v[168:171], v[44:47]
    v_mfma_f32_16x16x32_bf16 v[132:135], v[26:29], v[160:163], v[132:135]
    ds_read_b64_tr_b16 v[124:125], v14 offset:12288
    ds_read_b64_tr_b16 v[126:127], v14 offset:14336
    v_exp_f32 v232, v232
    s_waitcnt lgkmcnt(10)
    v_mfma_f32_16x16x32_bf16 v[48:51], v[104:107], v[160:163], v[48:51]
    v_exp_f32 v233, v233
    v_mfma_f32_16x16x32_bf16 v[52:55], v[104:107], v[168:171], v[52:55]
    ds_read_b64_tr_b16 v[96:97], v11 offset:16384
    ds_read_b64_tr_b16 v[98:99], v11 offset:18432
    v_exp_f32 v234, v234
    v_exp_f32 v235, v235
    s_waitcnt lgkmcnt(10)
    v_mfma_f32_16x16x32_bf16 v[56:59], v[108:111], v[160:163], v[56:59]
    v_exp_f32 v236, v236
    v_mfma_f32_16x16x32_bf16 v[60:63], v[108:111], v[168:171], v[60:63]
    v_mfma_f32_16x16x32_bf16 v[140:143], v[26:29], v[168:171], v[140:143]
    ds_read_b64_tr_b16 v[100:101], v12 offset:16384
    ds_read_b64_tr_b16 v[102:103], v12 offset:18432
    v_exp_f32 v237, v237
    v_exp_f32 v238, v238
    s_waitcnt lgkmcnt(10)
    v_mfma_f32_16x16x32_bf16 v[32:35], v[112:115], v[176:179], v[32:35]
    v_exp_f32 v239, v239
    v_mfma_f32_16x16x32_bf16 v[36:39], v[112:115], v[184:187], v[36:39]
    ds_read_b64_tr_b16 v[104:105], v13 offset:16384
    ds_read_b64_tr_b16 v[106:107], v13 offset:18432
    v_cvt_pk_bf16_f32 v232, v232, v233
    v_cvt_pk_bf16_f32 v233, v234, v235
    s_waitcnt lgkmcnt(10)
    v_mfma_f32_16x16x32_bf16 v[40:43], v[116:119], v[176:179], v[40:43]
    buffer_load_dwordx4 v4, s[12:15], s33 offen offset:0 nt lds
    v_cvt_pk_bf16_f32 v234, v236, v237
    v_mfma_f32_16x16x32_bf16 v[44:47], v[116:119], v[184:187], v[44:47]
    v_mfma_f32_16x16x32_bf16 v[132:135], v[26:29], v[176:179], v[132:135]
    ds_read_b64_tr_b16 v[108:109], v14 offset:16384
    ds_read_b64_tr_b16 v[110:111], v14 offset:18432
    v_cvt_pk_bf16_f32 v235, v238, v239
    s_waitcnt lgkmcnt(10)
    v_mfma_f32_16x16x32_bf16 v[48:51], v[120:123], v[176:179], v[48:51]
    v_fma_f32 v240, v240, s37, -v17
    v_fma_f32 v241, v241, s37, -v17
    v_mfma_f32_16x16x32_bf16 v[52:55], v[120:123], v[184:187], v[52:55]
    ds_read_b64_tr_b16 v[112:113], v11 offset:20480
    ds_read_b64_tr_b16 v[114:115], v11 offset:22528
    v_fma_f32 v242, v242, s37, -v17
    s_waitcnt lgkmcnt(10)
    v_mfma_f32_16x16x32_bf16 v[56:59], v[124:127], v[176:179], v[56:59]
    v_fma_f32 v243, v243, s37, -v17
    v_fma_f32 v244, v244, s37, -v17
    v_mfma_f32_16x16x32_bf16 v[60:63], v[124:127], v[184:187], v[60:63]
    v_mfma_f32_16x16x32_bf16 v[140:143], v[26:29], v[184:187], v[140:143]
    ds_read_b64_tr_b16 v[116:117], v12 offset:20480
    ds_read_b64_tr_b16 v[118:119], v12 offset:22528
    v_fma_f32 v245, v245, s37, -v17
    s_waitcnt lgkmcnt(10)
    v_mfma_f32_16x16x32_bf16 v[32:35], v[96:99], v[192:195], v[32:35]
    v_fma_f32 v246, v246, s37, -v17
    v_fma_f32 v247, v247, s37, -v17
    v_mfma_f32_16x16x32_bf16 v[36:39], v[96:99], v[200:203], v[36:39]
    ds_read_b64_tr_b16 v[120:121], v13 offset:20480
    ds_read_b64_tr_b16 v[122:123], v13 offset:22528
    v_exp_f32 v240, v240
    s_waitcnt lgkmcnt(10)
    v_mfma_f32_16x16x32_bf16 v[40:43], v[100:103], v[192:195], v[40:43]
    s_mov_b32 m0, s40
    s_add_u32 s40, s40, 32768
    s_cmp_eq_u32 s40, s41
    s_cselect_b32 s40, s35, s40
    buffer_load_dwordx4 v1, s[16:19], s33 offen offset:0 nt lds
    s_add_u32 m0, m0, 1024
    v_exp_f32 v241, v241
    v_mfma_f32_16x16x32_bf16 v[44:47], v[100:103], v[200:203], v[44:47]
    v_mfma_f32_16x16x32_bf16 v[132:135], v[26:29], v[192:195], v[132:135]
    ds_read_b64_tr_b16 v[124:125], v14 offset:20480
    ds_read_b64_tr_b16 v[126:127], v14 offset:22528
    v_exp_f32 v242, v242
    v_exp_f32 v243, v243
    s_waitcnt lgkmcnt(10)
    v_mfma_f32_16x16x32_bf16 v[48:51], v[104:107], v[192:195], v[48:51]
    v_exp_f32 v244, v244
    v_mfma_f32_16x16x32_bf16 v[52:55], v[104:107], v[200:203], v[52:55]
    ds_read_b64_tr_b16 v[96:97], v11 offset:24576
    ds_read_b64_tr_b16 v[98:99], v11 offset:26624
    v_exp_f32 v245, v245
    v_exp_f32 v246, v246
    s_waitcnt lgkmcnt(10)
    v_mfma_f32_16x16x32_bf16 v[56:59], v[108:111], v[192:195], v[56:59]
    v_exp_f32 v247, v247
    v_mfma_f32_16x16x32_bf16 v[60:63], v[108:111], v[200:203], v[60:63]
    v_mfma_f32_16x16x32_bf16 v[140:143], v[26:29], v[200:203], v[140:143]
    ds_read_b64_tr_b16 v[100:101], v12 offset:24576
    ds_read_b64_tr_b16 v[102:103], v12 offset:26624
    v_cvt_pk_bf16_f32 v240, v240, v241
    v_cvt_pk_bf16_f32 v241, v242, v243
    s_waitcnt lgkmcnt(10)
    v_mfma_f32_16x16x32_bf16 v[32:35], v[112:115], v[208:211], v[32:35]
    v_cvt_pk_bf16_f32 v242, v244, v245
    v_mfma_f32_16x16x32_bf16 v[36:39], v[112:115], v[216:219], v[36:39]
    ds_read_b64_tr_b16 v[104:105], v13 offset:24576
    ds_read_b64_tr_b16 v[106:107], v13 offset:26624
    v_cvt_pk_bf16_f32 v243, v246, v247
    s_waitcnt lgkmcnt(10)
    v_mfma_f32_16x16x32_bf16 v[40:43], v[116:119], v[208:211], v[40:43]
    v_fma_f32 v248, v248, s37, -v18
    v_fma_f32 v249, v249, s37, -v18
    v_mfma_f32_16x16x32_bf16 v[44:47], v[116:119], v[216:219], v[44:47]
    v_mfma_f32_16x16x32_bf16 v[132:135], v[26:29], v[208:211], v[132:135]
    ds_read_b64_tr_b16 v[108:109], v14 offset:24576
    ds_read_b64_tr_b16 v[110:111], v14 offset:26624
    buffer_load_dwordx4 v2, s[16:19], s33 offen offset:0 nt lds
    s_add_u32 m0, m0, 1024
    v_fma_f32 v250, v250, s37, -v18
    s_waitcnt lgkmcnt(10)
    v_mfma_f32_16x16x32_bf16 v[48:51], v[120:123], v[208:211], v[48:51]
    v_fma_f32 v251, v251, s37, -v18
    v_fma_f32 v252, v252, s37, -v18
    v_mfma_f32_16x16x32_bf16 v[52:55], v[120:123], v[216:219], v[52:55]
    ds_read_b64_tr_b16 v[112:113], v11 offset:28672
    ds_read_b64_tr_b16 v[114:115], v11 offset:30720
    v_fma_f32 v253, v253, s37, -v18
    s_waitcnt lgkmcnt(10)
    v_mfma_f32_16x16x32_bf16 v[56:59], v[124:127], v[208:211], v[56:59]
    v_fma_f32 v254, v254, s37, -v18
    v_fma_f32 v255, v255, s37, -v18
    v_mfma_f32_16x16x32_bf16 v[60:63], v[124:127], v[216:219], v[60:63]
    v_mfma_f32_16x16x32_bf16 v[140:143], v[26:29], v[216:219], v[140:143]
    ds_read_b64_tr_b16 v[116:117], v12 offset:28672
    ds_read_b64_tr_b16 v[118:119], v12 offset:30720
    v_exp_f32 v248, v248
    s_waitcnt lgkmcnt(10)
    v_mfma_f32_16x16x32_bf16 v[32:35], v[96:99], v[224:227], v[32:35]
    v_exp_f32 v249, v249
    v_mfma_f32_16x16x32_bf16 v[36:39], v[96:99], v[232:235], v[36:39]
    ds_read_b64_tr_b16 v[120:121], v13 offset:28672
    ds_read_b64_tr_b16 v[122:123], v13 offset:30720
    v_exp_f32 v250, v250
    v_exp_f32 v251, v251
    s_waitcnt lgkmcnt(10)
    v_mfma_f32_16x16x32_bf16 v[40:43], v[100:103], v[224:227], v[40:43]
    v_exp_f32 v252, v252
    v_mfma_f32_16x16x32_bf16 v[44:47], v[100:103], v[232:235], v[44:47]
    v_mfma_f32_16x16x32_bf16 v[132:135], v[26:29], v[224:227], v[132:135]
    ds_read_b64_tr_b16 v[124:125], v14 offset:28672
    ds_read_b64_tr_b16 v[126:127], v14 offset:30720
    buffer_load_dwordx4 v3, s[16:19], s33 offen offset:0 nt lds
    s_add_u32 m0, m0, 1024
    v_exp_f32 v253, v253
    v_exp_f32 v254, v254
    s_waitcnt lgkmcnt(10)
    v_mfma_f32_16x16x32_bf16 v[48:51], v[104:107], v[224:227], v[48:51]
    v_exp_f32 v255, v255
    v_mfma_f32_16x16x32_bf16 v[52:55], v[104:107], v[232:235], v[52:55]
    v_cvt_pk_bf16_f32 v248, v248, v249
    v_cvt_pk_bf16_f32 v249, v250, v251
    s_waitcnt lgkmcnt(8)
    v_mfma_f32_16x16x32_bf16 v[56:59], v[108:111], v[224:227], v[56:59]
    v_cvt_pk_bf16_f32 v250, v252, v253
    v_mfma_f32_16x16x32_bf16 v[60:63], v[108:111], v[232:235], v[60:63]
    v_mfma_f32_16x16x32_bf16 v[140:143], v[26:29], v[232:235], v[140:143]
    v_cvt_pk_bf16_f32 v251, v254, v255
    s_waitcnt lgkmcnt(6)
    v_mfma_f32_16x16x32_bf16 v[32:35], v[112:115], v[240:243], v[32:35]
    v_mfma_f32_16x16x32_bf16 v[36:39], v[112:115], v[248:251], v[36:39]
    s_waitcnt lgkmcnt(4)
    v_mfma_f32_16x16x32_bf16 v[40:43], v[116:119], v[240:243], v[40:43]
    v_mfma_f32_16x16x32_bf16 v[44:47], v[116:119], v[248:251], v[44:47]
    v_mfma_f32_16x16x32_bf16 v[132:135], v[26:29], v[240:243], v[132:135]
    s_waitcnt lgkmcnt(2)
    v_mfma_f32_16x16x32_bf16 v[48:51], v[120:123], v[240:243], v[48:51]
    buffer_load_dwordx4 v4, s[16:19], s33 offen offset:0 nt lds
    v_mfma_f32_16x16x32_bf16 v[52:55], v[120:123], v[248:251], v[52:55]
    s_waitcnt lgkmcnt(0)
    v_mfma_f32_16x16x32_bf16 v[56:59], v[124:127], v[240:243], v[56:59]
    v_mfma_f32_16x16x32_bf16 v[60:63], v[124:127], v[248:251], v[60:63]
    v_mfma_f32_16x16x32_bf16 v[140:143], v[26:29], v[248:251], v[140:143]
    v_add_u32 v11, s42, v7
    v_add_u32 v12, s42, v8
    v_add_u32 v13, s42, v9
    v_add_u32 v14, s42, v10
    s_add_u32 s42, s42, 32768
    s_cmp_eq_u32 s42, 163840
    s_cselect_b32 s42, 0, s42
    s_waitcnt vmcnt(12)
    s_barrier
    ds_read_b64_tr_b16 v[96:97], v11 offset:0
    ds_read_b64_tr_b16 v[98:99], v11 offset:2048
    ds_read_b64_tr_b16 v[100:101], v12 offset:0
    ds_read_b64_tr_b16 v[102:103], v12 offset:2048
    ds_read_b64_tr_b16 v[104:105], v13 offset:0
    ds_read_b64_tr_b16 v[106:107], v13 offset:2048
    ds_read_b64_tr_b16 v[108:109], v14 offset:0
    ds_read_b64_tr_b16 v[110:111], v14 offset:2048
    ds_read_b64_tr_b16 v[112:113], v11 offset:4096
    ds_read_b64_tr_b16 v[114:115], v11 offset:6144
    ds_read_b64_tr_b16 v[116:117], v12 offset:4096
    ds_read_b64_tr_b16 v[118:119], v12 offset:6144
    v_rcp_f32 v19, v132
    v_rcp_f32 v20, v140
    s_waitcnt lgkmcnt(10)
    v_mfma_f32_16x16x32_bf16 v[64:67], v[96:99], v[128:131], 0
    v_add_u32 v21, s40, v15
    v_add_u32 v25, s40, v16
    v_xor_b32 v22, 32, v21
    v_xor_b32 v23, 64, v21
    v_xor_b32 v24, 96, v21
    v_mfma_f32_16x16x32_bf16 v[68:71], v[96:99], v[136:139], 0
    ds_read_b64_tr_b16 v[120:121], v13 offset:4096
    ds_read_b64_tr_b16 v[122:123], v13 offset:6144
    v_mul_f32 v32, v32, v19
    v_mul_f32 v33, v33, v19
    v_mul_f32 v34, v34, v19
    v_mul_f32 v35, v35, v19
    v_cvt_pk_bf16_f32 v32, v32, v33
    s_waitcnt lgkmcnt(10)
    v_mfma_f32_16x16x32_bf16 v[72:75], v[100:103], v[128:131], 0
    v_cvt_pk_bf16_f32 v33, v34, v35
    ds_write_b64 v21, v[32:33] offset:0
    v_mul_f32 v36, v36, v20
    v_mul_f32 v37, v37, v20
    v_mul_f32 v38, v38, v20
    v_mfma_f32_16x16x32_bf16 v[76:79], v[100:103], v[136:139], 0
    ds_read_b64_tr_b16 v[124:125], v14 offset:4096
    ds_read_b64_tr_b16 v[126:127], v14 offset:6144
    v_mul_f32 v39, v39, v20
    v_cvt_pk_bf16_f32 v36, v36, v37
    v_cvt_pk_bf16_f32 v37, v38, v39
    ds_write_b64 v21, v[36:37] offset:2048
    v_mul_f32 v40, v40, v19
    s_waitcnt lgkmcnt(12)
    v_mfma_f32_16x16x32_bf16 v[80:83], v[104:107], v[128:131], 0
    v_mul_f32 v41, v41, v19
    v_mul_f32 v42, v42, v19
    v_mul_f32 v43, v43, v19
    v_cvt_pk_bf16_f32 v40, v40, v41
    v_cvt_pk_bf16_f32 v41, v42, v43
    v_mfma_f32_16x16x32_bf16 v[84:87], v[104:107], v[136:139], 0
    ds_read_b64_tr_b16 v[96:97], v11 offset:8192
    ds_read_b64_tr_b16 v[98:99], v11 offset:10240
    ds_write_b64 v22, v[40:41] offset:0
    v_mul_f32 v44, v44, v20
    v_mul_f32 v45, v45, v20
    v_mul_f32 v46, v46, v20
    v_mul_f32 v47, v47, v20
    s_waitcnt lgkmcnt(13)
    v_mfma_f32_16x16x32_bf16 v[88:91], v[108:111], v[128:131], 0
    v_cvt_pk_bf16_f32 v44, v44, v45
    v_cvt_pk_bf16_f32 v45, v46, v47
    ds_write_b64 v22, v[44:45] offset:2048
    v_mul_f32 v48, v48, v19
    v_mul_f32 v49, v49, v19
    v_mfma_f32_16x16x32_bf16 v[92:95], v[108:111], v[136:139], 0
    ds_read_b64_tr_b16 v[100:101], v12 offset:8192
    s_waitcnt lgkmcnt(14)
    ds_read_b64_tr_b16 v[102:103], v12 offset:10240
    v_mul_f32 v50, v50, v19
    v_mul_f32 v51, v51, v19
    v_cvt_pk_bf16_f32 v48, v48, v49
    v_cvt_pk_bf16_f32 v49, v50, v51
    s_waitcnt lgkmcnt(14)
    ds_write_b64 v23, v[48:49] offset:0
    v_mfma_f32_16x16x32_bf16 v[64:67], v[112:115], v[144:147], v[64:67]
    v_mul_f32 v52, v52, v20
    v_mul_f32 v53, v53, v20
    v_mul_f32 v54, v54, v20
    v_mul_f32 v55, v55, v20
    v_cvt_pk_bf16_f32 v52, v52, v53
    v_mfma_f32_16x16x32_bf16 v[68:71], v[112:115], v[152:155], v[68:71]
    s_waitcnt lgkmcnt(14)
    ds_read_b64_tr_b16 v[104:105], v13 offset:8192
    s_waitcnt lgkmcnt(14)
    ds_read_b64_tr_b16 v[106:107], v13 offset:10240
    v_cvt_pk_bf16_f32 v53, v54, v55
    s_waitcnt lgkmcnt(14)
    ds_write_b64 v23, v[52:53] offset:2048
    v_mul_f32 v56, v56, v19
    v_mul_f32 v57, v57, v19
    v_mul_f32 v58, v58, v19
    v_mfma_f32_16x16x32_bf16 v[72:75], v[116:119], v[144:147], v[72:75]
    v_mul_f32 v59, v59, v19
    v_cvt_pk_bf16_f32 v56, v56, v57
    v_cvt_pk_bf16_f32 v57, v58, v59
    s_waitcnt lgkmcnt(14)
    ds_write_b64 v24, v[56:57] offset:0
    v_mul_f32 v60, v60, v20
    v_mfma_f32_16x16x32_bf16 v[76:79], v[116:119], v[152:155], v[76:79]
    s_waitcnt lgkmcnt(14)
    ds_read_b64_tr_b16 v[108:109], v14 offset:8192
    s_waitcnt lgkmcnt(14)
    ds_read_b64_tr_b16 v[110:111], v14 offset:10240
    v_mul_f32 v61, v61, v20
    v_mul_f32 v62, v62, v20
    v_mul_f32 v63, v63, v20
    v_cvt_pk_bf16_f32 v60, v60, v61
    v_cvt_pk_bf16_f32 v61, v62, v63
    v_mfma_f32_16x16x32_bf16 v[80:83], v[120:123], v[144:147], v[80:83]
    s_waitcnt lgkmcnt(14)
    ds_write_b64 v24, v[60:61] offset:2048
    v_mfma_f32_16x16x32_bf16 v[84:87], v[120:123], v[152:155], v[84:87]
    s_waitcnt lgkmcnt(14)
    ds_read_b64_tr_b16 v[112:113], v11 offset:12288
    s_waitcnt lgkmcnt(14)
    ds_read_b64_tr_b16 v[114:115], v11 offset:14336
    s_waitcnt lgkmcnt(14)
    ds_read_b128 v[48:51], v25 offset:0
    s_waitcnt lgkmcnt(14)
    ds_read_b128 v[52:55], v25 offset:1024
    s_waitcnt lgkmcnt(14)
    ds_read_b128 v[56:59], v25 offset:2048
    s_waitcnt lgkmcnt(14)
    ds_read_b128 v[60:63], v25 offset:3072
    v_mfma_f32_16x16x32_bf16 v[88:91], v[124:127], v[144:147], v[88:91]
    v_mfma_f32_16x16x32_bf16 v[92:95], v[124:127], v[152:155], v[92:95]
    s_waitcnt lgkmcnt(14)
    ds_read_b64_tr_b16 v[116:117], v12 offset:12288
    s_waitcnt lgkmcnt(14)
    ds_read_b64_tr_b16 v[118:119], v12 offset:14336
    v_mfma_f32_16x16x32_bf16 v[64:67], v[96:99], v[160:163], v[64:67]
    s_waitcnt lgkmcnt(5)
    buffer_store_dwordx4 v[48:51], v1, s[24:27], s32 offen offset:0 sc1
    v_mfma_f32_16x16x32_bf16 v[68:71], v[96:99], v[168:171], v[68:71]
    ds_read_b64_tr_b16 v[120:121], v13 offset:12288
    ds_read_b64_tr_b16 v[122:123], v13 offset:14336
    v_mfma_f32_16x16x32_bf16 v[72:75], v[100:103], v[160:163], v[72:75]
    v_mfma_f32_16x16x32_bf16 v[76:79], v[100:103], v[168:171], v[76:79]
    ds_read_b64_tr_b16 v[124:125], v14 offset:12288
    ds_read_b64_tr_b16 v[126:127], v14 offset:14336
    v_mfma_f32_16x16x32_bf16 v[80:83], v[104:107], v[160:163], v[80:83]
    v_mfma_f32_16x16x32_bf16 v[84:87], v[104:107], v[168:171], v[84:87]
    ds_read_b64_tr_b16 v[96:97], v11 offset:16384
    ds_read_b64_tr_b16 v[98:99], v11 offset:18432
    v_mfma_f32_16x16x32_bf16 v[88:91], v[108:111], v[160:163], v[88:91]
    s_waitcnt lgkmcnt(10)
    buffer_store_dwordx4 v[52:55], v2, s[24:27], s32 offen offset:0 sc1
    v_mfma_f32_16x16x32_bf16 v[92:95], v[108:111], v[168:171], v[92:95]
    ds_read_b64_tr_b16 v[100:101], v12 offset:16384
    ds_read_b64_tr_b16 v[102:103], v12 offset:18432
    v_mfma_f32_16x16x32_bf16 v[64:67], v[112:115], v[176:179], v[64:67]
    v_mfma_f32_16x16x32_bf16 v[68:71], v[112:115], v[184:187], v[68:71]
    ds_read_b64_tr_b16 v[104:105], v13 offset:16384
    ds_read_b64_tr_b16 v[106:107], v13 offset:18432
    s_waitcnt lgkmcnt(10)
    v_mfma_f32_16x16x32_bf16 v[72:75], v[116:119], v[176:179], v[72:75]
    v_mfma_f32_16x16x32_bf16 v[76:79], v[116:119], v[184:187], v[76:79]
    ds_read_b64_tr_b16 v[108:109], v14 offset:16384
    ds_read_b64_tr_b16 v[110:111], v14 offset:18432
    s_waitcnt lgkmcnt(10)
    v_mfma_f32_16x16x32_bf16 v[80:83], v[120:123], v[176:179], v[80:83]
    buffer_store_dwordx4 v[56:59], v3, s[24:27], s32 offen offset:0 sc1
    v_mfma_f32_16x16x32_bf16 v[84:87], v[120:123], v[184:187], v[84:87]
    ds_read_b64_tr_b16 v[112:113], v11 offset:20480
    ds_read_b64_tr_b16 v[114:115], v11 offset:22528
    s_waitcnt lgkmcnt(10)
    v_mfma_f32_16x16x32_bf16 v[88:91], v[124:127], v[176:179], v[88:91]
    v_mfma_f32_16x16x32_bf16 v[92:95], v[124:127], v[184:187], v[92:95]
    ds_read_b64_tr_b16 v[116:117], v12 offset:20480
    ds_read_b64_tr_b16 v[118:119], v12 offset:22528
    s_waitcnt lgkmcnt(10)
    v_mfma_f32_16x16x32_bf16 v[64:67], v[96:99], v[192:195], v[64:67]
    v_mfma_f32_16x16x32_bf16 v[68:71], v[96:99], v[200:203], v[68:71]
    ds_read_b64_tr_b16 v[120:121], v13 offset:20480
    ds_read_b64_tr_b16 v[122:123], v13 offset:22528
    s_waitcnt lgkmcnt(10)
    v_mfma_f32_16x16x32_bf16 v[72:75], v[100:103], v[192:195], v[72:75]
    buffer_store_dwordx4 v[60:63], v4, s[24:27], s32 offen offset:0 sc1
    v_mfma_f32_16x16x32_bf16 v[76:79], v[100:103], v[200:203], v[76:79]
    ds_read_b64_tr_b16 v[124:125], v14 offset:20480
    ds_read_b64_tr_b16 v[126:127], v14 offset:22528
    s_waitcnt lgkmcnt(10)
    v_mfma_f32_16x16x32_bf16 v[80:83], v[104:107], v[192:195], v[80:83]
    v_mfma_f32_16x16x32_bf16 v[84:87], v[104:107], v[200:203], v[84:87]
    ds_read_b64_tr_b16 v[96:97], v11 offset:24576
    ds_read_b64_tr_b16 v[98:99], v11 offset:26624
    s_waitcnt lgkmcnt(10)
    v_mfma_f32_16x16x32_bf16 v[88:91], v[108:111], v[192:195], v[88:91]
    v_mfma_f32_16x16x32_bf16 v[92:95], v[108:111], v[200:203], v[92:95]
    ds_read_b64_tr_b16 v[100:101], v12 offset:24576
    ds_read_b64_tr_b16 v[102:103], v12 offset:26624
    s_waitcnt lgkmcnt(10)
    v_mfma_f32_16x16x32_bf16 v[64:67], v[112:115], v[208:211], v[64:67]
    v_mfma_f32_16x16x32_bf16 v[68:71], v[112:115], v[216:219], v[68:71]
    ds_read_b64_tr_b16 v[104:105], v13 offset:24576
    ds_read_b64_tr_b16 v[106:107], v13 offset:26624
    s_add_u32 s39, s33, 128
    s_mov_b32 m0, s40
    s_add_u32 s40, s40, 32768
    s_cmp_eq_u32 s40, s41
    s_cselect_b32 s40, s35, s40
    buffer_load_dwordx4 v1, s[12:15], s39 offen offset:0 nt lds
    s_add_u32 m0, m0, 1024
    s_waitcnt lgkmcnt(10)
    v_mfma_f32_16x16x32_bf16 v[72:75], v[116:119], v[208:211], v[72:75]
    v_mfma_f32_16x16x32_bf16 v[76:79], v[116:119], v[216:219], v[76:79]
    ds_read_b64_tr_b16 v[108:109], v14 offset:24576
    ds_read_b64_tr_b16 v[110:111], v14 offset:26624
    s_waitcnt lgkmcnt(10)
    v_mfma_f32_16x16x32_bf16 v[80:83], v[120:123], v[208:211], v[80:83]
    v_mfma_f32_16x16x32_bf16 v[84:87], v[120:123], v[216:219], v[84:87]
    ds_read_b64_tr_b16 v[112:113], v11 offset:28672
    ds_read_b64_tr_b16 v[114:115], v11 offset:30720
    s_waitcnt lgkmcnt(10)
    v_mfma_f32_16x16x32_bf16 v[88:91], v[124:127], v[208:211], v[88:91]
    v_mfma_f32_16x16x32_bf16 v[92:95], v[124:127], v[216:219], v[92:95]
    ds_read_b64_tr_b16 v[116:117], v12 offset:28672
    ds_read_b64_tr_b16 v[118:119], v12 offset:30720
    buffer_load_dwordx4 v2, s[12:15], s39 offen offset:0 nt lds
    s_add_u32 m0, m0, 1024
    s_waitcnt lgkmcnt(10)
    v_mfma_f32_16x16x32_bf16 v[64:67], v[96:99], v[224:227], v[64:67]
    v_mfma_f32_16x16x32_bf16 v[68:71], v[96:99], v[232:235], v[68:71]
    ds_read_b64_tr_b16 v[120:121], v13 offset:28672
    ds_read_b64_tr_b16 v[122:123], v13 offset:30720
    s_waitcnt lgkmcnt(10)
    v_mfma_f32_16x16x32_bf16 v[72:75], v[100:103], v[224:227], v[72:75]
    v_mfma_f32_16x16x32_bf16 v[76:79], v[100:103], v[232:235], v[76:79]
    ds_read_b64_tr_b16 v[124:125], v14 offset:28672
    ds_read_b64_tr_b16 v[126:127], v14 offset:30720
    s_waitcnt lgkmcnt(10)
    v_mfma_f32_16x16x32_bf16 v[80:83], v[104:107], v[224:227], v[80:83]
    v_mfma_f32_16x16x32_bf16 v[84:87], v[104:107], v[232:235], v[84:87]
    buffer_load_dwordx4 v3, s[12:15], s39 offen offset:0 nt lds
    s_add_u32 m0, m0, 1024
    s_waitcnt lgkmcnt(8)
    v_mfma_f32_16x16x32_bf16 v[88:91], v[108:111], v[224:227], v[88:91]
    v_mfma_f32_16x16x32_bf16 v[92:95], v[108:111], v[232:235], v[92:95]
    s_waitcnt lgkmcnt(6)
    v_mfma_f32_16x16x32_bf16 v[64:67], v[112:115], v[240:243], v[64:67]
    v_mfma_f32_16x16x32_bf16 v[68:71], v[112:115], v[248:251], v[68:71]
    s_waitcnt lgkmcnt(4)
    v_mfma_f32_16x16x32_bf16 v[72:75], v[116:119], v[240:243], v[72:75]
    v_mfma_f32_16x16x32_bf16 v[76:79], v[116:119], v[248:251], v[76:79]
    s_waitcnt lgkmcnt(2)
    v_mfma_f32_16x16x32_bf16 v[80:83], v[120:123], v[240:243], v[80:83]
    buffer_load_dwordx4 v4, s[12:15], s39 offen offset:0 nt lds
    v_mfma_f32_16x16x32_bf16 v[84:87], v[120:123], v[248:251], v[84:87]
    s_waitcnt lgkmcnt(0)
    v_mfma_f32_16x16x32_bf16 v[88:91], v[124:127], v[240:243], v[88:91]
    v_mfma_f32_16x16x32_bf16 v[92:95], v[124:127], v[248:251], v[92:95]
    v_add_u32 v11, s42, v7
    v_add_u32 v12, s42, v8
    v_add_u32 v13, s42, v9
    v_add_u32 v14, s42, v10
    s_add_u32 s42, s42, 32768
    s_cmp_eq_u32 s42, 163840
    s_cselect_b32 s42, 0, s42
    s_waitcnt vmcnt(16)
    s_barrier
    ds_read_b64_tr_b16 v[96:97], v11 offset:0
    ds_read_b64_tr_b16 v[98:99], v11 offset:2048
    ds_read_b64_tr_b16 v[100:101], v12 offset:0
    ds_read_b64_tr_b16 v[102:103], v12 offset:2048
    ds_read_b64_tr_b16 v[104:105], v13 offset:0
    ds_read_b64_tr_b16 v[106:107], v13 offset:2048
    ds_read_b64_tr_b16 v[108:109], v14 offset:0
    ds_read_b64_tr_b16 v[110:111], v14 offset:2048
    ds_read_b64_tr_b16 v[112:113], v11 offset:4096
    ds_read_b64_tr_b16 v[114:115], v11 offset:6144
    ds_read_b64_tr_b16 v[116:117], v12 offset:4096
    ds_read_b64_tr_b16 v[118:119], v12 offset:6144
    s_waitcnt lgkmcnt(10)
    v_mfma_f32_16x16x32_bf16 v[32:35], v[96:99], v[128:131], 0
    v_add_u32 v21, s40, v15
    v_add_u32 v25, s40, v16
    v_xor_b32 v22, 32, v21
    v_xor_b32 v23, 64, v21
    v_xor_b32 v24, 96, v21
    v_mfma_f32_16x16x32_bf16 v[36:39], v[96:99], v[136:139], 0
    ds_read_b64_tr_b16 v[120:121], v13 offset:4096
    ds_read_b64_tr_b16 v[122:123], v13 offset:6144
    v_mul_f32 v64, v64, v19
    v_mul_f32 v65, v65, v19
    v_mul_f32 v66, v66, v19
    v_mul_f32 v67, v67, v19
    v_cvt_pk_bf16_f32 v64, v64, v65
    s_waitcnt lgkmcnt(10)
    v_mfma_f32_16x16x32_bf16 v[40:43], v[100:103], v[128:131], 0
    v_cvt_pk_bf16_f32 v65, v66, v67
    ds_write_b64 v21, v[64:65] offset:0
    v_mul_f32 v68, v68, v20
    v_mul_f32 v69, v69, v20
    v_mul_f32 v70, v70, v20
    v_mfma_f32_16x16x32_bf16 v[44:47], v[100:103], v[136:139], 0
    ds_read_b64_tr_b16 v[124:125], v14 offset:4096
    ds_read_b64_tr_b16 v[126:127], v14 offset:6144
    v_mul_f32 v71, v71, v20
    v_cvt_pk_bf16_f32 v68, v68, v69
    v_cvt_pk_bf16_f32 v69, v70, v71
    ds_write_b64 v21, v[68:69] offset:2048
    v_mul_f32 v72, v72, v19
    s_waitcnt lgkmcnt(12)
    v_mfma_f32_16x16x32_bf16 v[48:51], v[104:107], v[128:131], 0
    v_mul_f32 v73, v73, v19
    v_mul_f32 v74, v74, v19
    v_mul_f32 v75, v75, v19
    v_cvt_pk_bf16_f32 v72, v72, v73
    v_cvt_pk_bf16_f32 v73, v74, v75
    v_mfma_f32_16x16x32_bf16 v[52:55], v[104:107], v[136:139], 0
    ds_read_b64_tr_b16 v[96:97], v11 offset:8192
    ds_read_b64_tr_b16 v[98:99], v11 offset:10240
    ds_write_b64 v22, v[72:73] offset:0
    v_mul_f32 v76, v76, v20
    v_mul_f32 v77, v77, v20
    v_mul_f32 v78, v78, v20
    v_mul_f32 v79, v79, v20
    s_waitcnt lgkmcnt(13)
    v_mfma_f32_16x16x32_bf16 v[56:59], v[108:111], v[128:131], 0
    v_cvt_pk_bf16_f32 v76, v76, v77
    v_cvt_pk_bf16_f32 v77, v78, v79
    ds_write_b64 v22, v[76:77] offset:2048
    v_mul_f32 v80, v80, v19
    v_mul_f32 v81, v81, v19
    v_mfma_f32_16x16x32_bf16 v[60:63], v[108:111], v[136:139], 0
    ds_read_b64_tr_b16 v[100:101], v12 offset:8192
    s_waitcnt lgkmcnt(14)
    ds_read_b64_tr_b16 v[102:103], v12 offset:10240
    v_mul_f32 v82, v82, v19
    v_mul_f32 v83, v83, v19
    v_cvt_pk_bf16_f32 v80, v80, v81
    v_cvt_pk_bf16_f32 v81, v82, v83
    s_waitcnt lgkmcnt(14)
    ds_write_b64 v23, v[80:81] offset:0
    v_mfma_f32_16x16x32_bf16 v[32:35], v[112:115], v[144:147], v[32:35]
    v_mul_f32 v84, v84, v20
    v_mul_f32 v85, v85, v20
    v_mul_f32 v86, v86, v20
    v_mul_f32 v87, v87, v20
    v_cvt_pk_bf16_f32 v84, v84, v85
    v_mfma_f32_16x16x32_bf16 v[36:39], v[112:115], v[152:155], v[36:39]
    s_waitcnt lgkmcnt(14)
    ds_read_b64_tr_b16 v[104:105], v13 offset:8192
    s_waitcnt lgkmcnt(14)
    ds_read_b64_tr_b16 v[106:107], v13 offset:10240
    v_cvt_pk_bf16_f32 v85, v86, v87
    s_waitcnt lgkmcnt(14)
    ds_write_b64 v23, v[84:85] offset:2048
    v_mul_f32 v88, v88, v19
    v_mul_f32 v89, v89, v19
    v_mul_f32 v90, v90, v19
    v_mfma_f32_16x16x32_bf16 v[40:43], v[116:119], v[144:147], v[40:43]
    v_mul_f32 v91, v91, v19
    v_cvt_pk_bf16_f32 v88, v88, v89
    v_cvt_pk_bf16_f32 v89, v90, v91
    s_waitcnt lgkmcnt(14)
    ds_write_b64 v24, v[88:89] offset:0
    v_mul_f32 v92, v92, v20
    v_mfma_f32_16x16x32_bf16 v[44:47], v[116:119], v[152:155], v[44:47]
    s_waitcnt lgkmcnt(14)
    ds_read_b64_tr_b16 v[108:109], v14 offset:8192
    s_waitcnt lgkmcnt(14)
    ds_read_b64_tr_b16 v[110:111], v14 offset:10240
    v_mul_f32 v93, v93, v20
    v_mul_f32 v94, v94, v20
    v_mul_f32 v95, v95, v20
    v_cvt_pk_bf16_f32 v92, v92, v93
    v_cvt_pk_bf16_f32 v93, v94, v95
    v_mfma_f32_16x16x32_bf16 v[48:51], v[120:123], v[144:147], v[48:51]
    s_waitcnt lgkmcnt(14)
    ds_write_b64 v24, v[92:93] offset:2048
    v_mfma_f32_16x16x32_bf16 v[52:55], v[120:123], v[152:155], v[52:55]
    s_waitcnt lgkmcnt(14)
    ds_read_b64_tr_b16 v[112:113], v11 offset:12288
    s_waitcnt lgkmcnt(14)
    ds_read_b64_tr_b16 v[114:115], v11 offset:14336
    s_waitcnt lgkmcnt(14)
    ds_read_b128 v[80:83], v25 offset:0
    s_waitcnt lgkmcnt(14)
    ds_read_b128 v[84:87], v25 offset:1024
    s_waitcnt lgkmcnt(14)
    ds_read_b128 v[88:91], v25 offset:2048
    s_waitcnt lgkmcnt(14)
    ds_read_b128 v[92:95], v25 offset:3072
    v_mfma_f32_16x16x32_bf16 v[56:59], v[124:127], v[144:147], v[56:59]
    v_mfma_f32_16x16x32_bf16 v[60:63], v[124:127], v[152:155], v[60:63]
    s_waitcnt lgkmcnt(14)
    ds_read_b64_tr_b16 v[116:117], v12 offset:12288
    s_waitcnt lgkmcnt(14)
    ds_read_b64_tr_b16 v[118:119], v12 offset:14336
    v_mfma_f32_16x16x32_bf16 v[32:35], v[96:99], v[160:163], v[32:35]
    s_waitcnt lgkmcnt(5)
    buffer_store_dwordx4 v[80:83], v1, s[24:27], s32 offen offset:128 sc1
    v_mfma_f32_16x16x32_bf16 v[36:39], v[96:99], v[168:171], v[36:39]
    ds_read_b64_tr_b16 v[120:121], v13 offset:12288
    ds_read_b64_tr_b16 v[122:123], v13 offset:14336
    v_mfma_f32_16x16x32_bf16 v[40:43], v[100:103], v[160:163], v[40:43]
    v_mfma_f32_16x16x32_bf16 v[44:47], v[100:103], v[168:171], v[44:47]
    ds_read_b64_tr_b16 v[124:125], v14 offset:12288
    ds_read_b64_tr_b16 v[126:127], v14 offset:14336
    v_mfma_f32_16x16x32_bf16 v[48:51], v[104:107], v[160:163], v[48:51]
    v_mfma_f32_16x16x32_bf16 v[52:55], v[104:107], v[168:171], v[52:55]
    ds_read_b64_tr_b16 v[96:97], v11 offset:16384
    ds_read_b64_tr_b16 v[98:99], v11 offset:18432
    v_mfma_f32_16x16x32_bf16 v[56:59], v[108:111], v[160:163], v[56:59]
    s_waitcnt lgkmcnt(10)
    buffer_store_dwordx4 v[84:87], v2, s[24:27], s32 offen offset:128 sc1
    v_mfma_f32_16x16x32_bf16 v[60:63], v[108:111], v[168:171], v[60:63]
    ds_read_b64_tr_b16 v[100:101], v12 offset:16384
    ds_read_b64_tr_b16 v[102:103], v12 offset:18432
    v_mfma_f32_16x16x32_bf16 v[32:35], v[112:115], v[176:179], v[32:35]
    v_mfma_f32_16x16x32_bf16 v[36:39], v[112:115], v[184:187], v[36:39]
    ds_read_b64_tr_b16 v[104:105], v13 offset:16384
    ds_read_b64_tr_b16 v[106:107], v13 offset:18432
    s_waitcnt lgkmcnt(10)
    v_mfma_f32_16x16x32_bf16 v[40:43], v[116:119], v[176:179], v[40:43]
    v_mfma_f32_16x16x32_bf16 v[44:47], v[116:119], v[184:187], v[44:47]
    ds_read_b64_tr_b16 v[108:109], v14 offset:16384
    ds_read_b64_tr_b16 v[110:111], v14 offset:18432
    s_waitcnt lgkmcnt(10)
    v_mfma_f32_16x16x32_bf16 v[48:51], v[120:123], v[176:179], v[48:51]
    buffer_store_dwordx4 v[88:91], v3, s[24:27], s32 offen offset:128 sc1
    v_mfma_f32_16x16x32_bf16 v[52:55], v[120:123], v[184:187], v[52:55]
    ds_read_b64_tr_b16 v[112:113], v11 offset:20480
    ds_read_b64_tr_b16 v[114:115], v11 offset:22528
    s_waitcnt lgkmcnt(10)
    v_mfma_f32_16x16x32_bf16 v[56:59], v[124:127], v[176:179], v[56:59]
    v_mfma_f32_16x16x32_bf16 v[60:63], v[124:127], v[184:187], v[60:63]
    ds_read_b64_tr_b16 v[116:117], v12 offset:20480
    ds_read_b64_tr_b16 v[118:119], v12 offset:22528
    s_waitcnt lgkmcnt(10)
    v_mfma_f32_16x16x32_bf16 v[32:35], v[96:99], v[192:195], v[32:35]
    v_mfma_f32_16x16x32_bf16 v[36:39], v[96:99], v[200:203], v[36:39]
    ds_read_b64_tr_b16 v[120:121], v13 offset:20480
    ds_read_b64_tr_b16 v[122:123], v13 offset:22528
    s_waitcnt lgkmcnt(10)
    v_mfma_f32_16x16x32_bf16 v[40:43], v[100:103], v[192:195], v[40:43]
    buffer_store_dwordx4 v[92:95], v4, s[24:27], s32 offen offset:128 sc1
    v_mfma_f32_16x16x32_bf16 v[44:47], v[100:103], v[200:203], v[44:47]
    ds_read_b64_tr_b16 v[124:125], v14 offset:20480
    ds_read_b64_tr_b16 v[126:127], v14 offset:22528
    s_waitcnt lgkmcnt(10)
    v_mfma_f32_16x16x32_bf16 v[48:51], v[104:107], v[192:195], v[48:51]
    v_mfma_f32_16x16x32_bf16 v[52:55], v[104:107], v[200:203], v[52:55]
    ds_read_b64_tr_b16 v[96:97], v11 offset:24576
    ds_read_b64_tr_b16 v[98:99], v11 offset:26624
    s_waitcnt lgkmcnt(10)
    v_mfma_f32_16x16x32_bf16 v[56:59], v[108:111], v[192:195], v[56:59]
    v_mfma_f32_16x16x32_bf16 v[60:63], v[108:111], v[200:203], v[60:63]
    ds_read_b64_tr_b16 v[100:101], v12 offset:24576
    ds_read_b64_tr_b16 v[102:103], v12 offset:26624
    s_waitcnt lgkmcnt(10)
    v_mfma_f32_16x16x32_bf16 v[32:35], v[112:115], v[208:211], v[32:35]
    v_mfma_f32_16x16x32_bf16 v[36:39], v[112:115], v[216:219], v[36:39]
    ds_read_b64_tr_b16 v[104:105], v13 offset:24576
    ds_read_b64_tr_b16 v[106:107], v13 offset:26624
    s_add_u32 s39, s33, 128
    s_mov_b32 m0, s40
    s_add_u32 s40, s40, 32768
    s_cmp_eq_u32 s40, s41
    s_cselect_b32 s40, s35, s40
    buffer_load_dwordx4 v1, s[16:19], s39 offen offset:0 nt lds
    s_add_u32 m0, m0, 1024
    s_waitcnt lgkmcnt(10)
    v_mfma_f32_16x16x32_bf16 v[40:43], v[116:119], v[208:211], v[40:43]
    v_mfma_f32_16x16x32_bf16 v[44:47], v[116:119], v[216:219], v[44:47]
    ds_read_b64_tr_b16 v[108:109], v14 offset:24576
    ds_read_b64_tr_b16 v[110:111], v14 offset:26624
    s_waitcnt lgkmcnt(10)
    v_mfma_f32_16x16x32_bf16 v[48:51], v[120:123], v[208:211], v[48:51]
    v_mfma_f32_16x16x32_bf16 v[52:55], v[120:123], v[216:219], v[52:55]
    ds_read_b64_tr_b16 v[112:113], v11 offset:28672
    ds_read_b64_tr_b16 v[114:115], v11 offset:30720
    s_waitcnt lgkmcnt(10)
    v_mfma_f32_16x16x32_bf16 v[56:59], v[124:127], v[208:211], v[56:59]
    v_mfma_f32_16x16x32_bf16 v[60:63], v[124:127], v[216:219], v[60:63]
    ds_read_b64_tr_b16 v[116:117], v12 offset:28672
    ds_read_b64_tr_b16 v[118:119], v12 offset:30720
    buffer_load_dwordx4 v2, s[16:19], s39 offen offset:0 nt lds
    s_add_u32 m0, m0, 1024
    s_waitcnt lgkmcnt(10)
    v_mfma_f32_16x16x32_bf16 v[32:35], v[96:99], v[224:227], v[32:35]
    v_mfma_f32_16x16x32_bf16 v[36:39], v[96:99], v[232:235], v[36:39]
    ds_read_b64_tr_b16 v[120:121], v13 offset:28672
    ds_read_b64_tr_b16 v[122:123], v13 offset:30720
    s_waitcnt lgkmcnt(10)
    v_mfma_f32_16x16x32_bf16 v[40:43], v[100:103], v[224:227], v[40:43]
    v_mfma_f32_16x16x32_bf16 v[44:47], v[100:103], v[232:235], v[44:47]
    ds_read_b64_tr_b16 v[124:125], v14 offset:28672
    ds_read_b64_tr_b16 v[126:127], v14 offset:30720
    s_waitcnt lgkmcnt(10)
    v_mfma_f32_16x16x32_bf16 v[48:51], v[104:107], v[224:227], v[48:51]
    v_mfma_f32_16x16x32_bf16 v[52:55], v[104:107], v[232:235], v[52:55]
    buffer_load_dwordx4 v3, s[16:19], s39 offen offset:0 nt lds
    s_add_u32 m0, m0, 1024
    s_waitcnt lgkmcnt(8)
    v_mfma_f32_16x16x32_bf16 v[56:59], v[108:111], v[224:227], v[56:59]
    v_mfma_f32_16x16x32_bf16 v[60:63], v[108:111], v[232:235], v[60:63]
    s_waitcnt lgkmcnt(6)
    v_mfma_f32_16x16x32_bf16 v[32:35], v[112:115], v[240:243], v[32:35]
    v_mfma_f32_16x16x32_bf16 v[36:39], v[112:115], v[248:251], v[36:39]
    s_waitcnt lgkmcnt(4)
    v_mfma_f32_16x16x32_bf16 v[40:43], v[116:119], v[240:243], v[40:43]
    v_mfma_f32_16x16x32_bf16 v[44:47], v[116:119], v[248:251], v[44:47]
    s_waitcnt lgkmcnt(2)
    v_mfma_f32_16x16x32_bf16 v[48:51], v[120:123], v[240:243], v[48:51]
    buffer_load_dwordx4 v4, s[16:19], s39 offen offset:0 nt lds
    v_mfma_f32_16x16x32_bf16 v[52:55], v[120:123], v[248:251], v[52:55]
    s_waitcnt lgkmcnt(0)
    v_mfma_f32_16x16x32_bf16 v[56:59], v[124:127], v[240:243], v[56:59]
    v_mfma_f32_16x16x32_bf16 v[60:63], v[124:127], v[248:251], v[60:63]
    s_add_u32 s28, s42, s35
    s_add_u32 s42, s42, 32768
    s_cmp_eq_u32 s42, 163840
    s_cselect_b32 s42, 0, s42
    v_add_u32 v13, s28, v5
    v_add_u32 v11, s42, v5
    v_add_u32 v14, s28, v6
    v_add_u32 v12, s42, v6
    s_add_u32 s42, s42, 32768
    s_cmp_eq_u32 s42, 163840
    s_cselect_b32 s42, 0, s42
    s_waitcnt vmcnt(16)
    s_barrier
    ds_read_b128 v[96:99], v13 offset:0
    ds_read_b128 v[64:67], v11 offset:0
    ds_read_b128 v[100:103], v13 offset:2048
    ds_read_b128 v[68:71], v11 offset:2048
    ds_read_b128 v[72:75], v11 offset:4096
    ds_read_b128 v[76:79], v11 offset:6144
    ds_read_b128 v[80:83], v11 offset:8192
    ds_read_b128 v[84:87], v11 offset:10240
    ds_read_b128 v[88:91], v11 offset:12288
    ds_read_b128 v[92:95], v11 offset:14336
    ds_read_b128 v[104:107], v14 offset:0
    s_mov_b32 s34, s32
    s_mov_b32 s32, s33
    s_add_u32 s36, s36, 1
    s_add_u32 s3, s36, 1
    s_mul_i32 s31, s3, 33
    s_xor_b32 s31, s31, s30
    s_lshl_b32 s3, s3, 8
    s_add_u32 s31, s31, s3
    s_mul_i32 s33, s31, 98304
    s_waitcnt lgkmcnt(9)
    v_mfma_f32_16x16x32_bf16 v[128:131], v[64:67], v[96:99], 0
    v_add_u32 v21, s40, v15
    v_add_u32 v25, s40, v16
    v_xor_b32 v22, 32, v21
    v_xor_b32 v23, 64, v21
    v_xor_b32 v24, 96, v21
    s_waitcnt lgkmcnt(8)
    v_mfma_f32_16x16x32_bf16 v[136:139], v[64:67], v[100:103], 0
    ds_read_b128 v[112:115], v12 offset:0
    ds_read_b128 v[108:111], v14 offset:2048
    v_mul_f32 v32, v32, v19
    v_mul_f32 v33, v33, v19
    v_mul_f32 v34, v34, v19
    v_mul_f32 v35, v35, v19
    v_cvt_pk_bf16_f32 v32, v32, v33
    s_waitcnt lgkmcnt(9)
    v_mfma_f32_16x16x32_bf16 v[132:135], v[68:71], v[96:99], 0
    v_cvt_pk_bf16_f32 v33, v34, v35
    ds_write_b64 v21, v[32:33] offset:0
    v_mul_f32 v36, v36, v20
    v_mul_f32 v37, v37, v20
    v_mul_f32 v38, v38, v20
    v_mfma_f32_16x16x32_bf16 v[140:143], v[68:71], v[100:103], 0
    ds_read_b128 v[116:119], v12 offset:2048
    v_mul_f32 v39, v39, v20
    v_cvt_pk_bf16_f32 v36, v36, v37
    v_cvt_pk_bf16_f32 v37, v38, v39
    ds_write_b64 v21, v[36:37] offset:2048
    v_mul_f32 v40, v40, v19
    s_waitcnt lgkmcnt(11)
    v_mfma_f32_16x16x32_bf16 v[144:147], v[72:75], v[96:99], 0
    v_mul_f32 v41, v41, v19
    v_mul_f32 v42, v42, v19
    v_mul_f32 v43, v43, v19
    v_cvt_pk_bf16_f32 v40, v40, v41
    v_cvt_pk_bf16_f32 v41, v42, v43
    v_mfma_f32_16x16x32_bf16 v[152:155], v[72:75], v[100:103], 0
    ds_read_b128 v[120:123], v12 offset:4096
    ds_write_b64 v22, v[40:41] offset:0
    v_mul_f32 v44, v44, v20
    v_mul_f32 v45, v45, v20
    v_mul_f32 v46, v46, v20
    v_mul_f32 v47, v47, v20
    s_waitcnt lgkmcnt(12)
    v_mfma_f32_16x16x32_bf16 v[148:151], v[76:79], v[96:99], 0
    v_cvt_pk_bf16_f32 v44, v44, v45
    v_cvt_pk_bf16_f32 v45, v46, v47
    ds_write_b64 v22, v[44:45] offset:2048
    v_mul_f32 v48, v48, v19
    v_mul_f32 v49, v49, v19
    v_mfma_f32_16x16x32_bf16 v[156:159], v[76:79], v[100:103], 0
    ds_read_b128 v[124:127], v12 offset:6144
    v_mul_f32 v50, v50, v19
    v_mul_f32 v51, v51, v19
    v_cvt_pk_bf16_f32 v48, v48, v49
    v_cvt_pk_bf16_f32 v49, v50, v51
    ds_write_b64 v23, v[48:49] offset:0
    s_waitcnt lgkmcnt(14)
    v_mfma_f32_16x16x32_bf16 v[160:163], v[80:83], v[96:99], 0
    v_mul_f32 v52, v52, v20
    v_mul_f32 v53, v53, v20
    v_mul_f32 v54, v54, v20
    v_mul_f32 v55, v55, v20
    v_cvt_pk_bf16_f32 v52, v52, v53
    v_mfma_f32_16x16x32_bf16 v[168:171], v[80:83], v[100:103], 0
    ds_read_b128 v[64:67], v12 offset:8192
    v_cvt_pk_bf16_f32 v53, v54, v55
    s_waitcnt lgkmcnt(14)
    ds_write_b64 v23, v[52:53] offset:2048
    v_mul_f32 v56, v56, v19
    v_mul_f32 v57, v57, v19
    v_mul_f32 v58, v58, v19
    v_mfma_f32_16x16x32_bf16 v[164:167], v[84:87], v[96:99], 0
    v_mul_f32 v59, v59, v19
    v_cvt_pk_bf16_f32 v56, v56, v57
    v_cvt_pk_bf16_f32 v57, v58, v59
    s_waitcnt lgkmcnt(14)
    ds_write_b64 v24, v[56:57] offset:0
    v_mul_f32 v60, v60, v20
    v_mfma_f32_16x16x32_bf16 v[172:175], v[84:87], v[100:103], 0
    s_waitcnt lgkmcnt(14)
    ds_read_b128 v[68:71], v12 offset:10240
    v_mul_f32 v61, v61, v20
    v_mul_f32 v62, v62, v20
    v_mul_f32 v63, v63, v20
    v_cvt_pk_bf16_f32 v60, v60, v61
    v_cvt_pk_bf16_f32 v61, v62, v63
    v_mfma_f32_16x16x32_bf16 v[176:179], v[88:91], v[96:99], 0
    s_waitcnt lgkmcnt(14)
    ds_write_b64 v24, v[60:61] offset:2048
    v_mfma_f32_16x16x32_bf16 v[184:187], v[88:91], v[100:103], 0
    s_waitcnt lgkmcnt(14)
    ds_read_b128 v[72:75], v12 offset:12288
    s_waitcnt lgkmcnt(14)
    ds_read_b128 v[48:51], v25 offset:0
    s_waitcnt lgkmcnt(14)
    ds_read_b128 v[52:55], v25 offset:1024
    s_waitcnt lgkmcnt(14)
    ds_read_b128 v[56:59], v25 offset:2048
    s_waitcnt lgkmcnt(14)
    ds_read_b128 v[60:63], v25 offset:3072
    v_mfma_f32_16x16x32_bf16 v[180:183], v[92:95], v[96:99], 0
    v_mfma_f32_16x16x32_bf16 v[188:191], v[92:95], v[100:103], 0
    s_waitcnt lgkmcnt(14)
    ds_read_b128 v[76:79], v12 offset:14336
    v_mfma_f32_16x16x32_bf16 v[128:131], v[112:115], v[104:107], v[128:131]
    s_waitcnt lgkmcnt(1)
    s_add_u32 s39, s32, 256
    s_mov_b32 m0, s40
    s_add_u32 s40, s40, 32768
    s_cmp_eq_u32 s40, s41
    s_cselect_b32 s40, s35, s40
    buffer_load_dwordx4 v1, s[12:15], s39 offen offset:0 nt lds
    s_add_u32 m0, m0, 1024
    v_mfma_f32_16x16x32_bf16 v[136:139], v[112:115], v[108:111], v[136:139]
    ds_read_b128 v[80:83], v11 offset:16384
    v_mfma_f32_16x16x32_bf16 v[132:135], v[116:119], v[104:107], v[132:135]
    v_mfma_f32_16x16x32_bf16 v[140:143], v[116:119], v[108:111], v[140:143]
    ds_read_b128 v[84:87], v11 offset:18432
    v_mfma_f32_16x16x32_bf16 v[144:147], v[120:123], v[104:107], v[144:147]
    v_mfma_f32_16x16x32_bf16 v[152:155], v[120:123], v[108:111], v[152:155]
    ds_read_b128 v[88:91], v11 offset:20480
    v_mfma_f32_16x16x32_bf16 v[148:151], v[124:127], v[104:107], v[148:151]
    buffer_load_dwordx4 v2, s[12:15], s39 offen offset:0 nt lds
    s_add_u32 m0, m0, 1024
    v_mfma_f32_16x16x32_bf16 v[156:159], v[124:127], v[108:111], v[156:159]
    ds_read_b128 v[92:95], v11 offset:22528
    v_mfma_f32_16x16x32_bf16 v[160:163], v[64:67], v[104:107], v[160:163]
    v_mfma_f32_16x16x32_bf16 v[168:171], v[64:67], v[108:111], v[168:171]
    ds_read_b128 v[112:115], v11 offset:24576
    v_mfma_f32_16x16x32_bf16 v[164:167], v[68:71], v[104:107], v[164:167]
    v_mfma_f32_16x16x32_bf16 v[172:175], v[68:71], v[108:111], v[172:175]
    ds_read_b128 v[116:119], v11 offset:26624
    v_mfma_f32_16x16x32_bf16 v[176:179], v[72:75], v[104:107], v[176:179]
    buffer_load_dwordx4 v3, s[12:15], s39 offen offset:0 nt lds
    s_add_u32 m0, m0, 1024
    v_mfma_f32_16x16x32_bf16 v[184:187], v[72:75], v[108:111], v[184:187]
    ds_read_b128 v[120:123], v11 offset:28672
    s_waitcnt lgkmcnt(7)
    v_mfma_f32_16x16x32_bf16 v[180:183], v[76:79], v[104:107], v[180:183]
    v_mfma_f32_16x16x32_bf16 v[188:191], v[76:79], v[108:111], v[188:191]
    ds_read_b128 v[124:127], v11 offset:30720
    s_waitcnt lgkmcnt(7)
    v_mfma_f32_16x16x32_bf16 v[192:195], v[80:83], v[96:99], 0
    v_mfma_f32_16x16x32_bf16 v[200:203], v[80:83], v[100:103], 0
    ds_read_b128 v[64:67], v12 offset:16384
    s_waitcnt lgkmcnt(7)
    v_mfma_f32_16x16x32_bf16 v[196:199], v[84:87], v[96:99], 0
    buffer_load_dwordx4 v4, s[12:15], s39 offen offset:0 nt lds
    v_mfma_f32_16x16x32_bf16 v[204:207], v[84:87], v[100:103], 0
    ds_read_b128 v[68:71], v12 offset:18432
    s_waitcnt lgkmcnt(7)
    v_mfma_f32_16x16x32_bf16 v[208:211], v[88:91], v[96:99], 0
    v_mfma_f32_16x16x32_bf16 v[216:219], v[88:91], v[100:103], 0
    ds_read_b128 v[72:75], v12 offset:20480
    s_waitcnt lgkmcnt(7)
    v_mfma_f32_16x16x32_bf16 v[212:215], v[92:95], v[96:99], 0
    v_mfma_f32_16x16x32_bf16 v[220:223], v[92:95], v[100:103], 0
    ds_read_b128 v[76:79], v12 offset:22528
    s_waitcnt lgkmcnt(7)
    v_mfma_f32_16x16x32_bf16 v[224:227], v[112:115], v[96:99], 0
    v_mfma_f32_16x16x32_bf16 v[232:235], v[112:115], v[100:103], 0
    ds_read_b128 v[80:83], v12 offset:24576
    s_add_u32 s39, s32, 256
    s_mov_b32 m0, s40
    s_add_u32 s40, s40, 32768
    s_cmp_eq_u32 s40, s41
    s_cselect_b32 s40, s35, s40
    buffer_load_dwordx4 v1, s[16:19], s39 offen offset:0 nt lds
    s_add_u32 m0, m0, 1024
    s_waitcnt lgkmcnt(7)
    v_mfma_f32_16x16x32_bf16 v[228:231], v[116:119], v[96:99], 0
    v_mfma_f32_16x16x32_bf16 v[236:239], v[116:119], v[100:103], 0
    ds_read_b128 v[84:87], v12 offset:26624
    s_waitcnt lgkmcnt(7)
    v_mfma_f32_16x16x32_bf16 v[240:243], v[120:123], v[96:99], 0
    v_mfma_f32_16x16x32_bf16 v[248:251], v[120:123], v[100:103], 0
    ds_read_b128 v[88:91], v12 offset:28672
    s_waitcnt lgkmcnt(7)
    v_mfma_f32_16x16x32_bf16 v[244:247], v[124:127], v[96:99], 0
    v_mfma_f32_16x16x32_bf16 v[252:255], v[124:127], v[100:103], 0
    ds_read_b128 v[92:95], v12 offset:30720
    buffer_load_dwordx4 v2, s[16:19], s39 offen offset:0 nt lds
    s_add_u32 m0, m0, 1024
    s_waitcnt lgkmcnt(7)
    v_mfma_f32_16x16x32_bf16 v[192:195], v[64:67], v[104:107], v[192:195]
    v_mfma_f32_16x16x32_bf16 v[200:203], v[64:67], v[108:111], v[200:203]
    s_waitcnt lgkmcnt(6)
    v_mfma_f32_16x16x32_bf16 v[196:199], v[68:71], v[104:107], v[196:199]
    v_mfma_f32_16x16x32_bf16 v[204:207], v[68:71], v[108:111], v[204:207]
    s_waitcnt lgkmcnt(5)
    v_mfma_f32_16x16x32_bf16 v[208:211], v[72:75], v[104:107], v[208:211]
    v_mfma_f32_16x16x32_bf16 v[216:219], v[72:75], v[108:111], v[216:219]
    buffer_load_dwordx4 v3, s[16:19], s39 offen offset:0 nt lds
    s_add_u32 m0, m0, 1024
    s_waitcnt lgkmcnt(4)
    v_mfma_f32_16x16x32_bf16 v[212:215], v[76:79], v[104:107], v[212:215]
    v_mfma_f32_16x16x32_bf16 v[220:223], v[76:79], v[108:111], v[220:223]
    s_waitcnt lgkmcnt(3)
    v_mfma_f32_16x16x32_bf16 v[224:227], v[80:83], v[104:107], v[224:227]
    v_mfma_f32_16x16x32_bf16 v[232:235], v[80:83], v[108:111], v[232:235]
    s_waitcnt lgkmcnt(2)
    v_mfma_f32_16x16x32_bf16 v[228:231], v[84:87], v[104:107], v[228:231]
    v_mfma_f32_16x16x32_bf16 v[236:239], v[84:87], v[108:111], v[236:239]
    s_waitcnt lgkmcnt(1)
    v_mfma_f32_16x16x32_bf16 v[240:243], v[88:91], v[104:107], v[240:243]
    buffer_load_dwordx4 v4, s[16:19], s39 offen offset:0 nt lds
    v_mfma_f32_16x16x32_bf16 v[248:251], v[88:91], v[108:111], v[248:251]
    s_waitcnt lgkmcnt(0)
    v_mfma_f32_16x16x32_bf16 v[244:247], v[92:95], v[104:107], v[244:247]
    v_mfma_f32_16x16x32_bf16 v[252:255], v[92:95], v[108:111], v[252:255]
    s_add_u32 s28, s42, s35
    s_add_u32 s42, s42, 32768
    s_cmp_eq_u32 s42, 163840
    s_cselect_b32 s42, 0, s42
    v_add_u32 v13, s28, v5
    v_add_u32 v11, s42, v5
    v_add_u32 v14, s28, v6
    v_add_u32 v12, s42, v6
    s_add_u32 s42, s42, 32768
    s_cmp_eq_u32 s42, 163840
    s_cselect_b32 s42, 0, s42
    s_waitcnt vmcnt(8)
    s_barrier
    ds_read_b128 v[96:99], v13 offset:0
    ds_read_b128 v[112:115], v11 offset:0
    ds_read_b128 v[100:103], v13 offset:2048
    ds_read_b128 v[116:119], v11 offset:2048
    ds_read_b128 v[120:123], v11 offset:4096
    ds_read_b128 v[124:127], v11 offset:6144
    ds_read_b128 v[64:67], v11 offset:8192
    ds_read_b128 v[68:71], v11 offset:10240
    ds_read_b128 v[72:75], v11 offset:12288
    ds_read_b128 v[76:79], v11 offset:14336
    ds_read_b128 v[104:107], v14 offset:0
    s_waitcnt lgkmcnt(9)
    v_mfma_f32_16x16x32_bf16 v[128:131], v[112:115], v[96:99], v[128:131]
    s_waitcnt lgkmcnt(8)
    v_mfma_f32_16x16x32_bf16 v[136:139], v[112:115], v[100:103], v[136:139]
    ds_read_b128 v[80:83], v12 offset:0
    ds_read_b128 v[108:111], v14 offset:2048
    buffer_store_dwordx4 v[48:51], v1, s[24:27], s34 offen offset:256 sc1
    s_waitcnt lgkmcnt(9)
    v_mfma_f32_16x16x32_bf16 v[132:135], v[116:119], v[96:99], v[132:135]
    v_mfma_f32_16x16x32_bf16 v[140:143], v[116:119], v[100:103], v[140:143]
    ds_read_b128 v[84:87], v12 offset:2048
    s_waitcnt lgkmcnt(9)
    v_mfma_f32_16x16x32_bf16 v[144:147], v[120:123], v[96:99], v[144:147]
    v_mfma_f32_16x16x32_bf16 v[152:155], v[120:123], v[100:103], v[152:155]
    ds_read_b128 v[88:91], v12 offset:4096
    s_waitcnt lgkmcnt(9)
    v_mfma_f32_16x16x32_bf16 v[148:151], v[124:127], v[96:99], v[148:151]
    v_mfma_f32_16x16x32_bf16 v[156:159], v[124:127], v[100:103], v[156:159]
    ds_read_b128 v[92:95], v12 offset:6144
    s_waitcnt lgkmcnt(9)
    v_mfma_f32_16x16x32_bf16 v[160:163], v[64:67], v[96:99], v[160:163]
    v_mfma_f32_16x16x32_bf16 v[168:171], v[64:67], v[100:103], v[168:171]
    ds_read_b128 v[112:115], v12 offset:8192
    buffer_store_dwordx4 v[52:55], v2, s[24:27], s34 offen offset:256 sc1
    s_waitcnt lgkmcnt(9)
    v_mfma_f32_16x16x32_bf16 v[164:167], v[68:71], v[96:99], v[164:167]
    v_mfma_f32_16x16x32_bf16 v[172:175], v[68:71], v[100:103], v[172:175]
    ds_read_b128 v[116:119], v12 offset:10240
    s_waitcnt lgkmcnt(9)
    v_mfma_f32_16x16x32_bf16 v[176:179], v[72:75], v[96:99], v[176:179]
    v_mfma_f32_16x16x32_bf16 v[184:187], v[72:75], v[100:103], v[184:187]
    ds_read_b128 v[120:123], v12 offset:12288
    s_waitcnt lgkmcnt(9)
    v_mfma_f32_16x16x32_bf16 v[180:183], v[76:79], v[96:99], v[180:183]
    v_mfma_f32_16x16x32_bf16 v[188:191], v[76:79], v[100:103], v[188:191]
    ds_read_b128 v[124:127], v12 offset:14336
    s_waitcnt lgkmcnt(8)
    v_mfma_f32_16x16x32_bf16 v[128:131], v[80:83], v[104:107], v[128:131]
    s_waitcnt lgkmcnt(7)
    v_mfma_f32_16x16x32_bf16 v[136:139], v[80:83], v[108:111], v[136:139]
    ds_read_b128 v[64:67], v11 offset:16384
    buffer_store_dwordx4 v[56:59], v3, s[24:27], s34 offen offset:256 sc1
    s_waitcnt lgkmcnt(7)
    v_mfma_f32_16x16x32_bf16 v[132:135], v[84:87], v[104:107], v[132:135]
    v_mfma_f32_16x16x32_bf16 v[140:143], v[84:87], v[108:111], v[140:143]
    ds_read_b128 v[68:71], v11 offset:18432
    s_waitcnt lgkmcnt(7)
    v_mfma_f32_16x16x32_bf16 v[144:147], v[88:91], v[104:107], v[144:147]
    v_mfma_f32_16x16x32_bf16 v[152:155], v[88:91], v[108:111], v[152:155]
    ds_read_b128 v[72:75], v11 offset:20480
    s_waitcnt lgkmcnt(7)
    v_mfma_f32_16x16x32_bf16 v[148:151], v[92:95], v[104:107], v[148:151]
    v_mfma_f32_16x16x32_bf16 v[156:159], v[92:95], v[108:111], v[156:159]
    ds_read_b128 v[76:79], v11 offset:22528
    s_waitcnt lgkmcnt(7)
    v_mfma_f32_16x16x32_bf16 v[160:163], v[112:115], v[104:107], v[160:163]
    v_mfma_f32_16x16x32_bf16 v[168:171], v[112:115], v[108:111], v[168:171]
    ds_read_b128 v[80:83], v11 offset:24576
    s_waitcnt lgkmcnt(7)
    v_mfma_f32_16x16x32_bf16 v[164:167], v[116:119], v[104:107], v[164:167]
    buffer_store_dwordx4 v[60:63], v4, s[24:27], s34 offen offset:256 sc1
    v_mfma_f32_16x16x32_bf16 v[172:175], v[116:119], v[108:111], v[172:175]
    ds_read_b128 v[84:87], v11 offset:26624
    s_waitcnt lgkmcnt(7)
    v_mfma_f32_16x16x32_bf16 v[176:179], v[120:123], v[104:107], v[176:179]
    v_mfma_f32_16x16x32_bf16 v[184:187], v[120:123], v[108:111], v[184:187]
    ds_read_b128 v[88:91], v11 offset:28672
    s_waitcnt lgkmcnt(7)
    v_mfma_f32_16x16x32_bf16 v[180:183], v[124:127], v[104:107], v[180:183]
    v_mfma_f32_16x16x32_bf16 v[188:191], v[124:127], v[108:111], v[188:191]
    ds_read_b128 v[92:95], v11 offset:30720
    s_waitcnt lgkmcnt(7)
    v_mfma_f32_16x16x32_bf16 v[192:195], v[64:67], v[96:99], v[192:195]
    v_mfma_f32_16x16x32_bf16 v[200:203], v[64:67], v[100:103], v[200:203]
    ds_read_b128 v[112:115], v12 offset:16384
    s_waitcnt lgkmcnt(7)
    v_mfma_f32_16x16x32_bf16 v[196:199], v[68:71], v[96:99], v[196:199]
    s_mov_b32 m0, s40
    s_add_u32 s40, s40, 32768
    s_cmp_eq_u32 s40, s41
    s_cselect_b32 s40, s35, s40
    buffer_load_dwordx4 v1, s[20:23], s32 offen offset:0 nt lds
    s_add_u32 m0, m0, 1024
    v_mfma_f32_16x16x32_bf16 v[204:207], v[68:71], v[100:103], v[204:207]
    ds_read_b128 v[116:119], v12 offset:18432
    s_waitcnt lgkmcnt(7)
    v_mfma_f32_16x16x32_bf16 v[208:211], v[72:75], v[96:99], v[208:211]
    v_mfma_f32_16x16x32_bf16 v[216:219], v[72:75], v[100:103], v[216:219]
    ds_read_b128 v[120:123], v12 offset:20480
    s_waitcnt lgkmcnt(7)
    v_mfma_f32_16x16x32_bf16 v[212:215], v[76:79], v[96:99], v[212:215]
    v_mfma_f32_16x16x32_bf16 v[220:223], v[76:79], v[100:103], v[220:223]
    ds_read_b128 v[124:127], v12 offset:22528
    s_waitcnt lgkmcnt(7)
    v_mfma_f32_16x16x32_bf16 v[224:227], v[80:83], v[96:99], v[224:227]
    v_mfma_f32_16x16x32_bf16 v[232:235], v[80:83], v[100:103], v[232:235]
    ds_read_b128 v[64:67], v12 offset:24576
    s_waitcnt lgkmcnt(7)
    v_mfma_f32_16x16x32_bf16 v[228:231], v[84:87], v[96:99], v[228:231]
    v_mfma_f32_16x16x32_bf16 v[236:239], v[84:87], v[100:103], v[236:239]
    ds_read_b128 v[68:71], v12 offset:26624
    buffer_load_dwordx4 v2, s[20:23], s32 offen offset:0 nt lds
    s_add_u32 m0, m0, 1024
    s_waitcnt lgkmcnt(7)
    v_mfma_f32_16x16x32_bf16 v[240:243], v[88:91], v[96:99], v[240:243]
    v_mfma_f32_16x16x32_bf16 v[248:251], v[88:91], v[100:103], v[248:251]
    ds_read_b128 v[72:75], v12 offset:28672
    s_waitcnt lgkmcnt(7)
    v_mfma_f32_16x16x32_bf16 v[244:247], v[92:95], v[96:99], v[244:247]
    v_mfma_f32_16x16x32_bf16 v[252:255], v[92:95], v[100:103], v[252:255]
    ds_read_b128 v[76:79], v12 offset:30720
    s_waitcnt lgkmcnt(7)
    v_mfma_f32_16x16x32_bf16 v[192:195], v[112:115], v[104:107], v[192:195]
    v_mfma_f32_16x16x32_bf16 v[200:203], v[112:115], v[108:111], v[200:203]
    s_waitcnt lgkmcnt(6)
    v_mfma_f32_16x16x32_bf16 v[196:199], v[116:119], v[104:107], v[196:199]
    v_mfma_f32_16x16x32_bf16 v[204:207], v[116:119], v[108:111], v[204:207]
    buffer_load_dwordx4 v3, s[20:23], s32 offen offset:0 nt lds
    s_add_u32 m0, m0, 1024
    s_waitcnt lgkmcnt(5)
    v_mfma_f32_16x16x32_bf16 v[208:211], v[120:123], v[104:107], v[208:211]
    v_mfma_f32_16x16x32_bf16 v[216:219], v[120:123], v[108:111], v[216:219]
    s_waitcnt lgkmcnt(4)
    v_mfma_f32_16x16x32_bf16 v[212:215], v[124:127], v[104:107], v[212:215]
    v_mfma_f32_16x16x32_bf16 v[220:223], v[124:127], v[108:111], v[220:223]
    s_waitcnt lgkmcnt(3)
    v_mfma_f32_16x16x32_bf16 v[224:227], v[64:67], v[104:107], v[224:227]
    v_mfma_f32_16x16x32_bf16 v[232:235], v[64:67], v[108:111], v[232:235]
    s_waitcnt lgkmcnt(2)
    v_mfma_f32_16x16x32_bf16 v[228:231], v[68:71], v[104:107], v[228:231]
    v_mfma_f32_16x16x32_bf16 v[236:239], v[68:71], v[108:111], v[236:239]
    s_waitcnt lgkmcnt(1)
    v_mfma_f32_16x16x32_bf16 v[240:243], v[72:75], v[104:107], v[240:243]
    buffer_load_dwordx4 v4, s[20:23], s32 offen offset:0 nt lds
    v_mfma_f32_16x16x32_bf16 v[248:251], v[72:75], v[108:111], v[248:251]
    s_waitcnt lgkmcnt(0)
    v_mfma_f32_16x16x32_bf16 v[244:247], v[76:79], v[104:107], v[244:247]
    v_mfma_f32_16x16x32_bf16 v[252:255], v[76:79], v[108:111], v[252:255]
    s_add_u32 s28, s42, s35
    s_add_u32 s42, s42, 32768
    s_cmp_eq_u32 s42, 163840
    s_cselect_b32 s42, 0, s42
    v_add_u32 v13, s28, v5
    v_add_u32 v11, s42, v5
    v_add_u32 v14, s28, v6
    v_add_u32 v12, s42, v6
    s_add_u32 s42, s42, 32768
    s_cmp_eq_u32 s42, 163840
    s_cselect_b32 s42, 0, s42
    s_waitcnt vmcnt(8)
    s_barrier
    ds_read_b128 v[96:99], v13 offset:0
    ds_read_b128 v[80:83], v11 offset:0
    ds_read_b128 v[100:103], v13 offset:2048
    ds_read_b128 v[84:87], v11 offset:2048
    ds_read_b128 v[88:91], v11 offset:4096
    ds_read_b128 v[92:95], v11 offset:6144
    ds_read_b128 v[112:115], v11 offset:8192
    ds_read_b128 v[116:119], v11 offset:10240
    ds_read_b128 v[120:123], v11 offset:12288
    ds_read_b128 v[124:127], v11 offset:14336
    ds_read_b128 v[104:107], v14 offset:0
    s_waitcnt lgkmcnt(9)
    v_mfma_f32_16x16x32_bf16 v[128:131], v[80:83], v[96:99], v[128:131]
    s_waitcnt lgkmcnt(8)
    v_mfma_f32_16x16x32_bf16 v[136:139], v[80:83], v[100:103], v[136:139]
    ds_read_b128 v[64:67], v12 offset:0
    ds_read_b128 v[108:111], v14 offset:2048
    s_add_u32 s39, s32, 128
    s_mov_b32 m0, s40
    s_add_u32 s40, s40, 32768
    s_cmp_eq_u32 s40, s41
    s_cselect_b32 s40, s35, s40
    buffer_load_dwordx4 v1, s[20:23], s39 offen offset:0 nt lds
    s_add_u32 m0, m0, 1024
    s_waitcnt lgkmcnt(9)
    v_mfma_f32_16x16x32_bf16 v[132:135], v[84:87], v[96:99], v[132:135]
    v_mfma_f32_16x16x32_bf16 v[140:143], v[84:87], v[100:103], v[140:143]
    ds_read_b128 v[68:71], v12 offset:2048
    s_waitcnt lgkmcnt(9)
    v_mfma_f32_16x16x32_bf16 v[144:147], v[88:91], v[96:99], v[144:147]
    v_mfma_f32_16x16x32_bf16 v[152:155], v[88:91], v[100:103], v[152:155]
    ds_read_b128 v[72:75], v12 offset:4096
    s_waitcnt lgkmcnt(9)
    v_mfma_f32_16x16x32_bf16 v[148:151], v[92:95], v[96:99], v[148:151]
    v_mfma_f32_16x16x32_bf16 v[156:159], v[92:95], v[100:103], v[156:159]
    ds_read_b128 v[76:79], v12 offset:6144
    s_waitcnt lgkmcnt(9)
    v_mfma_f32_16x16x32_bf16 v[160:163], v[112:115], v[96:99], v[160:163]
    v_mfma_f32_16x16x32_bf16 v[168:171], v[112:115], v[100:103], v[168:171]
    ds_read_b128 v[80:83], v12 offset:8192
    s_waitcnt lgkmcnt(9)
    v_mfma_f32_16x16x32_bf16 v[164:167], v[116:119], v[96:99], v[164:167]
    v_mfma_f32_16x16x32_bf16 v[172:175], v[116:119], v[100:103], v[172:175]
    ds_read_b128 v[84:87], v12 offset:10240
    s_waitcnt lgkmcnt(9)
    v_mfma_f32_16x16x32_bf16 v[176:179], v[120:123], v[96:99], v[176:179]
    v_mfma_f32_16x16x32_bf16 v[184:187], v[120:123], v[100:103], v[184:187]
    ds_read_b128 v[88:91], v12 offset:12288
    s_waitcnt lgkmcnt(9)
    v_mfma_f32_16x16x32_bf16 v[180:183], v[124:127], v[96:99], v[180:183]
    v_mfma_f32_16x16x32_bf16 v[188:191], v[124:127], v[100:103], v[188:191]
    ds_read_b128 v[92:95], v12 offset:14336
    s_waitcnt lgkmcnt(8)
    v_mfma_f32_16x16x32_bf16 v[128:131], v[64:67], v[104:107], v[128:131]
    buffer_load_dwordx4 v2, s[20:23], s39 offen offset:0 nt lds
    s_add_u32 m0, m0, 1024
    s_waitcnt lgkmcnt(7)
    v_mfma_f32_16x16x32_bf16 v[136:139], v[64:67], v[108:111], v[136:139]
    ds_read_b128 v[112:115], v11 offset:16384
    s_waitcnt lgkmcnt(7)
    v_mfma_f32_16x16x32_bf16 v[132:135], v[68:71], v[104:107], v[132:135]
    v_mfma_f32_16x16x32_bf16 v[140:143], v[68:71], v[108:111], v[140:143]
    ds_read_b128 v[116:119], v12 offset:16384
    s_waitcnt lgkmcnt(7)
    v_mfma_f32_16x16x32_bf16 v[144:147], v[72:75], v[104:107], v[144:147]
    v_max_f32 v17, v128, v129
    v_mfma_f32_16x16x32_bf16 v[152:155], v[72:75], v[108:111], v[152:155]
    ds_read_b128 v[120:123], v11 offset:18432
    v_max3_f32 v17, v17, v130, v131
    s_waitcnt lgkmcnt(7)
    v_mfma_f32_16x16x32_bf16 v[148:151], v[76:79], v[104:107], v[148:151]
    v_max_f32 v18, v136, v137
    v_mfma_f32_16x16x32_bf16 v[156:159], v[76:79], v[108:111], v[156:159]
    ds_read_b128 v[124:127], v12 offset:18432
    v_max3_f32 v18, v18, v138, v139
    s_waitcnt lgkmcnt(7)
    v_mfma_f32_16x16x32_bf16 v[160:163], v[80:83], v[104:107], v[160:163]
    v_max3_f32 v17, v17, v132, v133
    v_mfma_f32_16x16x32_bf16 v[168:171], v[80:83], v[108:111], v[168:171]
    ds_read_b128 v[64:67], v11 offset:20480
    v_max3_f32 v17, v17, v134, v135
    s_waitcnt lgkmcnt(7)
    v_mfma_f32_16x16x32_bf16 v[164:167], v[84:87], v[104:107], v[164:167]
    v_max3_f32 v18, v18, v140, v141
    v_mfma_f32_16x16x32_bf16 v[172:175], v[84:87], v[108:111], v[172:175]
    ds_read_b128 v[68:71], v12 offset:20480
    v_max3_f32 v18, v18, v142, v143
    s_waitcnt lgkmcnt(7)
    v_mfma_f32_16x16x32_bf16 v[176:179], v[88:91], v[104:107], v[176:179]
    v_max3_f32 v17, v17, v144, v145
    v_mfma_f32_16x16x32_bf16 v[184:187], v[88:91], v[108:111], v[184:187]
    ds_read_b128 v[72:75], v11 offset:22528
    v_max3_f32 v17, v17, v146, v147
    s_waitcnt lgkmcnt(7)
    v_mfma_f32_16x16x32_bf16 v[180:183], v[92:95], v[104:107], v[180:183]
    v_max3_f32 v18, v18, v152, v153
    v_mfma_f32_16x16x32_bf16 v[188:191], v[92:95], v[108:111], v[188:191]
    ds_read_b128 v[76:79], v12 offset:22528
    v_max3_f32 v18, v18, v154, v155
    s_waitcnt lgkmcnt(7)
    v_mfma_f32_16x16x32_bf16 v[192:195], v[112:115], v[96:99], v[192:195]
    v_max3_f32 v17, v17, v148, v149
    buffer_load_dwordx4 v3, s[20:23], s39 offen offset:0 nt lds
    s_add_u32 m0, m0, 1024
    v_mfma_f32_16x16x32_bf16 v[200:203], v[112:115], v[100:103], v[200:203]
    ds_read_b128 v[80:83], v11 offset:24576
    v_max3_f32 v17, v17, v150, v151
    s_waitcnt lgkmcnt(7)
    v_mfma_f32_16x16x32_bf16 v[192:195], v[116:119], v[104:107], v[192:195]
    v_max3_f32 v18, v18, v156, v157
    v_mfma_f32_16x16x32_bf16 v[200:203], v[116:119], v[108:111], v[200:203]
    ds_read_b128 v[84:87], v12 offset:24576
    v_max3_f32 v18, v18, v158, v159
    s_waitcnt lgkmcnt(7)
    v_mfma_f32_16x16x32_bf16 v[196:199], v[120:123], v[96:99], v[196:199]
    v_max3_f32 v17, v17, v160, v161
    v_mfma_f32_16x16x32_bf16 v[204:207], v[120:123], v[100:103], v[204:207]
    ds_read_b128 v[88:91], v11 offset:26624
    v_max3_f32 v17, v17, v162, v163
    s_waitcnt lgkmcnt(7)
    v_mfma_f32_16x16x32_bf16 v[196:199], v[124:127], v[104:107], v[196:199]
    v_max3_f32 v18, v18, v168, v169
    v_mfma_f32_16x16x32_bf16 v[204:207], v[124:127], v[108:111], v[204:207]
    ds_read_b128 v[92:95], v12 offset:26624
    v_max3_f32 v18, v18, v170, v171
    v_max3_f32 v17, v17, v164, v165
    s_waitcnt lgkmcnt(7)
    v_mfma_f32_16x16x32_bf16 v[208:211], v[64:67], v[96:99], v[208:211]
    v_max3_f32 v17, v17, v166, v167
    v_mfma_f32_16x16x32_bf16 v[216:219], v[64:67], v[100:103], v[216:219]
    ds_read_b128 v[112:115], v11 offset:28672
    v_max3_f32 v18, v18, v172, v173
    s_waitcnt lgkmcnt(7)
    v_mfma_f32_16x16x32_bf16 v[208:211], v[68:71], v[104:107], v[208:211]
    v_max3_f32 v18, v18, v174, v175
    v_max3_f32 v17, v17, v176, v177
    v_mfma_f32_16x16x32_bf16 v[216:219], v[68:71], v[108:111], v[216:219]
    ds_read_b128 v[116:119], v12 offset:28672
    v_max3_f32 v17, v17, v178, v179
    v_max3_f32 v18, v18, v184, v185
    s_waitcnt lgkmcnt(7)
    v_mfma_f32_16x16x32_bf16 v[212:215], v[72:75], v[96:99], v[212:215]
    v_max3_f32 v18, v18, v186, v187
    v_mfma_f32_16x16x32_bf16 v[220:223], v[72:75], v[100:103], v[220:223]
    ds_read_b128 v[120:123], v11 offset:30720
    v_max3_f32 v17, v17, v180, v181
    s_waitcnt lgkmcnt(7)
    v_mfma_f32_16x16x32_bf16 v[212:215], v[76:79], v[104:107], v[212:215]
    v_max3_f32 v17, v17, v182, v183
    v_max3_f32 v18, v18, v188, v189
    v_mfma_f32_16x16x32_bf16 v[220:223], v[76:79], v[108:111], v[220:223]
    ds_read_b128 v[124:127], v12 offset:30720
    v_max3_f32 v18, v18, v190, v191
    v_max3_f32 v17, v17, v192, v193
    s_waitcnt lgkmcnt(7)
    v_mfma_f32_16x16x32_bf16 v[224:227], v[80:83], v[96:99], v[224:227]
    v_max3_f32 v17, v17, v194, v195
    v_max3_f32 v18, v18, v200, v201
    buffer_load_dwordx4 v4, s[20:23], s39 offen offset:0 nt lds
    v_mfma_f32_16x16x32_bf16 v[232:235], v[80:83], v[100:103], v[232:235]
    v_max3_f32 v18, v18, v202, v203
    s_waitcnt lgkmcnt(6)
    v_mfma_f32_16x16x32_bf16 v[224:227], v[84:87], v[104:107], v[224:227]
    v_max3_f32 v17, v17, v196, v197
    v_max3_f32 v17, v17, v198, v199
    v_mfma_f32_16x16x32_bf16 v[232:235], v[84:87], v[108:111], v[232:235]
    v_max3_f32 v18, v18, v204, v205
    v_max3_f32 v18, v18, v206, v207
    s_waitcnt lgkmcnt(5)
    v_mfma_f32_16x16x32_bf16 v[228:231], v[88:91], v[96:99], v[228:231]
    v_max3_f32 v17, v17, v208, v209
    v_mfma_f32_16x16x32_bf16 v[236:239], v[88:91], v[100:103], v[236:239]
    v_max3_f32 v17, v17, v210, v211
    s_waitcnt lgkmcnt(4)
    v_mfma_f32_16x16x32_bf16 v[228:231], v[92:95], v[104:107], v[228:231]
    v_max3_f32 v18, v18, v216, v217
    v_max3_f32 v18, v18, v218, v219
    v_mfma_f32_16x16x32_bf16 v[236:239], v[92:95], v[108:111], v[236:239]
    v_max3_f32 v17, v17, v212, v213
    v_max3_f32 v17, v17, v214, v215
    s_waitcnt lgkmcnt(3)
    v_mfma_f32_16x16x32_bf16 v[240:243], v[112:115], v[96:99], v[240:243]
    v_max3_f32 v18, v18, v220, v221
    v_max3_f32 v18, v18, v222, v223
    v_mfma_f32_16x16x32_bf16 v[248:251], v[112:115], v[100:103], v[248:251]
    v_max3_f32 v17, v17, v224, v225
    s_waitcnt lgkmcnt(2)
    v_mfma_f32_16x16x32_bf16 v[240:243], v[116:119], v[104:107], v[240:243]
    v_max3_f32 v17, v17, v226, v227
    v_max3_f32 v18, v18, v232, v233
    v_mfma_f32_16x16x32_bf16 v[248:251], v[116:119], v[108:111], v[248:251]
    v_max3_f32 v18, v18, v234, v235
    v_max3_f32 v17, v17, v228, v229
    s_waitcnt lgkmcnt(1)
    v_mfma_f32_16x16x32_bf16 v[244:247], v[120:123], v[96:99], v[244:247]
    v_max3_f32 v17, v17, v230, v231
    v_max3_f32 v18, v18, v236, v237
    v_mfma_f32_16x16x32_bf16 v[252:255], v[120:123], v[100:103], v[252:255]
    v_max3_f32 v18, v18, v238, v239
    s_waitcnt lgkmcnt(0)
    v_mfma_f32_16x16x32_bf16 v[244:247], v[124:127], v[104:107], v[244:247]
    v_max3_f32 v17, v17, v240, v241
    v_max3_f32 v17, v17, v242, v243
    v_mfma_f32_16x16x32_bf16 v[252:255], v[124:127], v[108:111], v[252:255]
    v_max3_f32 v18, v18, v248, v249
    v_max3_f32 v18, v18, v250, v251
    s_nop 2
    v_max3_f32 v17, v17, v244, v245
    v_max3_f32 v17, v17, v246, v247
    s_nop 0
    v_max3_f32 v18, v18, v252, v253
    v_max3_f32 v18, v18, v254, v255
    v_mov_b32 v25, v17
    s_nop 1
    v_permlane32_swap_b32 v17, v25
    v_max_f32 v17, v17, v25
    v_mov_b32 v25, v17
    s_nop 1
    v_permlane16_swap_b32 v17, v25
    v_max_f32 v17, v17, v25
    v_mul_f32 v17, s37, v17
    v_mov_b32 v25, v18
    s_nop 1
    v_permlane32_swap_b32 v18, v25
    v_max_f32 v18, v18, v25
    v_mov_b32 v25, v18
    s_nop 1
    v_permlane16_swap_b32 v18, v25
    v_max_f32 v18, v18, v25
    v_mul_f32 v18, s37, v18
    v_fma_f32 v128, v128, s37, -v17
    v_fma_f32 v129, v129, s37, -v17
    v_fma_f32 v130, v130, s37, -v17
    v_fma_f32 v131, v131, s37, -v17
    v_fma_f32 v132, v132, s37, -v17
    v_fma_f32 v133, v133, s37, -v17
    v_fma_f32 v134, v134, s37, -v17
    v_fma_f32 v135, v135, s37, -v17
    v_exp_f32 v128, v128
    v_exp_f32 v129, v129
    v_exp_f32 v130, v130
    v_exp_f32 v131, v131
    v_exp_f32 v132, v132
    v_exp_f32 v133, v133
    v_exp_f32 v134, v134
    v_exp_f32 v135, v135
    v_cvt_pk_bf16_f32 v128, v128, v129
    v_cvt_pk_bf16_f32 v129, v130, v131
    v_cvt_pk_bf16_f32 v130, v132, v133
    v_cvt_pk_bf16_f32 v131, v134, v135
    s_add_u32 s39, s32, 256
    s_mov_b32 m0, s40
    s_add_u32 s40, s40, 32768
    s_cmp_eq_u32 s40, s41
    s_cselect_b32 s40, s35, s40
    buffer_load_dwordx4 v1, s[20:23], s39 offen offset:0 nt lds
    s_add_u32 m0, m0, 1024
    v_fma_f32 v136, v136, s37, -v18
    v_fma_f32 v137, v137, s37, -v18
    v_fma_f32 v138, v138, s37, -v18
    v_fma_f32 v139, v139, s37, -v18
    v_fma_f32 v140, v140, s37, -v18
    v_fma_f32 v141, v141, s37, -v18
    v_fma_f32 v142, v142, s37, -v18
    v_fma_f32 v143, v143, s37, -v18
    v_exp_f32 v136, v136
    v_exp_f32 v137, v137
    v_exp_f32 v138, v138
    v_exp_f32 v139, v139
    v_exp_f32 v140, v140
    v_exp_f32 v141, v141
    v_exp_f32 v142, v142
    v_exp_f32 v143, v143
    v_cvt_pk_bf16_f32 v136, v136, v137
    v_cvt_pk_bf16_f32 v137, v138, v139
    v_cvt_pk_bf16_f32 v138, v140, v141
    v_cvt_pk_bf16_f32 v139, v142, v143
    v_fma_f32 v144, v144, s37, -v17
    v_fma_f32 v145, v145, s37, -v17
    v_fma_f32 v146, v146, s37, -v17
    v_fma_f32 v147, v147, s37, -v17
    v_fma_f32 v148, v148, s37, -v17
    v_fma_f32 v149, v149, s37, -v17
    v_fma_f32 v150, v150, s37, -v17
    v_fma_f32 v151, v151, s37, -v17
    v_exp_f32 v144, v144
    v_exp_f32 v145, v145
    v_exp_f32 v146, v146
    v_exp_f32 v147, v147
    v_exp_f32 v148, v148
    v_exp_f32 v149, v149
    v_exp_f32 v150, v150
    v_exp_f32 v151, v151
    v_cvt_pk_bf16_f32 v144, v144, v145
    v_cvt_pk_bf16_f32 v145, v146, v147
    v_cvt_pk_bf16_f32 v146, v148, v149
    v_cvt_pk_bf16_f32 v147, v150, v151
    v_fma_f32 v152, v152, s37, -v18
    v_fma_f32 v153, v153, s37, -v18
    v_fma_f32 v154, v154, s37, -v18
    v_fma_f32 v155, v155, s37, -v18
    v_fma_f32 v156, v156, s37, -v18
    v_fma_f32 v157, v157, s37, -v18
    v_fma_f32 v158, v158, s37, -v18
    v_fma_f32 v159, v159, s37, -v18
    v_exp_f32 v152, v152
    v_exp_f32 v153, v153
    v_exp_f32 v154, v154
    v_exp_f32 v155, v155
    v_exp_f32 v156, v156
    v_exp_f32 v157, v157
    v_exp_f32 v158, v158
    v_exp_f32 v159, v159
    v_cvt_pk_bf16_f32 v152, v152, v153
    v_cvt_pk_bf16_f32 v153, v154, v155
    v_cvt_pk_bf16_f32 v154, v156, v157
    v_cvt_pk_bf16_f32 v155, v158, v159
    buffer_load_dwordx4 v2, s[20:23], s39 offen offset:0 nt lds
    s_add_u32 m0, m0, 1024
    v_fma_f32 v160, v160, s37, -v17
    v_fma_f32 v161, v161, s37, -v17
    v_fma_f32 v162, v162, s37, -v17
    v_fma_f32 v163, v163, s37, -v17
    v_fma_f32 v164, v164, s37, -v17
    v_fma_f32 v165, v165, s37, -v17
    v_fma_f32 v166, v166, s37, -v17
    v_fma_f32 v167, v167, s37, -v17
    v_exp_f32 v160, v160
    v_exp_f32 v161, v161
    v_exp_f32 v162, v162
    v_exp_f32 v163, v163
    v_exp_f32 v164, v164
    v_exp_f32 v165, v165
    v_exp_f32 v166, v166
    v_exp_f32 v167, v167
    v_cvt_pk_bf16_f32 v160, v160, v161
    v_cvt_pk_bf16_f32 v161, v162, v163
    v_cvt_pk_bf16_f32 v162, v164, v165
    v_cvt_pk_bf16_f32 v163, v166, v167
    v_fma_f32 v168, v168, s37, -v18
    v_fma_f32 v169, v169, s37, -v18
    v_fma_f32 v170, v170, s37, -v18
    v_fma_f32 v171, v171, s37, -v18
    v_fma_f32 v172, v172, s37, -v18
    v_fma_f32 v173, v173, s37, -v18
    v_fma_f32 v174, v174, s37, -v18
    v_fma_f32 v175, v175, s37, -v18
    v_exp_f32 v168, v168
    v_exp_f32 v169, v169
    v_exp_f32 v170, v170
    v_exp_f32 v171, v171
    v_exp_f32 v172, v172
    v_exp_f32 v173, v173
    v_exp_f32 v174, v174
    v_exp_f32 v175, v175
    v_cvt_pk_bf16_f32 v168, v168, v169
    v_cvt_pk_bf16_f32 v169, v170, v171
    v_cvt_pk_bf16_f32 v170, v172, v173
    v_cvt_pk_bf16_f32 v171, v174, v175
    v_fma_f32 v176, v176, s37, -v17
    v_fma_f32 v177, v177, s37, -v17
    v_fma_f32 v178, v178, s37, -v17
    v_fma_f32 v179, v179, s37, -v17
    v_fma_f32 v180, v180, s37, -v17
    v_fma_f32 v181, v181, s37, -v17
    v_fma_f32 v182, v182, s37, -v17
    v_fma_f32 v183, v183, s37, -v17
    v_exp_f32 v176, v176
    v_exp_f32 v177, v177
    v_exp_f32 v178, v178
    v_exp_f32 v179, v179
    v_exp_f32 v180, v180
    v_exp_f32 v181, v181
    v_exp_f32 v182, v182
    v_exp_f32 v183, v183
    v_cvt_pk_bf16_f32 v176, v176, v177
    v_cvt_pk_bf16_f32 v177, v178, v179
    v_cvt_pk_bf16_f32 v178, v180, v181
    v_cvt_pk_bf16_f32 v179, v182, v183
    buffer_load_dwordx4 v3, s[20:23], s39 offen offset:0 nt lds
    s_add_u32 m0, m0, 1024
    v_fma_f32 v184, v184, s37, -v18
    v_fma_f32 v185, v185, s37, -v18
    v_fma_f32 v186, v186, s37, -v18
    v_fma_f32 v187, v187, s37, -v18
    v_fma_f32 v188, v188, s37, -v18
    v_fma_f32 v189, v189, s37, -v18
    v_fma_f32 v190, v190, s37, -v18
    v_fma_f32 v191, v191, s37, -v18
    v_exp_f32 v184, v184
    v_exp_f32 v185, v185
    v_exp_f32 v186, v186
    v_exp_f32 v187, v187
    v_exp_f32 v188, v188
    v_exp_f32 v189, v189
    v_exp_f32 v190, v190
    v_exp_f32 v191, v191
    v_cvt_pk_bf16_f32 v184, v184, v185
    v_cvt_pk_bf16_f32 v185, v186, v187
    v_cvt_pk_bf16_f32 v186, v188, v189
    v_cvt_pk_bf16_f32 v187, v190, v191
    v_fma_f32 v192, v192, s37, -v17
    v_fma_f32 v193, v193, s37, -v17
    v_fma_f32 v194, v194, s37, -v17
    v_fma_f32 v195, v195, s37, -v17
    v_fma_f32 v196, v196, s37, -v17
    v_fma_f32 v197, v197, s37, -v17
    v_fma_f32 v198, v198, s37, -v17
    v_fma_f32 v199, v199, s37, -v17
    v_exp_f32 v192, v192
    v_exp_f32 v193, v193
    v_exp_f32 v194, v194
    v_exp_f32 v195, v195
    v_exp_f32 v196, v196
    v_exp_f32 v197, v197
    v_exp_f32 v198, v198
    v_exp_f32 v199, v199
    v_cvt_pk_bf16_f32 v192, v192, v193
    v_cvt_pk_bf16_f32 v193, v194, v195
    v_cvt_pk_bf16_f32 v194, v196, v197
    v_cvt_pk_bf16_f32 v195, v198, v199
    v_fma_f32 v200, v200, s37, -v18
    v_fma_f32 v201, v201, s37, -v18
    v_fma_f32 v202, v202, s37, -v18
    v_fma_f32 v203, v203, s37, -v18
    v_fma_f32 v204, v204, s37, -v18
    v_fma_f32 v205, v205, s37, -v18
    v_fma_f32 v206, v206, s37, -v18
    v_fma_f32 v207, v207, s37, -v18
    v_exp_f32 v200, v200
    v_exp_f32 v201, v201
    v_exp_f32 v202, v202
    v_exp_f32 v203, v203
    v_exp_f32 v204, v204
    v_exp_f32 v205, v205
    v_exp_f32 v206, v206
    v_exp_f32 v207, v207
    v_cvt_pk_bf16_f32 v200, v200, v201
    v_cvt_pk_bf16_f32 v201, v202, v203
    v_cvt_pk_bf16_f32 v202, v204, v205
    v_cvt_pk_bf16_f32 v203, v206, v207
    buffer_load_dwordx4 v4, s[20:23], s39 offen offset:0 nt lds
    v_add_u32 v11, s42, v7
    v_add_u32 v12, s42, v8
    v_add_u32 v13, s42, v9
    v_add_u32 v14, s42, v10
    s_add_u32 s42, s42, 32768
    s_cmp_eq_u32 s42, 163840
    s_cselect_b32 s42, 0, s42
    s_waitcnt vmcnt(8)
    s_barrier
    ds_read_b64_tr_b16 v[96:97], v11 offset:0
    ds_read_b64_tr_b16 v[98:99], v11 offset:2048
    ds_read_b64_tr_b16 v[100:101], v12 offset:0
    ds_read_b64_tr_b16 v[102:103], v12 offset:2048
    ds_read_b64_tr_b16 v[104:105], v13 offset:0
    ds_read_b64_tr_b16 v[106:107], v13 offset:2048
    ds_read_b64_tr_b16 v[108:109], v14 offset:0
    ds_read_b64_tr_b16 v[110:111], v14 offset:2048
    ds_read_b64_tr_b16 v[112:113], v11 offset:4096
    ds_read_b64_tr_b16 v[114:115], v11 offset:6144
    ds_read_b64_tr_b16 v[116:117], v12 offset:4096
    ds_read_b64_tr_b16 v[118:119], v12 offset:6144
    v_fma_f32 v208, v208, s37, -v17
    v_fma_f32 v209, v209, s37, -v17
    v_fma_f32 v210, v210, s37, -v17
    v_fma_f32 v211, v211, s37, -v17
    v_fma_f32 v212, v212, s37, -v17
    v_fma_f32 v213, v213, s37, -v17
    v_fma_f32 v214, v214, s37, -v17
    v_fma_f32 v215, v215, s37, -v17
    v_exp_f32 v208, v208
    v_exp_f32 v209, v209
    v_exp_f32 v210, v210
    v_exp_f32 v211, v211
    v_exp_f32 v212, v212
    v_exp_f32 v213, v213
    v_exp_f32 v214, v214
    v_exp_f32 v215, v215
    v_cvt_pk_bf16_f32 v208, v208, v209
    v_cvt_pk_bf16_f32 v209, v210, v211
    v_cvt_pk_bf16_f32 v210, v212, v213
    v_cvt_pk_bf16_f32 v211, v214, v215
    v_fma_f32 v216, v216, s37, -v18
    v_fma_f32 v217, v217, s37, -v18
    v_fma_f32 v218, v218, s37, -v18
    v_fma_f32 v219, v219, s37, -v18
    v_fma_f32 v220, v220, s37, -v18
    v_fma_f32 v221, v221, s37, -v18
    v_fma_f32 v222, v222, s37, -v18
    v_fma_f32 v223, v223, s37, -v18
    v_exp_f32 v216, v216
    v_exp_f32 v217, v217
    v_exp_f32 v218, v218
    v_exp_f32 v219, v219
    v_exp_f32 v220, v220
    v_exp_f32 v221, v221
    v_exp_f32 v222, v222
    v_exp_f32 v223, v223
    v_cvt_pk_bf16_f32 v216, v216, v217
    v_cvt_pk_bf16_f32 v217, v218, v219
    v_cvt_pk_bf16_f32 v218, v220, v221
    v_cvt_pk_bf16_f32 v219, v222, v223
    s_waitcnt lgkmcnt(10)
    v_mfma_f32_16x16x32_bf16 v[32:35], v[96:99], v[128:131], 0
    v_fma_f32 v224, v224, s37, -v17
    v_fma_f32 v225, v225, s37, -v17
    v_mfma_f32_16x16x32_bf16 v[36:39], v[96:99], v[136:139], 0
    ds_read_b64_tr_b16 v[120:121], v13 offset:4096
    ds_read_b64_tr_b16 v[122:123], v13 offset:6144
    s_mov_b32 m0, s40
    s_add_u32 s40, s40, 32768
    s_cmp_eq_u32 s40, s41
    s_cselect_b32 s40, s35, s40
    buffer_load_dwordx4 v1, s[12:15], s33 offen offset:0 nt lds
    s_add_u32 m0, m0, 1024
    v_fma_f32 v226, v226, s37, -v17
    s_waitcnt lgkmcnt(10)
    v_mfma_f32_16x16x32_bf16 v[40:43], v[100:103], v[128:131], 0
    v_fma_f32 v227, v227, s37, -v17
    v_fma_f32 v228, v228, s37, -v17
    v_mfma_f32_16x16x32_bf16 v[44:47], v[100:103], v[136:139], 0
    v_mfma_f32_16x16x32_bf16 v[132:135], v[26:29], v[128:131], 0
    ds_read_b64_tr_b16 v[124:125], v14 offset:4096
    ds_read_b64_tr_b16 v[126:127], v14 offset:6144
    v_fma_f32 v229, v229, s37, -v17
    s_waitcnt lgkmcnt(10)
    v_mfma_f32_16x16x32_bf16 v[48:51], v[104:107], v[128:131], 0
    v_fma_f32 v230, v230, s37, -v17
    v_fma_f32 v231, v231, s37, -v17
    v_mfma_f32_16x16x32_bf16 v[52:55], v[104:107], v[136:139], 0
    ds_read_b64_tr_b16 v[96:97], v11 offset:8192
    ds_read_b64_tr_b16 v[98:99], v11 offset:10240
    v_exp_f32 v224, v224
    s_waitcnt lgkmcnt(10)
    v_mfma_f32_16x16x32_bf16 v[56:59], v[108:111], v[128:131], 0
    v_exp_f32 v225, v225
    v_mfma_f32_16x16x32_bf16 v[60:63], v[108:111], v[136:139], 0
    v_mfma_f32_16x16x32_bf16 v[140:143], v[26:29], v[136:139], 0
    ds_read_b64_tr_b16 v[100:101], v12 offset:8192
    ds_read_b64_tr_b16 v[102:103], v12 offset:10240
    v_exp_f32 v226, v226
    v_exp_f32 v227, v227
    s_waitcnt lgkmcnt(10)
    v_mfma_f32_16x16x32_bf16 v[32:35], v[112:115], v[144:147], v[32:35]
    v_exp_f32 v228, v228
    v_mfma_f32_16x16x32_bf16 v[36:39], v[112:115], v[152:155], v[36:39]
    ds_read_b64_tr_b16 v[104:105], v13 offset:8192
    ds_read_b64_tr_b16 v[106:107], v13 offset:10240
    buffer_load_dwordx4 v2, s[12:15], s33 offen offset:0 nt lds
    s_add_u32 m0, m0, 1024
    v_exp_f32 v229, v229
    v_exp_f32 v230, v230
    s_waitcnt lgkmcnt(10)
    v_mfma_f32_16x16x32_bf16 v[40:43], v[116:119], v[144:147], v[40:43]
    v_exp_f32 v231, v231
    v_mfma_f32_16x16x32_bf16 v[44:47], v[116:119], v[152:155], v[44:47]
    v_mfma_f32_16x16x32_bf16 v[132:135], v[26:29], v[144:147], v[132:135]
    ds_read_b64_tr_b16 v[108:109], v14 offset:8192
    ds_read_b64_tr_b16 v[110:111], v14 offset:10240
    v_cvt_pk_bf16_f32 v224, v224, v225
    v_cvt_pk_bf16_f32 v225, v226, v227
    s_waitcnt lgkmcnt(10)
    v_mfma_f32_16x16x32_bf16 v[48:51], v[120:123], v[144:147], v[48:51]
    v_cvt_pk_bf16_f32 v226, v228, v229
    v_mfma_f32_16x16x32_bf16 v[52:55], v[120:123], v[152:155], v[52:55]
    ds_read_b64_tr_b16 v[112:113], v11 offset:12288
    ds_read_b64_tr_b16 v[114:115], v11 offset:14336
    v_cvt_pk_bf16_f32 v227, v230, v231
    s_waitcnt lgkmcnt(10)
    v_mfma_f32_16x16x32_bf16 v[56:59], v[124:127], v[144:147], v[56:59]
    v_fma_f32 v232, v232, s37, -v18
    v_fma_f32 v233, v233, s37, -v18
    v_mfma_f32_16x16x32_bf16 v[60:63], v[124:127], v[152:155], v[60:63]
    v_mfma_f32_16x16x32_bf16 v[140:143], v[26:29], v[152:155], v[140:143]
    ds_read_b64_tr_b16 v[116:117], v12 offset:12288
    ds_read_b64_tr_b16 v[118:119], v12 offset:14336
    v_fma_f32 v234, v234, s37, -v18
    s_waitcnt lgkmcnt(10)
    v_mfma_f32_16x16x32_bf16 v[32:35], v[96:99], v[160:163], v[32:35]
    v_fma_f32 v235, v235, s37, -v18
    v_fma_f32 v236, v236, s37, -v18
    v_mfma_f32_16x16x32_bf16 v[36:39], v[96:99], v[168:171], v[36:39]
    ds_read_b64_tr_b16 v[120:121], v13 offset:12288
    ds_read_b64_tr_b16 v[122:123], v13 offset:14336
    buffer_load_dwordx4 v3, s[12:15], s33 offen offset:0 nt lds
    s_add_u32 m0, m0, 1024
    v_fma_f32 v237, v237, s37, -v18
    s_waitcnt lgkmcnt(10)
    v_mfma_f32_16x16x32_bf16 v[40:43], v[100:103], v[160:163], v[40:43]
    v_fma_f32 v238, v238, s37, -v18
    v_fma_f32 v239, v239, s37, -v18
    v_mfma_f32_16x16x32_bf16 v[44:47], v[100:103], v[168:171], v[44:47]
    v_mfma_f32_16x16x32_bf16 v[132:135], v[26:29], v[160:163], v[132:135]
    ds_read_b64_tr_b16 v[124:125], v14 offset:12288
    ds_read_b64_tr_b16 v[126:127], v14 offset:14336
    v_exp_f32 v232, v232
    s_waitcnt lgkmcnt(10)
    v_mfma_f32_16x16x32_bf16 v[48:51], v[104:107], v[160:163], v[48:51]
    v_exp_f32 v233, v233
    v_mfma_f32_16x16x32_bf16 v[52:55], v[104:107], v[168:171], v[52:55]
    ds_read_b64_tr_b16 v[96:97], v11 offset:16384
    ds_read_b64_tr_b16 v[98:99], v11 offset:18432
    v_exp_f32 v234, v234
    v_exp_f32 v235, v235
    s_waitcnt lgkmcnt(10)
    v_mfma_f32_16x16x32_bf16 v[56:59], v[108:111], v[160:163], v[56:59]
    v_exp_f32 v236, v236
    v_mfma_f32_16x16x32_bf16 v[60:63], v[108:111], v[168:171], v[60:63]
    v_mfma_f32_16x16x32_bf16 v[140:143], v[26:29], v[168:171], v[140:143]
    ds_read_b64_tr_b16 v[100:101], v12 offset:16384
    ds_read_b64_tr_b16 v[102:103], v12 offset:18432
    v_exp_f32 v237, v237
    v_exp_f32 v238, v238
    s_waitcnt lgkmcnt(10)
    v_mfma_f32_16x16x32_bf16 v[32:35], v[112:115], v[176:179], v[32:35]
    v_exp_f32 v239, v239
    v_mfma_f32_16x16x32_bf16 v[36:39], v[112:115], v[184:187], v[36:39]
    ds_read_b64_tr_b16 v[104:105], v13 offset:16384
    ds_read_b64_tr_b16 v[106:107], v13 offset:18432
    v_cvt_pk_bf16_f32 v232, v232, v233
    v_cvt_pk_bf16_f32 v233, v234, v235
    s_waitcnt lgkmcnt(10)
    v_mfma_f32_16x16x32_bf16 v[40:43], v[116:119], v[176:179], v[40:43]
    buffer_load_dwordx4 v4, s[12:15], s33 offen offset:0 nt lds
    v_cvt_pk_bf16_f32 v234, v236, v237
    v_mfma_f32_16x16x32_bf16 v[44:47], v[116:119], v[184:187], v[44:47]
    v_mfma_f32_16x16x32_bf16 v[132:135], v[26:29], v[176:179], v[132:135]
    ds_read_b64_tr_b16 v[108:109], v14 offset:16384
    ds_read_b64_tr_b16 v[110:111], v14 offset:18432
    v_cvt_pk_bf16_f32 v235, v238, v239
    s_waitcnt lgkmcnt(10)
    v_mfma_f32_16x16x32_bf16 v[48:51], v[120:123], v[176:179], v[48:51]
    v_fma_f32 v240, v240, s37, -v17
    v_fma_f32 v241, v241, s37, -v17
    v_mfma_f32_16x16x32_bf16 v[52:55], v[120:123], v[184:187], v[52:55]
    ds_read_b64_tr_b16 v[112:113], v11 offset:20480
    ds_read_b64_tr_b16 v[114:115], v11 offset:22528
    v_fma_f32 v242, v242, s37, -v17
    s_waitcnt lgkmcnt(10)
    v_mfma_f32_16x16x32_bf16 v[56:59], v[124:127], v[176:179], v[56:59]
    v_fma_f32 v243, v243, s37, -v17
    v_fma_f32 v244, v244, s37, -v17
    v_mfma_f32_16x16x32_bf16 v[60:63], v[124:127], v[184:187], v[60:63]
    v_mfma_f32_16x16x32_bf16 v[140:143], v[26:29], v[184:187], v[140:143]
    ds_read_b64_tr_b16 v[116:117], v12 offset:20480
    ds_read_b64_tr_b16 v[118:119], v12 offset:22528
    v_fma_f32 v245, v245, s37, -v17
    s_waitcnt lgkmcnt(10)
    v_mfma_f32_16x16x32_bf16 v[32:35], v[96:99], v[192:195], v[32:35]
    v_fma_f32 v246, v246, s37, -v17
    v_fma_f32 v247, v247, s37, -v17
    v_mfma_f32_16x16x32_bf16 v[36:39], v[96:99], v[200:203], v[36:39]
    ds_read_b64_tr_b16 v[120:121], v13 offset:20480
    ds_read_b64_tr_b16 v[122:123], v13 offset:22528
    v_exp_f32 v240, v240
    s_waitcnt lgkmcnt(10)
    v_mfma_f32_16x16x32_bf16 v[40:43], v[100:103], v[192:195], v[40:43]
    s_mov_b32 m0, s40
    s_add_u32 s40, s40, 32768
    s_cmp_eq_u32 s40, s41
    s_cselect_b32 s40, s35, s40
    buffer_load_dwordx4 v1, s[16:19], s33 offen offset:0 nt lds
    s_add_u32 m0, m0, 1024
    v_exp_f32 v241, v241
    v_mfma_f32_16x16x32_bf16 v[44:47], v[100:103], v[200:203], v[44:47]
    v_mfma_f32_16x16x32_bf16 v[132:135], v[26:29], v[192:195], v[132:135]
    ds_read_b64_tr_b16 v[124:125], v14 offset:20480
    ds_read_b64_tr_b16 v[126:127], v14 offset:22528
    v_exp_f32 v242, v242
    v_exp_f32 v243, v243
    s_waitcnt lgkmcnt(10)
    v_mfma_f32_16x16x32_bf16 v[48:51], v[104:107], v[192:195], v[48:51]
    v_exp_f32 v244, v244
    v_mfma_f32_16x16x32_bf16 v[52:55], v[104:107], v[200:203], v[52:55]
    ds_read_b64_tr_b16 v[96:97], v11 offset:24576
    ds_read_b64_tr_b16 v[98:99], v11 offset:26624
    v_exp_f32 v245, v245
    v_exp_f32 v246, v246
    s_waitcnt lgkmcnt(10)
    v_mfma_f32_16x16x32_bf16 v[56:59], v[108:111], v[192:195], v[56:59]
    v_exp_f32 v247, v247
    v_mfma_f32_16x16x32_bf16 v[60:63], v[108:111], v[200:203], v[60:63]
    v_mfma_f32_16x16x32_bf16 v[140:143], v[26:29], v[200:203], v[140:143]
    ds_read_b64_tr_b16 v[100:101], v12 offset:24576
    ds_read_b64_tr_b16 v[102:103], v12 offset:26624
    v_cvt_pk_bf16_f32 v240, v240, v241
    v_cvt_pk_bf16_f32 v241, v242, v243
    s_waitcnt lgkmcnt(10)
    v_mfma_f32_16x16x32_bf16 v[32:35], v[112:115], v[208:211], v[32:35]
    v_cvt_pk_bf16_f32 v242, v244, v245
    v_mfma_f32_16x16x32_bf16 v[36:39], v[112:115], v[216:219], v[36:39]
    ds_read_b64_tr_b16 v[104:105], v13 offset:24576
    ds_read_b64_tr_b16 v[106:107], v13 offset:26624
    v_cvt_pk_bf16_f32 v243, v246, v247
    s_waitcnt lgkmcnt(10)
    v_mfma_f32_16x16x32_bf16 v[40:43], v[116:119], v[208:211], v[40:43]
    v_fma_f32 v248, v248, s37, -v18
    v_fma_f32 v249, v249, s37, -v18
    v_mfma_f32_16x16x32_bf16 v[44:47], v[116:119], v[216:219], v[44:47]
    v_mfma_f32_16x16x32_bf16 v[132:135], v[26:29], v[208:211], v[132:135]
    ds_read_b64_tr_b16 v[108:109], v14 offset:24576
    ds_read_b64_tr_b16 v[110:111], v14 offset:26624
    buffer_load_dwordx4 v2, s[16:19], s33 offen offset:0 nt lds
    s_add_u32 m0, m0, 1024
    v_fma_f32 v250, v250, s37, -v18
    s_waitcnt lgkmcnt(10)
    v_mfma_f32_16x16x32_bf16 v[48:51], v[120:123], v[208:211], v[48:51]
    v_fma_f32 v251, v251, s37, -v18
    v_fma_f32 v252, v252, s37, -v18
    v_mfma_f32_16x16x32_bf16 v[52:55], v[120:123], v[216:219], v[52:55]
    ds_read_b64_tr_b16 v[112:113], v11 offset:28672
    ds_read_b64_tr_b16 v[114:115], v11 offset:30720
    v_fma_f32 v253, v253, s37, -v18
    s_waitcnt lgkmcnt(10)
    v_mfma_f32_16x16x32_bf16 v[56:59], v[124:127], v[208:211], v[56:59]
    v_fma_f32 v254, v254, s37, -v18
    v_fma_f32 v255, v255, s37, -v18
    v_mfma_f32_16x16x32_bf16 v[60:63], v[124:127], v[216:219], v[60:63]
    v_mfma_f32_16x16x32_bf16 v[140:143], v[26:29], v[216:219], v[140:143]
    ds_read_b64_tr_b16 v[116:117], v12 offset:28672
    ds_read_b64_tr_b16 v[118:119], v12 offset:30720
    v_exp_f32 v248, v248
    s_waitcnt lgkmcnt(10)
    v_mfma_f32_16x16x32_bf16 v[32:35], v[96:99], v[224:227], v[32:35]
    v_exp_f32 v249, v249
    v_mfma_f32_16x16x32_bf16 v[36:39], v[96:99], v[232:235], v[36:39]
    ds_read_b64_tr_b16 v[120:121], v13 offset:28672
    ds_read_b64_tr_b16 v[122:123], v13 offset:30720
    v_exp_f32 v250, v250
    v_exp_f32 v251, v251
    s_waitcnt lgkmcnt(10)
    v_mfma_f32_16x16x32_bf16 v[40:43], v[100:103], v[224:227], v[40:43]
    v_exp_f32 v252, v252
    v_mfma_f32_16x16x32_bf16 v[44:47], v[100:103], v[232:235], v[44:47]
    v_mfma_f32_16x16x32_bf16 v[132:135], v[26:29], v[224:227], v[132:135]
    ds_read_b64_tr_b16 v[124:125], v14 offset:28672
    ds_read_b64_tr_b16 v[126:127], v14 offset:30720
    buffer_load_dwordx4 v3, s[16:19], s33 offen offset:0 nt lds
    s_add_u32 m0, m0, 1024
    v_exp_f32 v253, v253
    v_exp_f32 v254, v254
    s_waitcnt lgkmcnt(10)
    v_mfma_f32_16x16x32_bf16 v[48:51], v[104:107], v[224:227], v[48:51]
    v_exp_f32 v255, v255
    v_mfma_f32_16x16x32_bf16 v[52:55], v[104:107], v[232:235], v[52:55]
    v_cvt_pk_bf16_f32 v248, v248, v249
    v_cvt_pk_bf16_f32 v249, v250, v251
    s_waitcnt lgkmcnt(8)
    v_mfma_f32_16x16x32_bf16 v[56:59], v[108:111], v[224:227], v[56:59]
    v_cvt_pk_bf16_f32 v250, v252, v253
    v_mfma_f32_16x16x32_bf16 v[60:63], v[108:111], v[232:235], v[60:63]
    v_mfma_f32_16x16x32_bf16 v[140:143], v[26:29], v[232:235], v[140:143]
    v_cvt_pk_bf16_f32 v251, v254, v255
    s_waitcnt lgkmcnt(6)
    v_mfma_f32_16x16x32_bf16 v[32:35], v[112:115], v[240:243], v[32:35]
    v_mfma_f32_16x16x32_bf16 v[36:39], v[112:115], v[248:251], v[36:39]
    s_waitcnt lgkmcnt(4)
    v_mfma_f32_16x16x32_bf16 v[40:43], v[116:119], v[240:243], v[40:43]
    v_mfma_f32_16x16x32_bf16 v[44:47], v[116:119], v[248:251], v[44:47]
    v_mfma_f32_16x16x32_bf16 v[132:135], v[26:29], v[240:243], v[132:135]
    s_waitcnt lgkmcnt(2)
    v_mfma_f32_16x16x32_bf16 v[48:51], v[120:123], v[240:243], v[48:51]
    buffer_load_dwordx4 v4, s[16:19], s33 offen offset:0 nt lds
    v_mfma_f32_16x16x32_bf16 v[52:55], v[120:123], v[248:251], v[52:55]
    s_waitcnt lgkmcnt(0)
    v_mfma_f32_16x16x32_bf16 v[56:59], v[124:127], v[240:243], v[56:59]
    v_mfma_f32_16x16x32_bf16 v[60:63], v[124:127], v[248:251], v[60:63]
    v_mfma_f32_16x16x32_bf16 v[140:143], v[26:29], v[248:251], v[140:143]
    v_add_u32 v11, s42, v7
    v_add_u32 v12, s42, v8
    v_add_u32 v13, s42, v9
    v_add_u32 v14, s42, v10
    s_add_u32 s42, s42, 32768
    s_cmp_eq_u32 s42, 163840
    s_cselect_b32 s42, 0, s42
    s_waitcnt vmcnt(12)
    s_barrier
    ds_read_b64_tr_b16 v[96:97], v11 offset:0
    ds_read_b64_tr_b16 v[98:99], v11 offset:2048
    ds_read_b64_tr_b16 v[100:101], v12 offset:0
    ds_read_b64_tr_b16 v[102:103], v12 offset:2048
    ds_read_b64_tr_b16 v[104:105], v13 offset:0
    ds_read_b64_tr_b16 v[106:107], v13 offset:2048
    ds_read_b64_tr_b16 v[108:109], v14 offset:0
    ds_read_b64_tr_b16 v[110:111], v14 offset:2048
    ds_read_b64_tr_b16 v[112:113], v11 offset:4096
    ds_read_b64_tr_b16 v[114:115], v11 offset:6144
    ds_read_b64_tr_b16 v[116:117], v12 offset:4096
    ds_read_b64_tr_b16 v[118:119], v12 offset:6144
    v_rcp_f32 v19, v132
    v_rcp_f32 v20, v140
    s_waitcnt lgkmcnt(10)
    v_mfma_f32_16x16x32_bf16 v[64:67], v[96:99], v[128:131], 0
    v_add_u32 v21, s40, v15
    v_add_u32 v25, s40, v16
    v_xor_b32 v22, 32, v21
    v_xor_b32 v23, 64, v21
    v_xor_b32 v24, 96, v21
    v_mfma_f32_16x16x32_bf16 v[68:71], v[96:99], v[136:139], 0
    ds_read_b64_tr_b16 v[120:121], v13 offset:4096
    ds_read_b64_tr_b16 v[122:123], v13 offset:6144
    v_mul_f32 v32, v32, v19
    v_mul_f32 v33, v33, v19
    v_mul_f32 v34, v34, v19
    v_mul_f32 v35, v35, v19
    v_cvt_pk_bf16_f32 v32, v32, v33
    s_waitcnt lgkmcnt(10)
    v_mfma_f32_16x16x32_bf16 v[72:75], v[100:103], v[128:131], 0
    v_cvt_pk_bf16_f32 v33, v34, v35
    ds_write_b64 v21, v[32:33] offset:0
    v_mul_f32 v36, v36, v20
    v_mul_f32 v37, v37, v20
    v_mul_f32 v38, v38, v20
    v_mfma_f32_16x16x32_bf16 v[76:79], v[100:103], v[136:139], 0
    ds_read_b64_tr_b16 v[124:125], v14 offset:4096
    ds_read_b64_tr_b16 v[126:127], v14 offset:6144
    v_mul_f32 v39, v39, v20
    v_cvt_pk_bf16_f32 v36, v36, v37
    v_cvt_pk_bf16_f32 v37, v38, v39
    ds_write_b64 v21, v[36:37] offset:2048
    v_mul_f32 v40, v40, v19
    s_waitcnt lgkmcnt(12)
    v_mfma_f32_16x16x32_bf16 v[80:83], v[104:107], v[128:131], 0
    v_mul_f32 v41, v41, v19
    v_mul_f32 v42, v42, v19
    v_mul_f32 v43, v43, v19
    v_cvt_pk_bf16_f32 v40, v40, v41
    v_cvt_pk_bf16_f32 v41, v42, v43
    v_mfma_f32_16x16x32_bf16 v[84:87], v[104:107], v[136:139], 0
    ds_read_b64_tr_b16 v[96:97], v11 offset:8192
    ds_read_b64_tr_b16 v[98:99], v11 offset:10240
    ds_write_b64 v22, v[40:41] offset:0
    v_mul_f32 v44, v44, v20
    v_mul_f32 v45, v45, v20
    v_mul_f32 v46, v46, v20
    v_mul_f32 v47, v47, v20
    s_waitcnt lgkmcnt(13)
    v_mfma_f32_16x16x32_bf16 v[88:91], v[108:111], v[128:131], 0
    v_cvt_pk_bf16_f32 v44, v44, v45
    v_cvt_pk_bf16_f32 v45, v46, v47
    ds_write_b64 v22, v[44:45] offset:2048
    v_mul_f32 v48, v48, v19
    v_mul_f32 v49, v49, v19
    v_mfma_f32_16x16x32_bf16 v[92:95], v[108:111], v[136:139], 0
    ds_read_b64_tr_b16 v[100:101], v12 offset:8192
    s_waitcnt lgkmcnt(14)
    ds_read_b64_tr_b16 v[102:103], v12 offset:10240
    v_mul_f32 v50, v50, v19
    v_mul_f32 v51, v51, v19
    v_cvt_pk_bf16_f32 v48, v48, v49
    v_cvt_pk_bf16_f32 v49, v50, v51
    s_waitcnt lgkmcnt(14)
    ds_write_b64 v23, v[48:49] offset:0
    v_mfma_f32_16x16x32_bf16 v[64:67], v[112:115], v[144:147], v[64:67]
    v_mul_f32 v52, v52, v20
    v_mul_f32 v53, v53, v20
    v_mul_f32 v54, v54, v20
    v_mul_f32 v55, v55, v20
    v_cvt_pk_bf16_f32 v52, v52, v53
    v_mfma_f32_16x16x32_bf16 v[68:71], v[112:115], v[152:155], v[68:71]
    s_waitcnt lgkmcnt(14)
    ds_read_b64_tr_b16 v[104:105], v13 offset:8192
    s_waitcnt lgkmcnt(14)
    ds_read_b64_tr_b16 v[106:107], v13 offset:10240
    v_cvt_pk_bf16_f32 v53, v54, v55
    s_waitcnt lgkmcnt(14)
    ds_write_b64 v23, v[52:53] offset:2048
    v_mul_f32 v56, v56, v19
    v_mul_f32 v57, v57, v19
    v_mul_f32 v58, v58, v19
    v_mfma_f32_16x16x32_bf16 v[72:75], v[116:119], v[144:147], v[72:75]
    v_mul_f32 v59, v59, v19
    v_cvt_pk_bf16_f32 v56, v56, v57
    v_cvt_pk_bf16_f32 v57, v58, v59
    s_waitcnt lgkmcnt(14)
    ds_write_b64 v24, v[56:57] offset:0
    v_mul_f32 v60, v60, v20
    v_mfma_f32_16x16x32_bf16 v[76:79], v[116:119], v[152:155], v[76:79]
    s_waitcnt lgkmcnt(14)
    ds_read_b64_tr_b16 v[108:109], v14 offset:8192
    s_waitcnt lgkmcnt(14)
    ds_read_b64_tr_b16 v[110:111], v14 offset:10240
    v_mul_f32 v61, v61, v20
    v_mul_f32 v62, v62, v20
    v_mul_f32 v63, v63, v20
    v_cvt_pk_bf16_f32 v60, v60, v61
    v_cvt_pk_bf16_f32 v61, v62, v63
    v_mfma_f32_16x16x32_bf16 v[80:83], v[120:123], v[144:147], v[80:83]
    s_waitcnt lgkmcnt(14)
    ds_write_b64 v24, v[60:61] offset:2048
    v_mfma_f32_16x16x32_bf16 v[84:87], v[120:123], v[152:155], v[84:87]
    s_waitcnt lgkmcnt(14)
    ds_read_b64_tr_b16 v[112:113], v11 offset:12288
    s_waitcnt lgkmcnt(14)
    ds_read_b64_tr_b16 v[114:115], v11 offset:14336
    s_waitcnt lgkmcnt(14)
    ds_read_b128 v[48:51], v25 offset:0
    s_waitcnt lgkmcnt(14)
    ds_read_b128 v[52:55], v25 offset:1024
    s_waitcnt lgkmcnt(14)
    ds_read_b128 v[56:59], v25 offset:2048
    s_waitcnt lgkmcnt(14)
    ds_read_b128 v[60:63], v25 offset:3072
    v_mfma_f32_16x16x32_bf16 v[88:91], v[124:127], v[144:147], v[88:91]
    v_mfma_f32_16x16x32_bf16 v[92:95], v[124:127], v[152:155], v[92:95]
    s_waitcnt lgkmcnt(14)
    ds_read_b64_tr_b16 v[116:117], v12 offset:12288
    s_waitcnt lgkmcnt(14)
    ds_read_b64_tr_b16 v[118:119], v12 offset:14336
    v_mfma_f32_16x16x32_bf16 v[64:67], v[96:99], v[160:163], v[64:67]
    s_waitcnt lgkmcnt(5)
    buffer_store_dwordx4 v[48:51], v1, s[24:27], s32 offen offset:0 sc1
    v_mfma_f32_16x16x32_bf16 v[68:71], v[96:99], v[168:171], v[68:71]
    ds_read_b64_tr_b16 v[120:121], v13 offset:12288
    ds_read_b64_tr_b16 v[122:123], v13 offset:14336
    v_mfma_f32_16x16x32_bf16 v[72:75], v[100:103], v[160:163], v[72:75]
    v_mfma_f32_16x16x32_bf16 v[76:79], v[100:103], v[168:171], v[76:79]
    ds_read_b64_tr_b16 v[124:125], v14 offset:12288
    ds_read_b64_tr_b16 v[126:127], v14 offset:14336
    v_mfma_f32_16x16x32_bf16 v[80:83], v[104:107], v[160:163], v[80:83]
    v_mfma_f32_16x16x32_bf16 v[84:87], v[104:107], v[168:171], v[84:87]
    ds_read_b64_tr_b16 v[96:97], v11 offset:16384
    ds_read_b64_tr_b16 v[98:99], v11 offset:18432
    v_mfma_f32_16x16x32_bf16 v[88:91], v[108:111], v[160:163], v[88:91]
    s_waitcnt lgkmcnt(10)
    buffer_store_dwordx4 v[52:55], v2, s[24:27], s32 offen offset:0 sc1
    v_mfma_f32_16x16x32_bf16 v[92:95], v[108:111], v[168:171], v[92:95]
    ds_read_b64_tr_b16 v[100:101], v12 offset:16384
    ds_read_b64_tr_b16 v[102:103], v12 offset:18432
    v_mfma_f32_16x16x32_bf16 v[64:67], v[112:115], v[176:179], v[64:67]
    v_mfma_f32_16x16x32_bf16 v[68:71], v[112:115], v[184:187], v[68:71]
    ds_read_b64_tr_b16 v[104:105], v13 offset:16384
    ds_read_b64_tr_b16 v[106:107], v13 offset:18432
    s_waitcnt lgkmcnt(10)
    v_mfma_f32_16x16x32_bf16 v[72:75], v[116:119], v[176:179], v[72:75]
    v_mfma_f32_16x16x32_bf16 v[76:79], v[116:119], v[184:187], v[76:79]
    ds_read_b64_tr_b16 v[108:109], v14 offset:16384
    ds_read_b64_tr_b16 v[110:111], v14 offset:18432
    s_waitcnt lgkmcnt(10)
    v_mfma_f32_16x16x32_bf16 v[80:83], v[120:123], v[176:179], v[80:83]
    buffer_store_dwordx4 v[56:59], v3, s[24:27], s32 offen offset:0 sc1
    v_mfma_f32_16x16x32_bf16 v[84:87], v[120:123], v[184:187], v[84:87]
    ds_read_b64_tr_b16 v[112:113], v11 offset:20480
    ds_read_b64_tr_b16 v[114:115], v11 offset:22528
    s_waitcnt lgkmcnt(10)
    v_mfma_f32_16x16x32_bf16 v[88:91], v[124:127], v[176:179], v[88:91]
    v_mfma_f32_16x16x32_bf16 v[92:95], v[124:127], v[184:187], v[92:95]
    ds_read_b64_tr_b16 v[116:117], v12 offset:20480
    ds_read_b64_tr_b16 v[118:119], v12 offset:22528
    s_waitcnt lgkmcnt(10)
    v_mfma_f32_16x16x32_bf16 v[64:67], v[96:99], v[192:195], v[64:67]
    v_mfma_f32_16x16x32_bf16 v[68:71], v[96:99], v[200:203], v[68:71]
    ds_read_b64_tr_b16 v[120:121], v13 offset:20480
    ds_read_b64_tr_b16 v[122:123], v13 offset:22528
    s_waitcnt lgkmcnt(10)
    v_mfma_f32_16x16x32_bf16 v[72:75], v[100:103], v[192:195], v[72:75]
    buffer_store_dwordx4 v[60:63], v4, s[24:27], s32 offen offset:0 sc1
    v_mfma_f32_16x16x32_bf16 v[76:79], v[100:103], v[200:203], v[76:79]
    ds_read_b64_tr_b16 v[124:125], v14 offset:20480
    ds_read_b64_tr_b16 v[126:127], v14 offset:22528
    s_waitcnt lgkmcnt(10)
    v_mfma_f32_16x16x32_bf16 v[80:83], v[104:107], v[192:195], v[80:83]
    v_mfma_f32_16x16x32_bf16 v[84:87], v[104:107], v[200:203], v[84:87]
    ds_read_b64_tr_b16 v[96:97], v11 offset:24576
    ds_read_b64_tr_b16 v[98:99], v11 offset:26624
    s_waitcnt lgkmcnt(10)
    v_mfma_f32_16x16x32_bf16 v[88:91], v[108:111], v[192:195], v[88:91]
    v_mfma_f32_16x16x32_bf16 v[92:95], v[108:111], v[200:203], v[92:95]
    ds_read_b64_tr_b16 v[100:101], v12 offset:24576
    ds_read_b64_tr_b16 v[102:103], v12 offset:26624
    s_waitcnt lgkmcnt(10)
    v_mfma_f32_16x16x32_bf16 v[64:67], v[112:115], v[208:211], v[64:67]
    v_mfma_f32_16x16x32_bf16 v[68:71], v[112:115], v[216:219], v[68:71]
    ds_read_b64_tr_b16 v[104:105], v13 offset:24576
    ds_read_b64_tr_b16 v[106:107], v13 offset:26624
    s_add_u32 s39, s33, 128
    s_mov_b32 m0, s40
    s_add_u32 s40, s40, 32768
    s_cmp_eq_u32 s40, s41
    s_cselect_b32 s40, s35, s40
    buffer_load_dwordx4 v1, s[12:15], s39 offen offset:0 nt lds
    s_add_u32 m0, m0, 1024
    s_waitcnt lgkmcnt(10)
    v_mfma_f32_16x16x32_bf16 v[72:75], v[116:119], v[208:211], v[72:75]
    v_mfma_f32_16x16x32_bf16 v[76:79], v[116:119], v[216:219], v[76:79]
    ds_read_b64_tr_b16 v[108:109], v14 offset:24576
    ds_read_b64_tr_b16 v[110:111], v14 offset:26624
    s_waitcnt lgkmcnt(10)
    v_mfma_f32_16x16x32_bf16 v[80:83], v[120:123], v[208:211], v[80:83]
    v_mfma_f32_16x16x32_bf16 v[84:87], v[120:123], v[216:219], v[84:87]
    ds_read_b64_tr_b16 v[112:113], v11 offset:28672
    ds_read_b64_tr_b16 v[114:115], v11 offset:30720
    s_waitcnt lgkmcnt(10)
    v_mfma_f32_16x16x32_bf16 v[88:91], v[124:127], v[208:211], v[88:91]
    v_mfma_f32_16x16x32_bf16 v[92:95], v[124:127], v[216:219], v[92:95]
    ds_read_b64_tr_b16 v[116:117], v12 offset:28672
    ds_read_b64_tr_b16 v[118:119], v12 offset:30720
    buffer_load_dwordx4 v2, s[12:15], s39 offen offset:0 nt lds
    s_add_u32 m0, m0, 1024
    s_waitcnt lgkmcnt(10)
    v_mfma_f32_16x16x32_bf16 v[64:67], v[96:99], v[224:227], v[64:67]
    v_mfma_f32_16x16x32_bf16 v[68:71], v[96:99], v[232:235], v[68:71]
    ds_read_b64_tr_b16 v[120:121], v13 offset:28672
    ds_read_b64_tr_b16 v[122:123], v13 offset:30720
    s_waitcnt lgkmcnt(10)
    v_mfma_f32_16x16x32_bf16 v[72:75], v[100:103], v[224:227], v[72:75]
    v_mfma_f32_16x16x32_bf16 v[76:79], v[100:103], v[232:235], v[76:79]
    ds_read_b64_tr_b16 v[124:125], v14 offset:28672
    ds_read_b64_tr_b16 v[126:127], v14 offset:30720
    s_waitcnt lgkmcnt(10)
    v_mfma_f32_16x16x32_bf16 v[80:83], v[104:107], v[224:227], v[80:83]
    v_mfma_f32_16x16x32_bf16 v[84:87], v[104:107], v[232:235], v[84:87]
    buffer_load_dwordx4 v3, s[12:15], s39 offen offset:0 nt lds
    s_add_u32 m0, m0, 1024
    s_waitcnt lgkmcnt(8)
    v_mfma_f32_16x16x32_bf16 v[88:91], v[108:111], v[224:227], v[88:91]
    v_mfma_f32_16x16x32_bf16 v[92:95], v[108:111], v[232:235], v[92:95]
    s_waitcnt lgkmcnt(6)
    v_mfma_f32_16x16x32_bf16 v[64:67], v[112:115], v[240:243], v[64:67]
    v_mfma_f32_16x16x32_bf16 v[68:71], v[112:115], v[248:251], v[68:71]
    s_waitcnt lgkmcnt(4)
    v_mfma_f32_16x16x32_bf16 v[72:75], v[116:119], v[240:243], v[72:75]
    v_mfma_f32_16x16x32_bf16 v[76:79], v[116:119], v[248:251], v[76:79]
    s_waitcnt lgkmcnt(2)
    v_mfma_f32_16x16x32_bf16 v[80:83], v[120:123], v[240:243], v[80:83]
    buffer_load_dwordx4 v4, s[12:15], s39 offen offset:0 nt lds
    v_mfma_f32_16x16x32_bf16 v[84:87], v[120:123], v[248:251], v[84:87]
    s_waitcnt lgkmcnt(0)
    v_mfma_f32_16x16x32_bf16 v[88:91], v[124:127], v[240:243], v[88:91]
    v_mfma_f32_16x16x32_bf16 v[92:95], v[124:127], v[248:251], v[92:95]
    v_add_u32 v11, s42, v7
    v_add_u32 v12, s42, v8
    v_add_u32 v13, s42, v9
    v_add_u32 v14, s42, v10
    s_add_u32 s42, s42, 32768
    s_cmp_eq_u32 s42, 163840
    s_cselect_b32 s42, 0, s42
    s_waitcnt vmcnt(16)
    s_barrier
    ds_read_b64_tr_b16 v[96:97], v11 offset:0
    ds_read_b64_tr_b16 v[98:99], v11 offset:2048
    ds_read_b64_tr_b16 v[100:101], v12 offset:0
    ds_read_b64_tr_b16 v[102:103], v12 offset:2048
    ds_read_b64_tr_b16 v[104:105], v13 offset:0
    ds_read_b64_tr_b16 v[106:107], v13 offset:2048
    ds_read_b64_tr_b16 v[108:109], v14 offset:0
    ds_read_b64_tr_b16 v[110:111], v14 offset:2048
    ds_read_b64_tr_b16 v[112:113], v11 offset:4096
    ds_read_b64_tr_b16 v[114:115], v11 offset:6144
    ds_read_b64_tr_b16 v[116:117], v12 offset:4096
    ds_read_b64_tr_b16 v[118:119], v12 offset:6144
    s_waitcnt lgkmcnt(10)
    v_mfma_f32_16x16x32_bf16 v[32:35], v[96:99], v[128:131], 0
    v_add_u32 v21, s40, v15
    v_add_u32 v25, s40, v16
    v_xor_b32 v22, 32, v21
    v_xor_b32 v23, 64, v21
    v_xor_b32 v24, 96, v21
    v_mfma_f32_16x16x32_bf16 v[36:39], v[96:99], v[136:139], 0
    ds_read_b64_tr_b16 v[120:121], v13 offset:4096
    ds_read_b64_tr_b16 v[122:123], v13 offset:6144
    v_mul_f32 v64, v64, v19
    v_mul_f32 v65, v65, v19
    v_mul_f32 v66, v66, v19
    v_mul_f32 v67, v67, v19
    v_cvt_pk_bf16_f32 v64, v64, v65
    s_waitcnt lgkmcnt(10)
    v_mfma_f32_16x16x32_bf16 v[40:43], v[100:103], v[128:131], 0
    v_cvt_pk_bf16_f32 v65, v66, v67
    ds_write_b64 v21, v[64:65] offset:0
    v_mul_f32 v68, v68, v20
    v_mul_f32 v69, v69, v20
    v_mul_f32 v70, v70, v20
    v_mfma_f32_16x16x32_bf16 v[44:47], v[100:103], v[136:139], 0
    ds_read_b64_tr_b16 v[124:125], v14 offset:4096
    ds_read_b64_tr_b16 v[126:127], v14 offset:6144
    v_mul_f32 v71, v71, v20
    v_cvt_pk_bf16_f32 v68, v68, v69
    v_cvt_pk_bf16_f32 v69, v70, v71
    ds_write_b64 v21, v[68:69] offset:2048
    v_mul_f32 v72, v72, v19
    s_waitcnt lgkmcnt(12)
    v_mfma_f32_16x16x32_bf16 v[48:51], v[104:107], v[128:131], 0
    v_mul_f32 v73, v73, v19
    v_mul_f32 v74, v74, v19
    v_mul_f32 v75, v75, v19
    v_cvt_pk_bf16_f32 v72, v72, v73
    v_cvt_pk_bf16_f32 v73, v74, v75
    v_mfma_f32_16x16x32_bf16 v[52:55], v[104:107], v[136:139], 0
    ds_read_b64_tr_b16 v[96:97], v11 offset:8192
    ds_read_b64_tr_b16 v[98:99], v11 offset:10240
    ds_write_b64 v22, v[72:73] offset:0
    v_mul_f32 v76, v76, v20
    v_mul_f32 v77, v77, v20
    v_mul_f32 v78, v78, v20
    v_mul_f32 v79, v79, v20
    s_waitcnt lgkmcnt(13)
    v_mfma_f32_16x16x32_bf16 v[56:59], v[108:111], v[128:131], 0
    v_cvt_pk_bf16_f32 v76, v76, v77
    v_cvt_pk_bf16_f32 v77, v78, v79
    ds_write_b64 v22, v[76:77] offset:2048
    v_mul_f32 v80, v80, v19
    v_mul_f32 v81, v81, v19
    v_mfma_f32_16x16x32_bf16 v[60:63], v[108:111], v[136:139], 0
    ds_read_b64_tr_b16 v[100:101], v12 offset:8192
    s_waitcnt lgkmcnt(14)
    ds_read_b64_tr_b16 v[102:103], v12 offset:10240
    v_mul_f32 v82, v82, v19
    v_mul_f32 v83, v83, v19
    v_cvt_pk_bf16_f32 v80, v80, v81
    v_cvt_pk_bf16_f32 v81, v82, v83
    s_waitcnt lgkmcnt(14)
    ds_write_b64 v23, v[80:81] offset:0
    v_mfma_f32_16x16x32_bf16 v[32:35], v[112:115], v[144:147], v[32:35]
    v_mul_f32 v84, v84, v20
    v_mul_f32 v85, v85, v20
    v_mul_f32 v86, v86, v20
    v_mul_f32 v87, v87, v20
    v_cvt_pk_bf16_f32 v84, v84, v85
    v_mfma_f32_16x16x32_bf16 v[36:39], v[112:115], v[152:155], v[36:39]
    s_waitcnt lgkmcnt(14)
    ds_read_b64_tr_b16 v[104:105], v13 offset:8192
    s_waitcnt lgkmcnt(14)
    ds_read_b64_tr_b16 v[106:107], v13 offset:10240
    v_cvt_pk_bf16_f32 v85, v86, v87
    s_waitcnt lgkmcnt(14)
    ds_write_b64 v23, v[84:85] offset:2048
    v_mul_f32 v88, v88, v19
    v_mul_f32 v89, v89, v19
    v_mul_f32 v90, v90, v19
    v_mfma_f32_16x16x32_bf16 v[40:43], v[116:119], v[144:147], v[40:43]
    v_mul_f32 v91, v91, v19
    v_cvt_pk_bf16_f32 v88, v88, v89
    v_cvt_pk_bf16_f32 v89, v90, v91
    s_waitcnt lgkmcnt(14)
    ds_write_b64 v24, v[88:89] offset:0
    v_mul_f32 v92, v92, v20
    v_mfma_f32_16x16x32_bf16 v[44:47], v[116:119], v[152:155], v[44:47]
    s_waitcnt lgkmcnt(14)
    ds_read_b64_tr_b16 v[108:109], v14 offset:8192
    s_waitcnt lgkmcnt(14)
    ds_read_b64_tr_b16 v[110:111], v14 offset:10240
    v_mul_f32 v93, v93, v20
    v_mul_f32 v94, v94, v20
    v_mul_f32 v95, v95, v20
    v_cvt_pk_bf16_f32 v92, v92, v93
    v_cvt_pk_bf16_f32 v93, v94, v95
    v_mfma_f32_16x16x32_bf16 v[48:51], v[120:123], v[144:147], v[48:51]
    s_waitcnt lgkmcnt(14)
    ds_write_b64 v24, v[92:93] offset:2048
    v_mfma_f32_16x16x32_bf16 v[52:55], v[120:123], v[152:155], v[52:55]
    s_waitcnt lgkmcnt(14)
    ds_read_b64_tr_b16 v[112:113], v11 offset:12288
    s_waitcnt lgkmcnt(14)
    ds_read_b64_tr_b16 v[114:115], v11 offset:14336
    s_waitcnt lgkmcnt(14)
    ds_read_b128 v[228:231], v25 offset:0
    s_waitcnt lgkmcnt(14)
    ds_read_b128 v[236:239], v25 offset:1024
    s_waitcnt lgkmcnt(14)
    ds_read_b128 v[244:247], v25 offset:2048
    s_waitcnt lgkmcnt(14)
    ds_read_b128 v[252:255], v25 offset:3072
    v_mfma_f32_16x16x32_bf16 v[56:59], v[124:127], v[144:147], v[56:59]
    v_mfma_f32_16x16x32_bf16 v[60:63], v[124:127], v[152:155], v[60:63]
    s_waitcnt lgkmcnt(14)
    ds_read_b64_tr_b16 v[116:117], v12 offset:12288
    s_waitcnt lgkmcnt(14)
    ds_read_b64_tr_b16 v[118:119], v12 offset:14336
    v_mfma_f32_16x16x32_bf16 v[32:35], v[96:99], v[160:163], v[32:35]
    s_waitcnt lgkmcnt(2)
    s_add_u32 s39, s33, 128
    s_mov_b32 m0, s40
    s_add_u32 s40, s40, 32768
    s_cmp_eq_u32 s40, s41
    s_cselect_b32 s40, s35, s40
    buffer_load_dwordx4 v1, s[16:19], s39 offen offset:0 nt lds
    s_add_u32 m0, m0, 1024
    v_mfma_f32_16x16x32_bf16 v[36:39], v[96:99], v[168:171], v[36:39]
    ds_read_b64_tr_b16 v[120:121], v13 offset:12288
    ds_read_b64_tr_b16 v[122:123], v13 offset:14336
    v_mfma_f32_16x16x32_bf16 v[40:43], v[100:103], v[160:163], v[40:43]
    v_mfma_f32_16x16x32_bf16 v[44:47], v[100:103], v[168:171], v[44:47]
    ds_read_b64_tr_b16 v[124:125], v14 offset:12288
    ds_read_b64_tr_b16 v[126:127], v14 offset:14336
    v_mfma_f32_16x16x32_bf16 v[48:51], v[104:107], v[160:163], v[48:51]
    v_mfma_f32_16x16x32_bf16 v[52:55], v[104:107], v[168:171], v[52:55]
    ds_read_b64_tr_b16 v[96:97], v11 offset:16384
    ds_read_b64_tr_b16 v[98:99], v11 offset:18432
    v_mfma_f32_16x16x32_bf16 v[56:59], v[108:111], v[160:163], v[56:59]
    v_mfma_f32_16x16x32_bf16 v[60:63], v[108:111], v[168:171], v[60:63]
    ds_read_b64_tr_b16 v[100:101], v12 offset:16384
    ds_read_b64_tr_b16 v[102:103], v12 offset:18432
    v_mfma_f32_16x16x32_bf16 v[32:35], v[112:115], v[176:179], v[32:35]
    v_mfma_f32_16x16x32_bf16 v[36:39], v[112:115], v[184:187], v[36:39]
    ds_read_b64_tr_b16 v[104:105], v13 offset:16384
    ds_read_b64_tr_b16 v[106:107], v13 offset:18432
    s_waitcnt lgkmcnt(10)
    v_mfma_f32_16x16x32_bf16 v[40:43], v[116:119], v[176:179], v[40:43]
    v_mfma_f32_16x16x32_bf16 v[44:47], v[116:119], v[184:187], v[44:47]
    ds_read_b64_tr_b16 v[108:109], v14 offset:16384
    ds_read_b64_tr_b16 v[110:111], v14 offset:18432
    s_waitcnt lgkmcnt(10)
    v_mfma_f32_16x16x32_bf16 v[48:51], v[120:123], v[176:179], v[48:51]
    v_mfma_f32_16x16x32_bf16 v[52:55], v[120:123], v[184:187], v[52:55]
    ds_read_b64_tr_b16 v[112:113], v11 offset:20480
    ds_read_b64_tr_b16 v[114:115], v11 offset:22528
    s_waitcnt lgkmcnt(10)
    v_mfma_f32_16x16x32_bf16 v[56:59], v[124:127], v[176:179], v[56:59]
    buffer_load_dwordx4 v2, s[16:19], s39 offen offset:0 nt lds
    s_add_u32 m0, m0, 1024
    v_mfma_f32_16x16x32_bf16 v[60:63], v[124:127], v[184:187], v[60:63]
    ds_read_b64_tr_b16 v[116:117], v12 offset:20480
    ds_read_b64_tr_b16 v[118:119], v12 offset:22528
    s_waitcnt lgkmcnt(10)
    v_mfma_f32_16x16x32_bf16 v[32:35], v[96:99], v[192:195], v[32:35]
    v_mfma_f32_16x16x32_bf16 v[36:39], v[96:99], v[200:203], v[36:39]
    ds_read_b64_tr_b16 v[120:121], v13 offset:20480
    ds_read_b64_tr_b16 v[122:123], v13 offset:22528
    s_waitcnt lgkmcnt(10)
    v_mfma_f32_16x16x32_bf16 v[40:43], v[100:103], v[192:195], v[40:43]
    v_mfma_f32_16x16x32_bf16 v[44:47], v[100:103], v[200:203], v[44:47]
    ds_read_b64_tr_b16 v[124:125], v14 offset:20480
    ds_read_b64_tr_b16 v[126:127], v14 offset:22528
    s_waitcnt lgkmcnt(10)
    v_mfma_f32_16x16x32_bf16 v[48:51], v[104:107], v[192:195], v[48:51]
    v_mfma_f32_16x16x32_bf16 v[52:55], v[104:107], v[200:203], v[52:55]
    ds_read_b64_tr_b16 v[96:97], v11 offset:24576
    ds_read_b64_tr_b16 v[98:99], v11 offset:26624
    s_waitcnt lgkmcnt(10)
    v_mfma_f32_16x16x32_bf16 v[56:59], v[108:111], v[192:195], v[56:59]
    v_mfma_f32_16x16x32_bf16 v[60:63], v[108:111], v[200:203], v[60:63]
    ds_read_b64_tr_b16 v[100:101], v12 offset:24576
    ds_read_b64_tr_b16 v[102:103], v12 offset:26624
    s_waitcnt lgkmcnt(10)
    v_mfma_f32_16x16x32_bf16 v[32:35], v[112:115], v[208:211], v[32:35]
    v_mfma_f32_16x16x32_bf16 v[36:39], v[112:115], v[216:219], v[36:39]
    ds_read_b64_tr_b16 v[104:105], v13 offset:24576
    ds_read_b64_tr_b16 v[106:107], v13 offset:26624
    s_waitcnt lgkmcnt(10)
    v_mfma_f32_16x16x32_bf16 v[40:43], v[116:119], v[208:211], v[40:43]
    v_mfma_f32_16x16x32_bf16 v[44:47], v[116:119], v[216:219], v[44:47]
    ds_read_b64_tr_b16 v[108:109], v14 offset:24576
    ds_read_b64_tr_b16 v[110:111], v14 offset:26624
    s_waitcnt lgkmcnt(10)
    v_mfma_f32_16x16x32_bf16 v[48:51], v[120:123], v[208:211], v[48:51]
    v_mfma_f32_16x16x32_bf16 v[52:55], v[120:123], v[216:219], v[52:55]
    ds_read_b64_tr_b16 v[112:113], v11 offset:28672
    ds_read_b64_tr_b16 v[114:115], v11 offset:30720
    buffer_load_dwordx4 v3, s[16:19], s39 offen offset:0 nt lds
    s_add_u32 m0, m0, 1024
    s_waitcnt lgkmcnt(10)
    v_mfma_f32_16x16x32_bf16 v[56:59], v[124:127], v[208:211], v[56:59]
    v_mfma_f32_16x16x32_bf16 v[60:63], v[124:127], v[216:219], v[60:63]
    ds_read_b64_tr_b16 v[116:117], v12 offset:28672
    ds_read_b64_tr_b16 v[118:119], v12 offset:30720
    s_waitcnt lgkmcnt(10)
    v_mfma_f32_16x16x32_bf16 v[32:35], v[96:99], v[224:227], v[32:35]
    v_mfma_f32_16x16x32_bf16 v[36:39], v[96:99], v[232:235], v[36:39]
    ds_read_b64_tr_b16 v[120:121], v13 offset:28672
    ds_read_b64_tr_b16 v[122:123], v13 offset:30720
    s_waitcnt lgkmcnt(10)
    v_mfma_f32_16x16x32_bf16 v[40:43], v[100:103], v[224:227], v[40:43]
    v_mfma_f32_16x16x32_bf16 v[44:47], v[100:103], v[232:235], v[44:47]
    ds_read_b64_tr_b16 v[124:125], v14 offset:28672
    ds_read_b64_tr_b16 v[126:127], v14 offset:30720
    s_waitcnt lgkmcnt(10)
    v_mfma_f32_16x16x32_bf16 v[48:51], v[104:107], v[224:227], v[48:51]
    v_mfma_f32_16x16x32_bf16 v[52:55], v[104:107], v[232:235], v[52:55]
    s_waitcnt lgkmcnt(8)
    v_mfma_f32_16x16x32_bf16 v[56:59], v[108:111], v[224:227], v[56:59]
    v_mfma_f32_16x16x32_bf16 v[60:63], v[108:111], v[232:235], v[60:63]
    s_waitcnt lgkmcnt(6)
    v_mfma_f32_16x16x32_bf16 v[32:35], v[112:115], v[240:243], v[32:35]
    v_mfma_f32_16x16x32_bf16 v[36:39], v[112:115], v[248:251], v[36:39]
    s_waitcnt lgkmcnt(4)
    v_mfma_f32_16x16x32_bf16 v[40:43], v[116:119], v[240:243], v[40:43]
    v_mfma_f32_16x16x32_bf16 v[44:47], v[116:119], v[248:251], v[44:47]
    s_waitcnt lgkmcnt(2)
    v_mfma_f32_16x16x32_bf16 v[48:51], v[120:123], v[240:243], v[48:51]
    buffer_load_dwordx4 v4, s[16:19], s39 offen offset:0 nt lds
    v_mfma_f32_16x16x32_bf16 v[52:55], v[120:123], v[248:251], v[52:55]
    s_waitcnt lgkmcnt(0)
    v_mfma_f32_16x16x32_bf16 v[56:59], v[124:127], v[240:243], v[56:59]
    v_mfma_f32_16x16x32_bf16 v[60:63], v[124:127], v[248:251], v[60:63]
    s_add_u32 s28, s42, s35
    s_add_u32 s42, s42, 32768
    s_cmp_eq_u32 s42, 163840
    s_cselect_b32 s42, 0, s42
    v_add_u32 v13, s28, v5
    v_add_u32 v11, s42, v5
    v_add_u32 v14, s28, v6
    v_add_u32 v12, s42, v6
    s_add_u32 s42, s42, 32768
    s_cmp_eq_u32 s42, 163840
    s_cselect_b32 s42, 0, s42
    s_waitcnt vmcnt(12)
    s_barrier
    ds_read_b128 v[96:99], v13 offset:0
    ds_read_b128 v[64:67], v11 offset:0
    ds_read_b128 v[100:103], v13 offset:2048
    ds_read_b128 v[68:71], v11 offset:2048
    ds_read_b128 v[72:75], v11 offset:4096
    ds_read_b128 v[76:79], v11 offset:6144
    ds_read_b128 v[80:83], v11 offset:8192
    ds_read_b128 v[84:87], v11 offset:10240
    ds_read_b128 v[88:91], v11 offset:12288
    ds_read_b128 v[92:95], v11 offset:14336
    ds_read_b128 v[104:107], v14 offset:0
    s_mov_b32 s34, s32
    s_mov_b32 s32, s33
    s_add_u32 s36, s36, 1
    s_waitcnt lgkmcnt(9)
    v_mfma_f32_16x16x32_bf16 v[128:131], v[64:67], v[96:99], 0
    v_add_u32 v21, s40, v15
    v_add_u32 v25, s40, v16
    v_xor_b32 v22, 32, v21
    v_xor_b32 v23, 64, v21
    v_xor_b32 v24, 96, v21
    s_waitcnt lgkmcnt(8)
    v_mfma_f32_16x16x32_bf16 v[136:139], v[64:67], v[100:103], 0
    ds_read_b128 v[112:115], v12 offset:0
    ds_read_b128 v[108:111], v14 offset:2048
    v_mul_f32 v32, v32, v19
    v_mul_f32 v33, v33, v19
    v_mul_f32 v34, v34, v19
    v_mul_f32 v35, v35, v19
    v_cvt_pk_bf16_f32 v32, v32, v33
    s_waitcnt lgkmcnt(9)
    v_mfma_f32_16x16x32_bf16 v[132:135], v[68:71], v[96:99], 0
    v_cvt_pk_bf16_f32 v33, v34, v35
    ds_write_b64 v21, v[32:33] offset:0
    v_mul_f32 v36, v36, v20
    v_mul_f32 v37, v37, v20
    v_mul_f32 v38, v38, v20
    v_mfma_f32_16x16x32_bf16 v[140:143], v[68:71], v[100:103], 0
    ds_read_b128 v[116:119], v12 offset:2048
    v_mul_f32 v39, v39, v20
    v_cvt_pk_bf16_f32 v36, v36, v37
    v_cvt_pk_bf16_f32 v37, v38, v39
    ds_write_b64 v21, v[36:37] offset:2048
    v_mul_f32 v40, v40, v19
    s_waitcnt lgkmcnt(11)
    v_mfma_f32_16x16x32_bf16 v[144:147], v[72:75], v[96:99], 0
    v_mul_f32 v41, v41, v19
    v_mul_f32 v42, v42, v19
    v_mul_f32 v43, v43, v19
    v_cvt_pk_bf16_f32 v40, v40, v41
    v_cvt_pk_bf16_f32 v41, v42, v43
    v_mfma_f32_16x16x32_bf16 v[152:155], v[72:75], v[100:103], 0
    ds_read_b128 v[120:123], v12 offset:4096
    ds_write_b64 v22, v[40:41] offset:0
    v_mul_f32 v44, v44, v20
    v_mul_f32 v45, v45, v20
    v_mul_f32 v46, v46, v20
    v_mul_f32 v47, v47, v20
    s_waitcnt lgkmcnt(12)
    v_mfma_f32_16x16x32_bf16 v[148:151], v[76:79], v[96:99], 0
    v_cvt_pk_bf16_f32 v44, v44, v45
    v_cvt_pk_bf16_f32 v45, v46, v47
    ds_write_b64 v22, v[44:45] offset:2048
    v_mul_f32 v48, v48, v19
    v_mul_f32 v49, v49, v19
    v_mfma_f32_16x16x32_bf16 v[156:159], v[76:79], v[100:103], 0
    ds_read_b128 v[124:127], v12 offset:6144
    v_mul_f32 v50, v50, v19
    v_mul_f32 v51, v51, v19
    v_cvt_pk_bf16_f32 v48, v48, v49
    v_cvt_pk_bf16_f32 v49, v50, v51
    ds_write_b64 v23, v[48:49] offset:0
    s_waitcnt lgkmcnt(14)
    v_mfma_f32_16x16x32_bf16 v[160:163], v[80:83], v[96:99], 0
    v_mul_f32 v52, v52, v20
    v_mul_f32 v53, v53, v20
    v_mul_f32 v54, v54, v20
    v_mul_f32 v55, v55, v20
    v_cvt_pk_bf16_f32 v52, v52, v53
    v_mfma_f32_16x16x32_bf16 v[168:171], v[80:83], v[100:103], 0
    ds_read_b128 v[64:67], v12 offset:8192
    v_cvt_pk_bf16_f32 v53, v54, v55
    s_waitcnt lgkmcnt(14)
    ds_write_b64 v23, v[52:53] offset:2048
    v_mul_f32 v56, v56, v19
    v_mul_f32 v57, v57, v19
    v_mul_f32 v58, v58, v19
    v_mfma_f32_16x16x32_bf16 v[164:167], v[84:87], v[96:99], 0
    v_mul_f32 v59, v59, v19
    v_cvt_pk_bf16_f32 v56, v56, v57
    v_cvt_pk_bf16_f32 v57, v58, v59
    s_waitcnt lgkmcnt(14)
    ds_write_b64 v24, v[56:57] offset:0
    v_mul_f32 v60, v60, v20
    v_mfma_f32_16x16x32_bf16 v[172:175], v[84:87], v[100:103], 0
    s_waitcnt lgkmcnt(14)
    ds_read_b128 v[68:71], v12 offset:10240
    v_mul_f32 v61, v61, v20
    v_mul_f32 v62, v62, v20
    v_mul_f32 v63, v63, v20
    v_cvt_pk_bf16_f32 v60, v60, v61
    v_cvt_pk_bf16_f32 v61, v62, v63
    v_mfma_f32_16x16x32_bf16 v[176:179], v[88:91], v[96:99], 0
    s_waitcnt lgkmcnt(14)
    ds_write_b64 v24, v[60:61] offset:2048
    v_mfma_f32_16x16x32_bf16 v[184:187], v[88:91], v[100:103], 0
    s_waitcnt lgkmcnt(14)
    ds_read_b128 v[72:75], v12 offset:12288
    s_waitcnt lgkmcnt(14)
    ds_read_b128 v[48:51], v25 offset:0
    s_waitcnt lgkmcnt(14)
    ds_read_b128 v[52:55], v25 offset:1024
    s_waitcnt lgkmcnt(14)
    ds_read_b128 v[56:59], v25 offset:2048
    s_waitcnt lgkmcnt(14)
    ds_read_b128 v[60:63], v25 offset:3072
    v_mfma_f32_16x16x32_bf16 v[180:183], v[92:95], v[96:99], 0
    v_mov_b32 v32, v228
    v_mov_b32 v33, v229
    v_mfma_f32_16x16x32_bf16 v[188:191], v[92:95], v[100:103], 0
    s_waitcnt lgkmcnt(14)
    ds_read_b128 v[76:79], v12 offset:14336
    v_mov_b32 v34, v230
    v_mov_b32 v35, v231
    v_mfma_f32_16x16x32_bf16 v[128:131], v[112:115], v[104:107], v[128:131]
    v_mov_b32 v36, v236
    v_mov_b32 v37, v237
    s_waitcnt lgkmcnt(1)
    s_add_u32 s39, s32, 256
    s_mov_b32 m0, s40
    s_add_u32 s40, s40, 32768
    s_cmp_eq_u32 s40, s41
    s_cselect_b32 s40, s35, s40
    buffer_load_dwordx4 v1, s[12:15], s39 offen offset:0 nt lds
    s_add_u32 m0, m0, 1024
    v_mfma_f32_16x16x32_bf16 v[136:139], v[112:115], v[108:111], v[136:139]
    ds_read_b128 v[80:83], v11 offset:16384
    v_mov_b32 v38, v238
    v_mov_b32 v39, v239
    v_mfma_f32_16x16x32_bf16 v[132:135], v[116:119], v[104:107], v[132:135]
    v_mov_b32 v40, v244
    v_mov_b32 v41, v245
    v_mfma_f32_16x16x32_bf16 v[140:143], v[116:119], v[108:111], v[140:143]
    ds_read_b128 v[84:87], v11 offset:18432
    v_mov_b32 v42, v246
    v_mov_b32 v43, v247
    v_mfma_f32_16x16x32_bf16 v[144:147], v[120:123], v[104:107], v[144:147]
    v_mov_b32 v44, v252
    v_mov_b32 v45, v253
    v_mfma_f32_16x16x32_bf16 v[152:155], v[120:123], v[108:111], v[152:155]
    ds_read_b128 v[88:91], v11 offset:20480
    v_mov_b32 v46, v254
    v_mov_b32 v47, v255
    v_mfma_f32_16x16x32_bf16 v[148:151], v[124:127], v[104:107], v[148:151]
    buffer_load_dwordx4 v2, s[12:15], s39 offen offset:0 nt lds
    s_add_u32 m0, m0, 1024
    v_mfma_f32_16x16x32_bf16 v[156:159], v[124:127], v[108:111], v[156:159]
    ds_read_b128 v[92:95], v11 offset:22528
    v_mfma_f32_16x16x32_bf16 v[160:163], v[64:67], v[104:107], v[160:163]
    v_mfma_f32_16x16x32_bf16 v[168:171], v[64:67], v[108:111], v[168:171]
    ds_read_b128 v[112:115], v11 offset:24576
    v_mfma_f32_16x16x32_bf16 v[164:167], v[68:71], v[104:107], v[164:167]
    v_mfma_f32_16x16x32_bf16 v[172:175], v[68:71], v[108:111], v[172:175]
    ds_read_b128 v[116:119], v11 offset:26624
    v_mfma_f32_16x16x32_bf16 v[176:179], v[72:75], v[104:107], v[176:179]
    buffer_load_dwordx4 v3, s[12:15], s39 offen offset:0 nt lds
    s_add_u32 m0, m0, 1024
    v_mfma_f32_16x16x32_bf16 v[184:187], v[72:75], v[108:111], v[184:187]
    ds_read_b128 v[120:123], v11 offset:28672
    s_waitcnt lgkmcnt(7)
    v_mfma_f32_16x16x32_bf16 v[180:183], v[76:79], v[104:107], v[180:183]
    v_mfma_f32_16x16x32_bf16 v[188:191], v[76:79], v[108:111], v[188:191]
    ds_read_b128 v[124:127], v11 offset:30720
    s_waitcnt lgkmcnt(7)
    v_mfma_f32_16x16x32_bf16 v[192:195], v[80:83], v[96:99], 0
    v_mfma_f32_16x16x32_bf16 v[200:203], v[80:83], v[100:103], 0
    ds_read_b128 v[64:67], v12 offset:16384
    s_waitcnt lgkmcnt(7)
    v_mfma_f32_16x16x32_bf16 v[196:199], v[84:87], v[96:99], 0
    buffer_load_dwordx4 v4, s[12:15], s39 offen offset:0 nt lds
    v_mfma_f32_16x16x32_bf16 v[204:207], v[84:87], v[100:103], 0
    ds_read_b128 v[68:71], v12 offset:18432
    s_waitcnt lgkmcnt(7)
    v_mfma_f32_16x16x32_bf16 v[208:211], v[88:91], v[96:99], 0
    v_mfma_f32_16x16x32_bf16 v[216:219], v[88:91], v[100:103], 0
    ds_read_b128 v[72:75], v12 offset:20480
    s_waitcnt lgkmcnt(7)
    v_mfma_f32_16x16x32_bf16 v[212:215], v[92:95], v[96:99], 0
    v_mfma_f32_16x16x32_bf16 v[220:223], v[92:95], v[100:103], 0
    ds_read_b128 v[76:79], v12 offset:22528
    s_waitcnt lgkmcnt(7)
    v_mfma_f32_16x16x32_bf16 v[224:227], v[112:115], v[96:99], 0
    v_mfma_f32_16x16x32_bf16 v[232:235], v[112:115], v[100:103], 0
    ds_read_b128 v[80:83], v12 offset:24576
    s_add_u32 s39, s32, 256
    s_mov_b32 m0, s40
    s_add_u32 s40, s40, 32768
    s_cmp_eq_u32 s40, s41
    s_cselect_b32 s40, s35, s40
    buffer_load_dwordx4 v1, s[16:19], s39 offen offset:0 nt lds
    s_add_u32 m0, m0, 1024
    s_waitcnt lgkmcnt(7)
    v_mfma_f32_16x16x32_bf16 v[228:231], v[116:119], v[96:99], 0
    v_mfma_f32_16x16x32_bf16 v[236:239], v[116:119], v[100:103], 0
    ds_read_b128 v[84:87], v12 offset:26624
    s_waitcnt lgkmcnt(7)
    v_mfma_f32_16x16x32_bf16 v[240:243], v[120:123], v[96:99], 0
    v_mfma_f32_16x16x32_bf16 v[248:251], v[120:123], v[100:103], 0
    ds_read_b128 v[88:91], v12 offset:28672
    s_waitcnt lgkmcnt(7)
    v_mfma_f32_16x16x32_bf16 v[244:247], v[124:127], v[96:99], 0
    v_mfma_f32_16x16x32_bf16 v[252:255], v[124:127], v[100:103], 0
    ds_read_b128 v[92:95], v12 offset:30720
    buffer_load_dwordx4 v2, s[16:19], s39 offen offset:0 nt lds
    s_add_u32 m0, m0, 1024
    s_waitcnt lgkmcnt(7)
    v_mfma_f32_16x16x32_bf16 v[192:195], v[64:67], v[104:107], v[192:195]
    v_mfma_f32_16x16x32_bf16 v[200:203], v[64:67], v[108:111], v[200:203]
    s_waitcnt lgkmcnt(6)
    v_mfma_f32_16x16x32_bf16 v[196:199], v[68:71], v[104:107], v[196:199]
    v_mfma_f32_16x16x32_bf16 v[204:207], v[68:71], v[108:111], v[204:207]
    s_waitcnt lgkmcnt(5)
    v_mfma_f32_16x16x32_bf16 v[208:211], v[72:75], v[104:107], v[208:211]
    v_mfma_f32_16x16x32_bf16 v[216:219], v[72:75], v[108:111], v[216:219]
    buffer_load_dwordx4 v3, s[16:19], s39 offen offset:0 nt lds
    s_add_u32 m0, m0, 1024
    s_waitcnt lgkmcnt(4)
    v_mfma_f32_16x16x32_bf16 v[212:215], v[76:79], v[104:107], v[212:215]
    v_mfma_f32_16x16x32_bf16 v[220:223], v[76:79], v[108:111], v[220:223]
    s_waitcnt lgkmcnt(3)
    v_mfma_f32_16x16x32_bf16 v[224:227], v[80:83], v[104:107], v[224:227]
    v_mfma_f32_16x16x32_bf16 v[232:235], v[80:83], v[108:111], v[232:235]
    s_waitcnt lgkmcnt(2)
    v_mfma_f32_16x16x32_bf16 v[228:231], v[84:87], v[104:107], v[228:231]
    v_mfma_f32_16x16x32_bf16 v[236:239], v[84:87], v[108:111], v[236:239]
    s_waitcnt lgkmcnt(1)
    v_mfma_f32_16x16x32_bf16 v[240:243], v[88:91], v[104:107], v[240:243]
    buffer_load_dwordx4 v4, s[16:19], s39 offen offset:0 nt lds
    v_mfma_f32_16x16x32_bf16 v[248:251], v[88:91], v[108:111], v[248:251]
    s_waitcnt lgkmcnt(0)
    v_mfma_f32_16x16x32_bf16 v[244:247], v[92:95], v[104:107], v[244:247]
    v_mfma_f32_16x16x32_bf16 v[252:255], v[92:95], v[108:111], v[252:255]
    s_add_u32 s28, s42, s35
    s_add_u32 s42, s42, 32768
    s_cmp_eq_u32 s42, 163840
    s_cselect_b32 s42, 0, s42
    v_add_u32 v13, s28, v5
    v_add_u32 v11, s42, v5
    v_add_u32 v14, s28, v6
    v_add_u32 v12, s42, v6
    s_add_u32 s42, s42, 32768
    s_cmp_eq_u32 s42, 163840
    s_cselect_b32 s42, 0, s42
    s_waitcnt vmcnt(8)
    s_barrier
    ds_read_b128 v[96:99], v13 offset:0
    ds_read_b128 v[112:115], v11 offset:0
    ds_read_b128 v[100:103], v13 offset:2048
    ds_read_b128 v[116:119], v11 offset:2048
    ds_read_b128 v[120:123], v11 offset:4096
    ds_read_b128 v[124:127], v11 offset:6144
    ds_read_b128 v[64:67], v11 offset:8192
    ds_read_b128 v[68:71], v11 offset:10240
    ds_read_b128 v[72:75], v11 offset:12288
    ds_read_b128 v[76:79], v11 offset:14336
    ds_read_b128 v[104:107], v14 offset:0
    s_waitcnt lgkmcnt(9)
    v_mfma_f32_16x16x32_bf16 v[128:131], v[112:115], v[96:99], v[128:131]
    s_waitcnt lgkmcnt(8)
    v_mfma_f32_16x16x32_bf16 v[136:139], v[112:115], v[100:103], v[136:139]
    ds_read_b128 v[80:83], v12 offset:0
    ds_read_b128 v[108:111], v14 offset:2048
    s_mov_b32 m0, s40
    s_add_u32 s40, s40, 32768
    s_cmp_eq_u32 s40, s41
    s_cselect_b32 s40, s35, s40
    buffer_load_dwordx4 v1, s[20:23], s32 offen offset:0 nt lds
    s_add_u32 m0, m0, 1024
    s_waitcnt lgkmcnt(9)
    v_mfma_f32_16x16x32_bf16 v[132:135], v[116:119], v[96:99], v[132:135]
    v_mfma_f32_16x16x32_bf16 v[140:143], v[116:119], v[100:103], v[140:143]
    ds_read_b128 v[84:87], v12 offset:2048
    s_waitcnt lgkmcnt(9)
    v_mfma_f32_16x16x32_bf16 v[144:147], v[120:123], v[96:99], v[144:147]
    v_mfma_f32_16x16x32_bf16 v[152:155], v[120:123], v[100:103], v[152:155]
    ds_read_b128 v[88:91], v12 offset:4096
    s_waitcnt lgkmcnt(9)
    v_mfma_f32_16x16x32_bf16 v[148:151], v[124:127], v[96:99], v[148:151]
    v_mfma_f32_16x16x32_bf16 v[156:159], v[124:127], v[100:103], v[156:159]
    ds_read_b128 v[92:95], v12 offset:6144
    s_waitcnt lgkmcnt(9)
    v_mfma_f32_16x16x32_bf16 v[160:163], v[64:67], v[96:99], v[160:163]
    v_mfma_f32_16x16x32_bf16 v[168:171], v[64:67], v[100:103], v[168:171]
    ds_read_b128 v[112:115], v12 offset:8192
    s_waitcnt lgkmcnt(9)
    v_mfma_f32_16x16x32_bf16 v[164:167], v[68:71], v[96:99], v[164:167]
    v_mfma_f32_16x16x32_bf16 v[172:175], v[68:71], v[100:103], v[172:175]
    ds_read_b128 v[116:119], v12 offset:10240
    s_waitcnt lgkmcnt(9)
    v_mfma_f32_16x16x32_bf16 v[176:179], v[72:75], v[96:99], v[176:179]
    v_mfma_f32_16x16x32_bf16 v[184:187], v[72:75], v[100:103], v[184:187]
    ds_read_b128 v[120:123], v12 offset:12288
    s_waitcnt lgkmcnt(9)
    v_mfma_f32_16x16x32_bf16 v[180:183], v[76:79], v[96:99], v[180:183]
    v_mfma_f32_16x16x32_bf16 v[188:191], v[76:79], v[100:103], v[188:191]
    ds_read_b128 v[124:127], v12 offset:14336
    s_waitcnt lgkmcnt(8)
    v_mfma_f32_16x16x32_bf16 v[128:131], v[80:83], v[104:107], v[128:131]
    s_waitcnt lgkmcnt(7)
    v_mfma_f32_16x16x32_bf16 v[136:139], v[80:83], v[108:111], v[136:139]
    ds_read_b128 v[64:67], v11 offset:16384
    s_waitcnt lgkmcnt(7)
    v_mfma_f32_16x16x32_bf16 v[132:135], v[84:87], v[104:107], v[132:135]
    v_mfma_f32_16x16x32_bf16 v[140:143], v[84:87], v[108:111], v[140:143]
    ds_read_b128 v[68:71], v11 offset:18432
    s_waitcnt lgkmcnt(7)
    v_mfma_f32_16x16x32_bf16 v[144:147], v[88:91], v[104:107], v[144:147]
    buffer_load_dwordx4 v2, s[20:23], s32 offen offset:0 nt lds
    s_add_u32 m0, m0, 1024
    v_mfma_f32_16x16x32_bf16 v[152:155], v[88:91], v[108:111], v[152:155]
    ds_read_b128 v[72:75], v11 offset:20480
    s_waitcnt lgkmcnt(7)
    v_mfma_f32_16x16x32_bf16 v[148:151], v[92:95], v[104:107], v[148:151]
    v_mfma_f32_16x16x32_bf16 v[156:159], v[92:95], v[108:111], v[156:159]
    ds_read_b128 v[76:79], v11 offset:22528
    s_waitcnt lgkmcnt(7)
    v_mfma_f32_16x16x32_bf16 v[160:163], v[112:115], v[104:107], v[160:163]
    v_mfma_f32_16x16x32_bf16 v[168:171], v[112:115], v[108:111], v[168:171]
    ds_read_b128 v[80:83], v11 offset:24576
    s_waitcnt lgkmcnt(7)
    v_mfma_f32_16x16x32_bf16 v[164:167], v[116:119], v[104:107], v[164:167]
    v_mfma_f32_16x16x32_bf16 v[172:175], v[116:119], v[108:111], v[172:175]
    ds_read_b128 v[84:87], v11 offset:26624
    s_waitcnt lgkmcnt(7)
    v_mfma_f32_16x16x32_bf16 v[176:179], v[120:123], v[104:107], v[176:179]
    v_mfma_f32_16x16x32_bf16 v[184:187], v[120:123], v[108:111], v[184:187]
    ds_read_b128 v[88:91], v11 offset:28672
    s_waitcnt lgkmcnt(7)
    v_mfma_f32_16x16x32_bf16 v[180:183], v[124:127], v[104:107], v[180:183]
    v_mfma_f32_16x16x32_bf16 v[188:191], v[124:127], v[108:111], v[188:191]
    ds_read_b128 v[92:95], v11 offset:30720
    s_waitcnt lgkmcnt(7)
    v_mfma_f32_16x16x32_bf16 v[192:195], v[64:67], v[96:99], v[192:195]
    v_mfma_f32_16x16x32_bf16 v[200:203], v[64:67], v[100:103], v[200:203]
    ds_read_b128 v[112:115], v12 offset:16384
    s_waitcnt lgkmcnt(7)
    v_mfma_f32_16x16x32_bf16 v[196:199], v[68:71], v[96:99], v[196:199]
    v_mfma_f32_16x16x32_bf16 v[204:207], v[68:71], v[100:103], v[204:207]
    ds_read_b128 v[116:119], v12 offset:18432
    s_waitcnt lgkmcnt(7)
    v_mfma_f32_16x16x32_bf16 v[208:211], v[72:75], v[96:99], v[208:211]
    v_mfma_f32_16x16x32_bf16 v[216:219], v[72:75], v[100:103], v[216:219]
    ds_read_b128 v[120:123], v12 offset:20480
    s_waitcnt lgkmcnt(7)
    v_mfma_f32_16x16x32_bf16 v[212:215], v[76:79], v[96:99], v[212:215]
    v_mfma_f32_16x16x32_bf16 v[220:223], v[76:79], v[100:103], v[220:223]
    ds_read_b128 v[124:127], v12 offset:22528
    s_waitcnt lgkmcnt(7)
    v_mfma_f32_16x16x32_bf16 v[224:227], v[80:83], v[96:99], v[224:227]
    buffer_load_dwordx4 v3, s[20:23], s32 offen offset:0 nt lds
    s_add_u32 m0, m0, 1024
    v_mfma_f32_16x16x32_bf16 v[232:235], v[80:83], v[100:103], v[232:235]
    ds_read_b128 v[64:67], v12 offset:24576
    s_waitcnt lgkmcnt(7)
    v_mfma_f32_16x16x32_bf16 v[228:231], v[84:87], v[96:99], v[228:231]
    v_mfma_f32_16x16x32_bf16 v[236:239], v[84:87], v[100:103], v[236:239]
    ds_read_b128 v[68:71], v12 offset:26624
    s_waitcnt lgkmcnt(7)
    v_mfma_f32_16x16x32_bf16 v[240:243], v[88:91], v[96:99], v[240:243]
    v_mfma_f32_16x16x32_bf16 v[248:251], v[88:91], v[100:103], v[248:251]
    ds_read_b128 v[72:75], v12 offset:28672
    s_waitcnt lgkmcnt(7)
    v_mfma_f32_16x16x32_bf16 v[244:247], v[92:95], v[96:99], v[244:247]
    v_mfma_f32_16x16x32_bf16 v[252:255], v[92:95], v[100:103], v[252:255]
    ds_read_b128 v[76:79], v12 offset:30720
    s_waitcnt lgkmcnt(7)
    v_mfma_f32_16x16x32_bf16 v[192:195], v[112:115], v[104:107], v[192:195]
    v_mfma_f32_16x16x32_bf16 v[200:203], v[112:115], v[108:111], v[200:203]
    s_waitcnt lgkmcnt(6)
    v_mfma_f32_16x16x32_bf16 v[196:199], v[116:119], v[104:107], v[196:199]
    v_mfma_f32_16x16x32_bf16 v[204:207], v[116:119], v[108:111], v[204:207]
    s_waitcnt lgkmcnt(5)
    v_mfma_f32_16x16x32_bf16 v[208:211], v[120:123], v[104:107], v[208:211]
    v_mfma_f32_16x16x32_bf16 v[216:219], v[120:123], v[108:111], v[216:219]
    s_waitcnt lgkmcnt(4)
    v_mfma_f32_16x16x32_bf16 v[212:215], v[124:127], v[104:107], v[212:215]
    v_mfma_f32_16x16x32_bf16 v[220:223], v[124:127], v[108:111], v[220:223]
    s_waitcnt lgkmcnt(3)
    v_mfma_f32_16x16x32_bf16 v[224:227], v[64:67], v[104:107], v[224:227]
    v_mfma_f32_16x16x32_bf16 v[232:235], v[64:67], v[108:111], v[232:235]
    s_waitcnt lgkmcnt(2)
    v_mfma_f32_16x16x32_bf16 v[228:231], v[68:71], v[104:107], v[228:231]
    v_mfma_f32_16x16x32_bf16 v[236:239], v[68:71], v[108:111], v[236:239]
    s_waitcnt lgkmcnt(1)
    v_mfma_f32_16x16x32_bf16 v[240:243], v[72:75], v[104:107], v[240:243]
    buffer_load_dwordx4 v4, s[20:23], s32 offen offset:0 nt lds
    v_mfma_f32_16x16x32_bf16 v[248:251], v[72:75], v[108:111], v[248:251]
    s_waitcnt lgkmcnt(0)
    v_mfma_f32_16x16x32_bf16 v[244:247], v[76:79], v[104:107], v[244:247]
    v_mfma_f32_16x16x32_bf16 v[252:255], v[76:79], v[108:111], v[252:255]
    s_add_u32 s28, s42, s35
    s_add_u32 s42, s42, 32768
    s_cmp_eq_u32 s42, 163840
    s_cselect_b32 s42, 0, s42
    v_add_u32 v13, s28, v5
    v_add_u32 v11, s42, v5
    v_add_u32 v14, s28, v6
    v_add_u32 v12, s42, v6
    s_add_u32 s42, s42, 32768
    s_cmp_eq_u32 s42, 163840
    s_cselect_b32 s42, 0, s42
    s_waitcnt vmcnt(4)
    s_barrier
    ds_read_b128 v[96:99], v13 offset:0
    ds_read_b128 v[80:83], v11 offset:0
    ds_read_b128 v[100:103], v13 offset:2048
    ds_read_b128 v[84:87], v11 offset:2048
    ds_read_b128 v[88:91], v11 offset:4096
    ds_read_b128 v[92:95], v11 offset:6144
    ds_read_b128 v[112:115], v11 offset:8192
    ds_read_b128 v[116:119], v11 offset:10240
    ds_read_b128 v[120:123], v11 offset:12288
    ds_read_b128 v[124:127], v11 offset:14336
    ds_read_b128 v[104:107], v14 offset:0
    s_waitcnt lgkmcnt(9)
    v_mfma_f32_16x16x32_bf16 v[128:131], v[80:83], v[96:99], v[128:131]
    s_waitcnt lgkmcnt(8)
    v_mfma_f32_16x16x32_bf16 v[136:139], v[80:83], v[100:103], v[136:139]
    ds_read_b128 v[64:67], v12 offset:0
    ds_read_b128 v[108:111], v14 offset:2048
    s_add_u32 s39, s32, 128
    s_mov_b32 m0, s40
    s_add_u32 s40, s40, 32768
    s_cmp_eq_u32 s40, s41
    s_cselect_b32 s40, s35, s40
    buffer_load_dwordx4 v1, s[20:23], s39 offen offset:0 nt lds
    s_add_u32 m0, m0, 1024
    s_waitcnt lgkmcnt(9)
    v_mfma_f32_16x16x32_bf16 v[132:135], v[84:87], v[96:99], v[132:135]
    v_mfma_f32_16x16x32_bf16 v[140:143], v[84:87], v[100:103], v[140:143]
    ds_read_b128 v[68:71], v12 offset:2048
    s_waitcnt lgkmcnt(9)
    v_mfma_f32_16x16x32_bf16 v[144:147], v[88:91], v[96:99], v[144:147]
    v_mfma_f32_16x16x32_bf16 v[152:155], v[88:91], v[100:103], v[152:155]
    ds_read_b128 v[72:75], v12 offset:4096
    s_waitcnt lgkmcnt(9)
    v_mfma_f32_16x16x32_bf16 v[148:151], v[92:95], v[96:99], v[148:151]
    v_mfma_f32_16x16x32_bf16 v[156:159], v[92:95], v[100:103], v[156:159]
    ds_read_b128 v[76:79], v12 offset:6144
    s_waitcnt lgkmcnt(9)
    v_mfma_f32_16x16x32_bf16 v[160:163], v[112:115], v[96:99], v[160:163]
    v_mfma_f32_16x16x32_bf16 v[168:171], v[112:115], v[100:103], v[168:171]
    ds_read_b128 v[80:83], v12 offset:8192
    s_waitcnt lgkmcnt(9)
    v_mfma_f32_16x16x32_bf16 v[164:167], v[116:119], v[96:99], v[164:167]
    v_mfma_f32_16x16x32_bf16 v[172:175], v[116:119], v[100:103], v[172:175]
    ds_read_b128 v[84:87], v12 offset:10240
    s_waitcnt lgkmcnt(9)
    v_mfma_f32_16x16x32_bf16 v[176:179], v[120:123], v[96:99], v[176:179]
    v_mfma_f32_16x16x32_bf16 v[184:187], v[120:123], v[100:103], v[184:187]
    ds_read_b128 v[88:91], v12 offset:12288
    s_waitcnt lgkmcnt(9)
    v_mfma_f32_16x16x32_bf16 v[180:183], v[124:127], v[96:99], v[180:183]
    v_mfma_f32_16x16x32_bf16 v[188:191], v[124:127], v[100:103], v[188:191]
    ds_read_b128 v[92:95], v12 offset:14336
    s_waitcnt lgkmcnt(8)
    v_mfma_f32_16x16x32_bf16 v[128:131], v[64:67], v[104:107], v[128:131]
    s_waitcnt lgkmcnt(7)
    v_mfma_f32_16x16x32_bf16 v[136:139], v[64:67], v[108:111], v[136:139]
    ds_read_b128 v[112:115], v11 offset:16384
    s_waitcnt lgkmcnt(7)
    v_mfma_f32_16x16x32_bf16 v[132:135], v[68:71], v[104:107], v[132:135]
    v_mfma_f32_16x16x32_bf16 v[140:143], v[68:71], v[108:111], v[140:143]
    ds_read_b128 v[116:119], v12 offset:16384
    s_waitcnt lgkmcnt(7)
    v_mfma_f32_16x16x32_bf16 v[144:147], v[72:75], v[104:107], v[144:147]
    v_max_f32 v17, v128, v129
    buffer_load_dwordx4 v2, s[20:23], s39 offen offset:0 nt lds
    s_add_u32 m0, m0, 1024
    v_mfma_f32_16x16x32_bf16 v[152:155], v[72:75], v[108:111], v[152:155]
    ds_read_b128 v[120:123], v11 offset:18432
    v_max3_f32 v17, v17, v130, v131
    s_waitcnt lgkmcnt(7)
    v_mfma_f32_16x16x32_bf16 v[148:151], v[76:79], v[104:107], v[148:151]
    v_max_f32 v18, v136, v137
    v_mfma_f32_16x16x32_bf16 v[156:159], v[76:79], v[108:111], v[156:159]
    ds_read_b128 v[124:127], v12 offset:18432
    v_max3_f32 v18, v18, v138, v139
    s_waitcnt lgkmcnt(7)
    v_mfma_f32_16x16x32_bf16 v[160:163], v[80:83], v[104:107], v[160:163]
    v_max3_f32 v17, v17, v132, v133
    v_mfma_f32_16x16x32_bf16 v[168:171], v[80:83], v[108:111], v[168:171]
    ds_read_b128 v[64:67], v11 offset:20480
    v_max3_f32 v17, v17, v134, v135
    s_waitcnt lgkmcnt(7)
    v_mfma_f32_16x16x32_bf16 v[164:167], v[84:87], v[104:107], v[164:167]
    v_max3_f32 v18, v18, v140, v141
    v_mfma_f32_16x16x32_bf16 v[172:175], v[84:87], v[108:111], v[172:175]
    ds_read_b128 v[68:71], v12 offset:20480
    v_max3_f32 v18, v18, v142, v143
    s_waitcnt lgkmcnt(7)
    v_mfma_f32_16x16x32_bf16 v[176:179], v[88:91], v[104:107], v[176:179]
    v_max3_f32 v17, v17, v144, v145
    v_mfma_f32_16x16x32_bf16 v[184:187], v[88:91], v[108:111], v[184:187]
    ds_read_b128 v[72:75], v11 offset:22528
    v_max3_f32 v17, v17, v146, v147
    s_waitcnt lgkmcnt(7)
    v_mfma_f32_16x16x32_bf16 v[180:183], v[92:95], v[104:107], v[180:183]
    v_max3_f32 v18, v18, v152, v153
    v_mfma_f32_16x16x32_bf16 v[188:191], v[92:95], v[108:111], v[188:191]
    ds_read_b128 v[76:79], v12 offset:22528
    v_max3_f32 v18, v18, v154, v155
    s_waitcnt lgkmcnt(7)
    v_mfma_f32_16x16x32_bf16 v[192:195], v[112:115], v[96:99], v[192:195]
    v_max3_f32 v17, v17, v148, v149
    v_mfma_f32_16x16x32_bf16 v[200:203], v[112:115], v[100:103], v[200:203]
    ds_read_b128 v[80:83], v11 offset:24576
    v_max3_f32 v17, v17, v150, v151
    s_waitcnt lgkmcnt(7)
    v_mfma_f32_16x16x32_bf16 v[192:195], v[116:119], v[104:107], v[192:195]
    v_max3_f32 v18, v18, v156, v157
    v_mfma_f32_16x16x32_bf16 v[200:203], v[116:119], v[108:111], v[200:203]
    ds_read_b128 v[84:87], v12 offset:24576
    v_max3_f32 v18, v18, v158, v159
    s_waitcnt lgkmcnt(7)
    v_mfma_f32_16x16x32_bf16 v[196:199], v[120:123], v[96:99], v[196:199]
    v_max3_f32 v17, v17, v160, v161
    v_mfma_f32_16x16x32_bf16 v[204:207], v[120:123], v[100:103], v[204:207]
    ds_read_b128 v[88:91], v11 offset:26624
    v_max3_f32 v17, v17, v162, v163
    s_waitcnt lgkmcnt(7)
    v_mfma_f32_16x16x32_bf16 v[196:199], v[124:127], v[104:107], v[196:199]
    v_max3_f32 v18, v18, v168, v169
    v_mfma_f32_16x16x32_bf16 v[204:207], v[124:127], v[108:111], v[204:207]
    ds_read_b128 v[92:95], v12 offset:26624
    v_max3_f32 v18, v18, v170, v171
    v_max3_f32 v17, v17, v164, v165
    s_waitcnt lgkmcnt(7)
    v_mfma_f32_16x16x32_bf16 v[208:211], v[64:67], v[96:99], v[208:211]
    v_max3_f32 v17, v17, v166, v167
    buffer_load_dwordx4 v3, s[20:23], s39 offen offset:0 nt lds
    s_add_u32 m0, m0, 1024
    v_mfma_f32_16x16x32_bf16 v[216:219], v[64:67], v[100:103], v[216:219]
    ds_read_b128 v[112:115], v11 offset:28672
    v_max3_f32 v18, v18, v172, v173
    s_waitcnt lgkmcnt(7)
    v_mfma_f32_16x16x32_bf16 v[208:211], v[68:71], v[104:107], v[208:211]
    v_max3_f32 v18, v18, v174, v175
    v_max3_f32 v17, v17, v176, v177
    v_mfma_f32_16x16x32_bf16 v[216:219], v[68:71], v[108:111], v[216:219]
    ds_read_b128 v[116:119], v12 offset:28672
    v_max3_f32 v17, v17, v178, v179
    v_max3_f32 v18, v18, v184, v185
    s_waitcnt lgkmcnt(7)
    v_mfma_f32_16x16x32_bf16 v[212:215], v[72:75], v[96:99], v[212:215]
    s_waitcnt vmcnt(3)
    s_barrier
    v_max3_f32 v18, v18, v186, v187
    v_mfma_f32_16x16x32_bf16 v[220:223], v[72:75], v[100:103], v[220:223]
    ds_read_b128 v[120:123], v11 offset:30720
    v_max3_f32 v17, v17, v180, v181
    s_waitcnt lgkmcnt(7)
    v_mfma_f32_16x16x32_bf16 v[212:215], v[76:79], v[104:107], v[212:215]
    v_max3_f32 v17, v17, v182, v183
    v_max3_f32 v18, v18, v188, v189
    v_mfma_f32_16x16x32_bf16 v[220:223], v[76:79], v[108:111], v[220:223]
    ds_read_b128 v[124:127], v12 offset:30720
    v_add_u32 v11, s42, v7
    v_add_u32 v12, s42, v8
    v_add_u32 v13, s42, v9
    v_add_u32 v14, s42, v10
    s_add_u32 s42, s42, 32768
    s_cmp_eq_u32 s42, 163840
    s_cselect_b32 s42, 0, s42
    v_max3_f32 v18, v18, v190, v191
    v_max3_f32 v17, v17, v192, v193
    s_waitcnt lgkmcnt(7)
    v_mfma_f32_16x16x32_bf16 v[224:227], v[80:83], v[96:99], v[224:227]
    v_max3_f32 v17, v17, v194, v195
    v_max3_f32 v18, v18, v200, v201
    v_mfma_f32_16x16x32_bf16 v[232:235], v[80:83], v[100:103], v[232:235]
    v_max3_f32 v18, v18, v202, v203
    s_waitcnt lgkmcnt(6)
    v_mfma_f32_16x16x32_bf16 v[224:227], v[84:87], v[104:107], v[224:227]
    v_max3_f32 v17, v17, v196, v197
    v_max3_f32 v17, v17, v198, v199
    v_mfma_f32_16x16x32_bf16 v[232:235], v[84:87], v[108:111], v[232:235]
    v_max3_f32 v18, v18, v204, v205
    v_max3_f32 v18, v18, v206, v207
    s_waitcnt lgkmcnt(5)
    v_mfma_f32_16x16x32_bf16 v[228:231], v[88:91], v[96:99], v[228:231]
    v_max3_f32 v17, v17, v208, v209
    v_mfma_f32_16x16x32_bf16 v[236:239], v[88:91], v[100:103], v[236:239]
    v_max3_f32 v17, v17, v210, v211
    s_waitcnt lgkmcnt(4)
    v_mfma_f32_16x16x32_bf16 v[228:231], v[92:95], v[104:107], v[228:231]
    v_max3_f32 v18, v18, v216, v217
    v_max3_f32 v18, v18, v218, v219
    v_mfma_f32_16x16x32_bf16 v[236:239], v[92:95], v[108:111], v[236:239]
    v_max3_f32 v17, v17, v212, v213
    v_max3_f32 v17, v17, v214, v215
    s_waitcnt lgkmcnt(3)
    v_mfma_f32_16x16x32_bf16 v[240:243], v[112:115], v[96:99], v[240:243]
    v_max3_f32 v18, v18, v220, v221
    v_max3_f32 v18, v18, v222, v223
    v_mfma_f32_16x16x32_bf16 v[248:251], v[112:115], v[100:103], v[248:251]
    v_max3_f32 v17, v17, v224, v225
    s_waitcnt lgkmcnt(2)
    v_mfma_f32_16x16x32_bf16 v[240:243], v[116:119], v[104:107], v[240:243]
    v_max3_f32 v17, v17, v226, v227
    v_max3_f32 v18, v18, v232, v233
    v_mfma_f32_16x16x32_bf16 v[248:251], v[116:119], v[108:111], v[248:251]
    v_max3_f32 v18, v18, v234, v235
    v_max3_f32 v17, v17, v228, v229
    s_waitcnt lgkmcnt(1)
    v_mfma_f32_16x16x32_bf16 v[244:247], v[120:123], v[96:99], v[244:247]
    ds_read_b64_tr_b16 v[96:97], v11 offset:0
    ds_read_b64_tr_b16 v[98:99], v11 offset:2048
    v_max3_f32 v17, v17, v230, v231
    v_max3_f32 v18, v18, v236, v237
    buffer_load_dwordx4 v4, s[20:23], s39 offen offset:0 nt lds
    v_mfma_f32_16x16x32_bf16 v[252:255], v[120:123], v[100:103], v[252:255]
    ds_read_b64_tr_b16 v[100:101], v12 offset:0
    ds_read_b64_tr_b16 v[102:103], v12 offset:2048
    v_max3_f32 v18, v18, v238, v239
    s_waitcnt lgkmcnt(4)
    v_mfma_f32_16x16x32_bf16 v[244:247], v[124:127], v[104:107], v[244:247]
    ds_read_b64_tr_b16 v[104:105], v13 offset:0
    ds_read_b64_tr_b16 v[106:107], v13 offset:2048
    v_max3_f32 v17, v17, v240, v241
    v_max3_f32 v17, v17, v242, v243
    v_mfma_f32_16x16x32_bf16 v[252:255], v[124:127], v[108:111], v[252:255]
    ds_read_b64_tr_b16 v[108:109], v14 offset:0
    ds_read_b64_tr_b16 v[110:111], v14 offset:2048
    ds_read_b64_tr_b16 v[112:113], v11 offset:4096
    ds_read_b64_tr_b16 v[114:115], v11 offset:6144
    ds_read_b64_tr_b16 v[116:117], v12 offset:4096
    ds_read_b64_tr_b16 v[118:119], v12 offset:6144
    v_max3_f32 v18, v18, v248, v249
    v_max3_f32 v18, v18, v250, v251
    v_max3_f32 v17, v17, v244, v245
    v_max3_f32 v17, v17, v246, v247
    v_max3_f32 v18, v18, v252, v253
    v_max3_f32 v18, v18, v254, v255
    v_mov_b32 v25, v17
    s_nop 1
    v_permlane32_swap_b32 v17, v25
    v_max_f32 v17, v17, v25
    v_mov_b32 v25, v17
    s_nop 1
    v_permlane16_swap_b32 v17, v25
    v_max_f32 v17, v17, v25
    v_mul_f32 v17, s37, v17
    v_mov_b32 v25, v18
    s_nop 1
    v_permlane32_swap_b32 v18, v25
    v_max_f32 v18, v18, v25
    v_mov_b32 v25, v18
    s_nop 1
    v_permlane16_swap_b32 v18, v25
    v_max_f32 v18, v18, v25
    v_mul_f32 v18, s37, v18
    v_fma_f32 v128, v128, s37, -v17
    v_fma_f32 v129, v129, s37, -v17
    v_fma_f32 v130, v130, s37, -v17
    v_fma_f32 v131, v131, s37, -v17
    v_fma_f32 v132, v132, s37, -v17
    v_fma_f32 v133, v133, s37, -v17
    v_fma_f32 v134, v134, s37, -v17
    v_fma_f32 v135, v135, s37, -v17
    v_exp_f32 v128, v128
    v_exp_f32 v129, v129
    v_exp_f32 v130, v130
    v_exp_f32 v131, v131
    v_exp_f32 v132, v132
    v_exp_f32 v133, v133
    v_exp_f32 v134, v134
    v_exp_f32 v135, v135
    v_cvt_pk_bf16_f32 v128, v128, v129
    v_cvt_pk_bf16_f32 v129, v130, v131
    v_cvt_pk_bf16_f32 v130, v132, v133
    v_cvt_pk_bf16_f32 v131, v134, v135
    v_fma_f32 v136, v136, s37, -v18
    v_fma_f32 v137, v137, s37, -v18
    v_fma_f32 v138, v138, s37, -v18
    v_fma_f32 v139, v139, s37, -v18
    v_fma_f32 v140, v140, s37, -v18
    v_fma_f32 v141, v141, s37, -v18
    v_fma_f32 v142, v142, s37, -v18
    v_fma_f32 v143, v143, s37, -v18
    v_exp_f32 v136, v136
    v_exp_f32 v137, v137
    v_exp_f32 v138, v138
    v_exp_f32 v139, v139
    v_exp_f32 v140, v140
    v_exp_f32 v141, v141
    v_exp_f32 v142, v142
    v_exp_f32 v143, v143
    v_cvt_pk_bf16_f32 v136, v136, v137
    v_cvt_pk_bf16_f32 v137, v138, v139
    v_cvt_pk_bf16_f32 v138, v140, v141
    v_cvt_pk_bf16_f32 v139, v142, v143
    v_fma_f32 v144, v144, s37, -v17
    v_fma_f32 v145, v145, s37, -v17
    v_fma_f32 v146, v146, s37, -v17
    v_fma_f32 v147, v147, s37, -v17
    v_fma_f32 v148, v148, s37, -v17
    v_fma_f32 v149, v149, s37, -v17
    v_fma_f32 v150, v150, s37, -v17
    v_fma_f32 v151, v151, s37, -v17
    v_exp_f32 v144, v144
    v_exp_f32 v145, v145
    v_exp_f32 v146, v146
    v_exp_f32 v147, v147
    v_exp_f32 v148, v148
    v_exp_f32 v149, v149
    v_exp_f32 v150, v150
    v_exp_f32 v151, v151
    v_cvt_pk_bf16_f32 v144, v144, v145
    v_cvt_pk_bf16_f32 v145, v146, v147
    v_cvt_pk_bf16_f32 v146, v148, v149
    v_cvt_pk_bf16_f32 v147, v150, v151
    v_fma_f32 v152, v152, s37, -v18
    v_fma_f32 v153, v153, s37, -v18
    v_fma_f32 v154, v154, s37, -v18
    v_fma_f32 v155, v155, s37, -v18
    v_fma_f32 v156, v156, s37, -v18
    v_fma_f32 v157, v157, s37, -v18
    v_fma_f32 v158, v158, s37, -v18
    v_fma_f32 v159, v159, s37, -v18
    v_exp_f32 v152, v152
    v_exp_f32 v153, v153
    v_exp_f32 v154, v154
    v_exp_f32 v155, v155
    v_exp_f32 v156, v156
    v_exp_f32 v157, v157
    v_exp_f32 v158, v158
    v_exp_f32 v159, v159
    v_cvt_pk_bf16_f32 v152, v152, v153
    v_cvt_pk_bf16_f32 v153, v154, v155
    v_cvt_pk_bf16_f32 v154, v156, v157
    v_cvt_pk_bf16_f32 v155, v158, v159
    s_waitcnt lgkmcnt(10)
    v_mfma_f32_16x16x32_bf16 v[64:67], v[96:99], v[128:131], 0
    v_fma_f32 v160, v160, s37, -v17
    v_fma_f32 v161, v161, s37, -v17
    v_fma_f32 v162, v162, s37, -v17
    v_fma_f32 v163, v163, s37, -v17
    v_mfma_f32_16x16x32_bf16 v[68:71], v[96:99], v[136:139], 0
    v_mfma_f32_16x16x32_bf16 v[132:135], v[26:29], v[128:131], 0
    ds_read_b64_tr_b16 v[120:121], v13 offset:4096
    ds_read_b64_tr_b16 v[122:123], v13 offset:6144
    s_add_u32 s39, s32, 256
    s_mov_b32 m0, s40
    s_add_u32 s40, s40, 32768
    s_cmp_eq_u32 s40, s41
    s_cselect_b32 s40, s35, s40
    buffer_load_dwordx4 v1, s[20:23], s39 offen offset:0 nt lds
    s_add_u32 m0, m0, 1024
    v_fma_f32 v164, v164, s37, -v17
    v_fma_f32 v165, v165, s37, -v17
    v_fma_f32 v166, v166, s37, -v17
    v_fma_f32 v167, v167, s37, -v17
    s_waitcnt lgkmcnt(10)
    v_mfma_f32_16x16x32_bf16 v[72:75], v[100:103], v[128:131], 0
    v_exp_f32 v160, v160
    v_exp_f32 v161, v161
    v_exp_f32 v162, v162
    v_exp_f32 v163, v163
    v_mfma_f32_16x16x32_bf16 v[76:79], v[100:103], v[136:139], 0
    v_mfma_f32_16x16x32_bf16 v[140:143], v[26:29], v[136:139], 0
    ds_read_b64_tr_b16 v[124:125], v14 offset:4096
    ds_read_b64_tr_b16 v[126:127], v14 offset:6144
    v_exp_f32 v164, v164
    v_exp_f32 v165, v165
    v_exp_f32 v166, v166
    s_waitcnt lgkmcnt(10)
    v_mfma_f32_16x16x32_bf16 v[80:83], v[104:107], v[128:131], 0
    v_mov_b32 v148, v32
    v_mov_b32 v149, v33
    v_exp_f32 v167, v167
    v_cvt_pk_bf16_f32 v160, v160, v161
    v_cvt_pk_bf16_f32 v161, v162, v163
    v_cvt_pk_bf16_f32 v162, v164, v165
    v_mfma_f32_16x16x32_bf16 v[84:87], v[104:107], v[136:139], 0
    ds_read_b64_tr_b16 v[96:97], v11 offset:8192
    ds_read_b64_tr_b16 v[98:99], v11 offset:10240
    v_mov_b32 v150, v34
    v_mov_b32 v151, v35
    v_cvt_pk_bf16_f32 v163, v166, v167
    v_fma_f32 v168, v168, s37, -v18
    v_fma_f32 v169, v169, s37, -v18
    v_fma_f32 v170, v170, s37, -v18
    s_waitcnt lgkmcnt(10)
    v_mfma_f32_16x16x32_bf16 v[88:91], v[108:111], v[128:131], 0
    v_mov_b32 v156, v36
    v_mov_b32 v157, v37
    v_fma_f32 v171, v171, s37, -v18
    v_fma_f32 v172, v172, s37, -v18
    v_fma_f32 v173, v173, s37, -v18
    v_fma_f32 v174, v174, s37, -v18
    v_mfma_f32_16x16x32_bf16 v[92:95], v[108:111], v[136:139], 0
    ds_read_b64_tr_b16 v[100:101], v12 offset:8192
    ds_read_b64_tr_b16 v[102:103], v12 offset:10240
    v_mov_b32 v158, v38
    v_mov_b32 v159, v39
    v_fma_f32 v175, v175, s37, -v18
    v_exp_f32 v168, v168
    v_exp_f32 v169, v169
    s_waitcnt lgkmcnt(10)
    v_mfma_f32_16x16x32_bf16 v[64:67], v[112:115], v[144:147], v[64:67]
    v_exp_f32 v170, v170
    v_exp_f32 v171, v171
    v_exp_f32 v172, v172
    v_exp_f32 v173, v173
    v_mfma_f32_16x16x32_bf16 v[68:71], v[112:115], v[152:155], v[68:71]
    v_mfma_f32_16x16x32_bf16 v[132:135], v[26:29], v[144:147], v[132:135]
    ds_read_b64_tr_b16 v[104:105], v13 offset:8192
    ds_read_b64_tr_b16 v[106:107], v13 offset:10240
    v_exp_f32 v174, v174
    v_exp_f32 v175, v175
    v_cvt_pk_bf16_f32 v168, v168, v169
    v_cvt_pk_bf16_f32 v169, v170, v171
    s_waitcnt lgkmcnt(10)
    v_mfma_f32_16x16x32_bf16 v[72:75], v[116:119], v[144:147], v[72:75]
    v_cvt_pk_bf16_f32 v170, v172, v173
    v_cvt_pk_bf16_f32 v171, v174, v175
    v_fma_f32 v176, v176, s37, -v17
    v_fma_f32 v177, v177, s37, -v17
    v_mfma_f32_16x16x32_bf16 v[76:79], v[116:119], v[152:155], v[76:79]
    v_mfma_f32_16x16x32_bf16 v[140:143], v[26:29], v[152:155], v[140:143]
    ds_read_b64_tr_b16 v[108:109], v14 offset:8192
    ds_read_b64_tr_b16 v[110:111], v14 offset:10240
    v_fma_f32 v178, v178, s37, -v17
    v_fma_f32 v179, v179, s37, -v17
    v_fma_f32 v180, v180, s37, -v17
    s_waitcnt lgkmcnt(10)
    v_mfma_f32_16x16x32_bf16 v[80:83], v[120:123], v[144:147], v[80:83]
    v_fma_f32 v181, v181, s37, -v17
    v_fma_f32 v182, v182, s37, -v17
    v_fma_f32 v183, v183, s37, -v17
    v_exp_f32 v176, v176
    v_mfma_f32_16x16x32_bf16 v[84:87], v[120:123], v[152:155], v[84:87]
    ds_read_b64_tr_b16 v[112:113], v11 offset:12288
    ds_read_b64_tr_b16 v[114:115], v11 offset:14336
    v_exp_f32 v177, v177
    v_exp_f32 v178, v178
    v_exp_f32 v179, v179
    v_exp_f32 v180, v180
    s_waitcnt lgkmcnt(10)
    v_mfma_f32_16x16x32_bf16 v[88:91], v[124:127], v[144:147], v[88:91]
    buffer_load_dwordx4 v2, s[20:23], s39 offen offset:0 nt lds
    s_add_u32 m0, m0, 1024
    v_exp_f32 v181, v181
    v_exp_f32 v182, v182
    v_exp_f32 v183, v183
    v_cvt_pk_bf16_f32 v176, v176, v177
    v_mfma_f32_16x16x32_bf16 v[92:95], v[124:127], v[152:155], v[92:95]
    ds_read_b64_tr_b16 v[116:117], v12 offset:12288
    ds_read_b64_tr_b16 v[118:119], v12 offset:14336
    v_cvt_pk_bf16_f32 v177, v178, v179
    v_cvt_pk_bf16_f32 v178, v180, v181
    v_cvt_pk_bf16_f32 v179, v182, v183
    s_waitcnt lgkmcnt(10)
    v_mfma_f32_16x16x32_bf16 v[64:67], v[96:99], v[160:163], v[64:67]
    v_mov_b32 v164, v40
    v_mov_b32 v165, v41
    v_fma_f32 v184, v184, s37, -v18
    v_fma_f32 v185, v185, s37, -v18
    v_fma_f32 v186, v186, s37, -v18
    v_fma_f32 v187, v187, s37, -v18
    v_mfma_f32_16x16x32_bf16 v[68:71], v[96:99], v[168:171], v[68:71]
    v_mfma_f32_16x16x32_bf16 v[132:135], v[26:29], v[160:163], v[132:135]
    ds_read_b64_tr_b16 v[120:121], v13 offset:12288
    ds_read_b64_tr_b16 v[122:123], v13 offset:14336
    v_mov_b32 v166, v42
    v_mov_b32 v167, v43
    v_fma_f32 v188, v188, s37, -v18
    v_fma_f32 v189, v189, s37, -v18
    v_fma_f32 v190, v190, s37, -v18
    v_fma_f32 v191, v191, s37, -v18
    s_waitcnt lgkmcnt(10)
    v_mfma_f32_16x16x32_bf16 v[72:75], v[100:103], v[160:163], v[72:75]
    v_mov_b32 v172, v44
    v_mov_b32 v173, v45
    v_exp_f32 v184, v184
    v_exp_f32 v185, v185
    v_exp_f32 v186, v186
    v_exp_f32 v187, v187
    v_mfma_f32_16x16x32_bf16 v[76:79], v[100:103], v[168:171], v[76:79]
    v_mfma_f32_16x16x32_bf16 v[140:143], v[26:29], v[168:171], v[140:143]
    ds_read_b64_tr_b16 v[124:125], v14 offset:12288
    ds_read_b64_tr_b16 v[126:127], v14 offset:14336
    v_mov_b32 v174, v46
    v_mov_b32 v175, v47
    v_exp_f32 v188, v188
    v_exp_f32 v189, v189
    v_exp_f32 v190, v190
    s_waitcnt lgkmcnt(10)
    v_mfma_f32_16x16x32_bf16 v[80:83], v[104:107], v[160:163], v[80:83]
    v_exp_f32 v191, v191
    v_cvt_pk_bf16_f32 v184, v184, v185
    v_cvt_pk_bf16_f32 v185, v186, v187
    v_cvt_pk_bf16_f32 v186, v188, v189
    v_mfma_f32_16x16x32_bf16 v[84:87], v[104:107], v[168:171], v[84:87]
    ds_read_b64_tr_b16 v[96:97], v11 offset:16384
    ds_read_b64_tr_b16 v[98:99], v11 offset:18432
    v_cvt_pk_bf16_f32 v187, v190, v191
    v_fma_f32 v192, v192, s37, -v17
    v_fma_f32 v193, v193, s37, -v17
    v_fma_f32 v194, v194, s37, -v17
    s_waitcnt lgkmcnt(10)
    v_mfma_f32_16x16x32_bf16 v[88:91], v[108:111], v[160:163], v[88:91]
    v_fma_f32 v195, v195, s37, -v17
    v_fma_f32 v196, v196, s37, -v17
    v_fma_f32 v197, v197, s37, -v17
    v_fma_f32 v198, v198, s37, -v17
    v_mfma_f32_16x16x32_bf16 v[92:95], v[108:111], v[168:171], v[92:95]
    ds_read_b64_tr_b16 v[100:101], v12 offset:16384
    ds_read_b64_tr_b16 v[102:103], v12 offset:18432
    v_fma_f32 v199, v199, s37, -v17
    v_exp_f32 v192, v192
    v_exp_f32 v193, v193
    s_waitcnt lgkmcnt(10)
    v_mfma_f32_16x16x32_bf16 v[64:67], v[112:115], v[176:179], v[64:67]
    v_mov_b32 v180, v48
    v_mov_b32 v181, v49
    v_exp_f32 v194, v194
    v_exp_f32 v195, v195
    v_exp_f32 v196, v196
    v_exp_f32 v197, v197
    v_mfma_f32_16x16x32_bf16 v[68:71], v[112:115], v[184:187], v[68:71]
    v_mfma_f32_16x16x32_bf16 v[132:135], v[26:29], v[176:179], v[132:135]
    ds_read_b64_tr_b16 v[104:105], v13 offset:16384
    ds_read_b64_tr_b16 v[106:107], v13 offset:18432
    v_mov_b32 v182, v50
    v_mov_b32 v183, v51
    v_exp_f32 v198, v198
    v_exp_f32 v199, v199
    v_cvt_pk_bf16_f32 v192, v192, v193
    v_cvt_pk_bf16_f32 v193, v194, v195
    s_waitcnt lgkmcnt(10)
    v_mfma_f32_16x16x32_bf16 v[72:75], v[116:119], v[176:179], v[72:75]
    s_waitcnt vmcnt(2)
    s_barrier
    v_mov_b32 v188, v52
    v_mov_b32 v189, v53
    v_cvt_pk_bf16_f32 v194, v196, v197
    v_cvt_pk_bf16_f32 v195, v198, v199
    v_fma_f32 v200, v200, s37, -v18
    v_fma_f32 v201, v201, s37, -v18
    v_mfma_f32_16x16x32_bf16 v[76:79], v[116:119], v[184:187], v[76:79]
    v_mfma_f32_16x16x32_bf16 v[140:143], v[26:29], v[184:187], v[140:143]
    ds_read_b64_tr_b16 v[108:109], v14 offset:16384
    ds_read_b64_tr_b16 v[110:111], v14 offset:18432
    v_mov_b32 v190, v54
    v_mov_b32 v191, v55
    buffer_load_dwordx4 v3, s[20:23], s39 offen offset:0 nt lds
    s_add_u32 m0, m0, 1024
    v_fma_f32 v202, v202, s37, -v18
    v_fma_f32 v203, v203, s37, -v18
    v_fma_f32 v204, v204, s37, -v18
    s_waitcnt lgkmcnt(10)
    v_mfma_f32_16x16x32_bf16 v[80:83], v[120:123], v[176:179], v[80:83]
    v_fma_f32 v205, v205, s37, -v18
    v_fma_f32 v206, v206, s37, -v18
    v_fma_f32 v207, v207, s37, -v18
    v_exp_f32 v200, v200
    v_mfma_f32_16x16x32_bf16 v[84:87], v[120:123], v[184:187], v[84:87]
    ds_read_b64_tr_b16 v[112:113], v11 offset:32768
    ds_read_b64_tr_b16 v[114:115], v11 offset:34816
    v_exp_f32 v201, v201
    v_exp_f32 v202, v202
    v_exp_f32 v203, v203
    v_exp_f32 v204, v204
    s_waitcnt lgkmcnt(10)
    v_mfma_f32_16x16x32_bf16 v[88:91], v[124:127], v[176:179], v[88:91]
    v_exp_f32 v205, v205
    v_exp_f32 v206, v206
    v_exp_f32 v207, v207
    v_cvt_pk_bf16_f32 v200, v200, v201
    v_mfma_f32_16x16x32_bf16 v[92:95], v[124:127], v[184:187], v[92:95]
    ds_read_b64_tr_b16 v[116:117], v12 offset:32768
    ds_read_b64_tr_b16 v[118:119], v12 offset:34816
    v_cvt_pk_bf16_f32 v201, v202, v203
    v_cvt_pk_bf16_f32 v202, v204, v205
    v_cvt_pk_bf16_f32 v203, v206, v207
    s_waitcnt lgkmcnt(10)
    v_mfma_f32_16x16x32_bf16 v[64:67], v[96:99], v[192:195], v[64:67]
    v_mov_b32 v196, v56
    v_mov_b32 v197, v57
    v_fma_f32 v208, v208, s37, -v17
    v_fma_f32 v209, v209, s37, -v17
    v_fma_f32 v210, v210, s37, -v17
    v_mfma_f32_16x16x32_bf16 v[68:71], v[96:99], v[200:203], v[68:71]
    v_mfma_f32_16x16x32_bf16 v[132:135], v[26:29], v[192:195], v[132:135]
    ds_read_b64_tr_b16 v[120:121], v13 offset:32768
    ds_read_b64_tr_b16 v[122:123], v13 offset:34816
    v_mov_b32 v198, v58
    v_mov_b32 v199, v59
    v_fma_f32 v211, v211, s37, -v17
    v_fma_f32 v212, v212, s37, -v17
    s_waitcnt lgkmcnt(10)
    v_mfma_f32_16x16x32_bf16 v[72:75], v[100:103], v[192:195], v[72:75]
    v_mov_b32 v204, v60
    v_mov_b32 v205, v61
    v_fma_f32 v213, v213, s37, -v17
    v_fma_f32 v214, v214, s37, -v17
    v_fma_f32 v215, v215, s37, -v17
    v_mfma_f32_16x16x32_bf16 v[76:79], v[100:103], v[200:203], v[76:79]
    v_mfma_f32_16x16x32_bf16 v[140:143], v[26:29], v[200:203], v[140:143]
    ds_read_b64_tr_b16 v[124:125], v14 offset:32768
    ds_read_b64_tr_b16 v[126:127], v14 offset:34816
    v_mov_b32 v206, v62
    v_mov_b32 v207, v63
    v_exp_f32 v208, v208
    v_exp_f32 v209, v209
    s_waitcnt lgkmcnt(10)
    v_mfma_f32_16x16x32_bf16 v[80:83], v[104:107], v[192:195], v[80:83]
    v_exp_f32 v210, v210
    v_exp_f32 v211, v211
    v_exp_f32 v212, v212
    v_mfma_f32_16x16x32_bf16 v[84:87], v[104:107], v[200:203], v[84:87]
    ds_read_b64_tr_b16 v[96:97], v11 offset:36864
    ds_read_b64_tr_b16 v[98:99], v11 offset:38912
    v_exp_f32 v213, v213
    v_exp_f32 v214, v214
    s_waitcnt lgkmcnt(10)
    v_mfma_f32_16x16x32_bf16 v[88:91], v[108:111], v[192:195], v[88:91]
    v_exp_f32 v215, v215
    v_cvt_pk_bf16_f32 v208, v208, v209
    v_cvt_pk_bf16_f32 v209, v210, v211
    v_mfma_f32_16x16x32_bf16 v[92:95], v[108:111], v[200:203], v[92:95]
    ds_read_b64_tr_b16 v[100:101], v12 offset:36864
    ds_read_b64_tr_b16 v[102:103], v12 offset:38912
    v_cvt_pk_bf16_f32 v210, v212, v213
    v_cvt_pk_bf16_f32 v211, v214, v215
    s_waitcnt lgkmcnt(10)
    v_mfma_f32_16x16x32_bf16 v[32:35], v[112:115], v[128:131], 0
    buffer_load_dwordx4 v4, s[20:23], s39 offen offset:0 nt lds
    v_fma_f32 v216, v216, s37, -v18
    v_fma_f32 v217, v217, s37, -v18
    v_fma_f32 v218, v218, s37, -v18
    v_mfma_f32_16x16x32_bf16 v[36:39], v[112:115], v[136:139], 0
    ds_read_b64_tr_b16 v[104:105], v13 offset:36864
    ds_read_b64_tr_b16 v[106:107], v13 offset:38912
    v_fma_f32 v219, v219, s37, -v18
    v_fma_f32 v220, v220, s37, -v18
    s_waitcnt lgkmcnt(10)
    v_mfma_f32_16x16x32_bf16 v[40:43], v[116:119], v[128:131], 0
    v_fma_f32 v221, v221, s37, -v18
    v_fma_f32 v222, v222, s37, -v18
    v_fma_f32 v223, v223, s37, -v18
    v_mfma_f32_16x16x32_bf16 v[44:47], v[116:119], v[136:139], 0
    ds_read_b64_tr_b16 v[108:109], v14 offset:36864
    ds_read_b64_tr_b16 v[110:111], v14 offset:38912
    v_exp_f32 v216, v216
    v_exp_f32 v217, v217
    s_waitcnt lgkmcnt(10)
    v_mfma_f32_16x16x32_bf16 v[48:51], v[120:123], v[128:131], 0
    v_exp_f32 v218, v218
    v_exp_f32 v219, v219
    v_exp_f32 v220, v220
    v_mfma_f32_16x16x32_bf16 v[52:55], v[120:123], v[136:139], 0
    ds_read_b64_tr_b16 v[112:113], v11 offset:40960
    ds_read_b64_tr_b16 v[114:115], v11 offset:43008
    v_exp_f32 v221, v221
    v_exp_f32 v222, v222
    s_waitcnt lgkmcnt(10)
    v_mfma_f32_16x16x32_bf16 v[56:59], v[124:127], v[128:131], 0
    v_exp_f32 v223, v223
    v_cvt_pk_bf16_f32 v216, v216, v217
    v_cvt_pk_bf16_f32 v217, v218, v219
    v_mfma_f32_16x16x32_bf16 v[60:63], v[124:127], v[136:139], 0
    ds_read_b64_tr_b16 v[116:117], v12 offset:40960
    ds_read_b64_tr_b16 v[118:119], v12 offset:43008
    v_cvt_pk_bf16_f32 v218, v220, v221
    v_cvt_pk_bf16_f32 v219, v222, v223
    s_waitcnt lgkmcnt(10)
    v_mfma_f32_16x16x32_bf16 v[32:35], v[96:99], v[144:147], v[32:35]
    v_fma_f32 v224, v224, s37, -v17
    v_fma_f32 v225, v225, s37, -v17
    v_fma_f32 v226, v226, s37, -v17
    v_mfma_f32_16x16x32_bf16 v[36:39], v[96:99], v[152:155], v[36:39]
    ds_read_b64_tr_b16 v[120:121], v13 offset:40960
    ds_read_b64_tr_b16 v[122:123], v13 offset:43008
    v_fma_f32 v227, v227, s37, -v17
    v_fma_f32 v228, v228, s37, -v17
    s_waitcnt lgkmcnt(10)
    v_mfma_f32_16x16x32_bf16 v[40:43], v[100:103], v[144:147], v[40:43]
    v_fma_f32 v229, v229, s37, -v17
    v_fma_f32 v230, v230, s37, -v17
    v_fma_f32 v231, v231, s37, -v17
    v_mfma_f32_16x16x32_bf16 v[44:47], v[100:103], v[152:155], v[44:47]
    ds_read_b64_tr_b16 v[124:125], v14 offset:40960
    ds_read_b64_tr_b16 v[126:127], v14 offset:43008
    s_add_u32 s42, s42, 32768
    s_cmp_eq_u32 s42, 163840
    s_cselect_b32 s42, 0, s42
    v_exp_f32 v224, v224
    v_exp_f32 v225, v225
    s_waitcnt lgkmcnt(10)
    v_mfma_f32_16x16x32_bf16 v[48:51], v[104:107], v[144:147], v[48:51]
    v_exp_f32 v226, v226
    v_exp_f32 v227, v227
    v_exp_f32 v228, v228
    v_mfma_f32_16x16x32_bf16 v[52:55], v[104:107], v[152:155], v[52:55]
    ds_read_b64_tr_b16 v[96:97], v11 offset:20480
    ds_read_b64_tr_b16 v[98:99], v11 offset:22528
    v_exp_f32 v229, v229
    v_exp_f32 v230, v230
    s_waitcnt lgkmcnt(10)
    v_mfma_f32_16x16x32_bf16 v[56:59], v[108:111], v[144:147], v[56:59]
    v_exp_f32 v231, v231
    v_cvt_pk_bf16_f32 v224, v224, v225
    v_cvt_pk_bf16_f32 v225, v226, v227
    v_mfma_f32_16x16x32_bf16 v[60:63], v[108:111], v[152:155], v[60:63]
    ds_read_b64_tr_b16 v[100:101], v12 offset:20480
    ds_read_b64_tr_b16 v[102:103], v12 offset:22528
    v_cvt_pk_bf16_f32 v226, v228, v229
    v_cvt_pk_bf16_f32 v227, v230, v231
    s_waitcnt lgkmcnt(10)
    v_mfma_f32_16x16x32_bf16 v[32:35], v[112:115], v[160:163], v[32:35]
    v_fma_f32 v232, v232, s37, -v18
    v_fma_f32 v233, v233, s37, -v18
    v_fma_f32 v234, v234, s37, -v18
    v_mfma_f32_16x16x32_bf16 v[36:39], v[112:115], v[168:171], v[36:39]
    ds_read_b64_tr_b16 v[104:105], v13 offset:20480
    ds_read_b64_tr_b16 v[106:107], v13 offset:22528
    v_fma_f32 v235, v235, s37, -v18
    v_fma_f32 v236, v236, s37, -v18
    s_waitcnt lgkmcnt(10)
    v_mfma_f32_16x16x32_bf16 v[40:43], v[116:119], v[160:163], v[40:43]
    v_fma_f32 v237, v237, s37, -v18
    v_fma_f32 v238, v238, s37, -v18
    v_fma_f32 v239, v239, s37, -v18
    v_mfma_f32_16x16x32_bf16 v[44:47], v[116:119], v[168:171], v[44:47]
    ds_read_b64_tr_b16 v[108:109], v14 offset:20480
    ds_read_b64_tr_b16 v[110:111], v14 offset:22528
    v_exp_f32 v232, v232
    v_exp_f32 v233, v233
    s_waitcnt lgkmcnt(10)
    v_mfma_f32_16x16x32_bf16 v[48:51], v[120:123], v[160:163], v[48:51]
    v_exp_f32 v234, v234
    v_exp_f32 v235, v235
    v_exp_f32 v236, v236
    v_mfma_f32_16x16x32_bf16 v[52:55], v[120:123], v[168:171], v[52:55]
    ds_read_b64_tr_b16 v[112:113], v11 offset:24576
    ds_read_b64_tr_b16 v[114:115], v11 offset:26624
    v_exp_f32 v237, v237
    v_exp_f32 v238, v238
    s_waitcnt lgkmcnt(10)
    v_mfma_f32_16x16x32_bf16 v[56:59], v[124:127], v[160:163], v[56:59]
    v_exp_f32 v239, v239
    v_cvt_pk_bf16_f32 v232, v232, v233
    v_cvt_pk_bf16_f32 v233, v234, v235
    v_mfma_f32_16x16x32_bf16 v[60:63], v[124:127], v[168:171], v[60:63]
    ds_read_b64_tr_b16 v[116:117], v12 offset:24576
    ds_read_b64_tr_b16 v[118:119], v12 offset:26624
    v_cvt_pk_bf16_f32 v234, v236, v237
    v_cvt_pk_bf16_f32 v235, v238, v239
    s_waitcnt lgkmcnt(10)
    v_mfma_f32_16x16x32_bf16 v[64:67], v[96:99], v[208:211], v[64:67]
    v_fma_f32 v240, v240, s37, -v17
    v_fma_f32 v241, v241, s37, -v17
    v_fma_f32 v242, v242, s37, -v17
    v_mfma_f32_16x16x32_bf16 v[68:71], v[96:99], v[216:219], v[68:71]
    v_mfma_f32_16x16x32_bf16 v[132:135], v[26:29], v[208:211], v[132:135]
    ds_read_b64_tr_b16 v[120:121], v13 offset:24576
    ds_read_b64_tr_b16 v[122:123], v13 offset:26624
    v_fma_f32 v243, v243, s37, -v17
    v_fma_f32 v244, v244, s37, -v17
    s_waitcnt lgkmcnt(10)
    v_mfma_f32_16x16x32_bf16 v[72:75], v[100:103], v[208:211], v[72:75]
    v_fma_f32 v245, v245, s37, -v17
    v_fma_f32 v246, v246, s37, -v17
    v_fma_f32 v247, v247, s37, -v17
    v_mfma_f32_16x16x32_bf16 v[76:79], v[100:103], v[216:219], v[76:79]
    v_mfma_f32_16x16x32_bf16 v[140:143], v[26:29], v[216:219], v[140:143]
    ds_read_b64_tr_b16 v[124:125], v14 offset:24576
    ds_read_b64_tr_b16 v[126:127], v14 offset:26624
    v_exp_f32 v240, v240
    v_exp_f32 v241, v241
    s_waitcnt lgkmcnt(10)
    v_mfma_f32_16x16x32_bf16 v[80:83], v[104:107], v[208:211], v[80:83]
    v_exp_f32 v242, v242
    v_exp_f32 v243, v243
    v_exp_f32 v244, v244
    v_mfma_f32_16x16x32_bf16 v[84:87], v[104:107], v[216:219], v[84:87]
    ds_read_b64_tr_b16 v[96:97], v11 offset:28672
    ds_read_b64_tr_b16 v[98:99], v11 offset:30720
    v_exp_f32 v245, v245
    v_exp_f32 v246, v246
    s_waitcnt lgkmcnt(10)
    v_mfma_f32_16x16x32_bf16 v[88:91], v[108:111], v[208:211], v[88:91]
    v_exp_f32 v247, v247
    v_cvt_pk_bf16_f32 v240, v240, v241
    v_cvt_pk_bf16_f32 v241, v242, v243
    v_mfma_f32_16x16x32_bf16 v[92:95], v[108:111], v[216:219], v[92:95]
    ds_read_b64_tr_b16 v[100:101], v12 offset:28672
    ds_read_b64_tr_b16 v[102:103], v12 offset:30720
    v_cvt_pk_bf16_f32 v242, v244, v245
    v_cvt_pk_bf16_f32 v243, v246, v247
    s_waitcnt lgkmcnt(10)
    v_mfma_f32_16x16x32_bf16 v[64:67], v[112:115], v[224:227], v[64:67]
    v_fma_f32 v248, v248, s37, -v18
    v_fma_f32 v249, v249, s37, -v18
    v_fma_f32 v250, v250, s37, -v18
    v_mfma_f32_16x16x32_bf16 v[68:71], v[112:115], v[232:235], v[68:71]
    v_mfma_f32_16x16x32_bf16 v[132:135], v[26:29], v[224:227], v[132:135]
    ds_read_b64_tr_b16 v[104:105], v13 offset:28672
    ds_read_b64_tr_b16 v[106:107], v13 offset:30720
    v_fma_f32 v251, v251, s37, -v18
    v_fma_f32 v252, v252, s37, -v18
    s_waitcnt lgkmcnt(10)
    v_mfma_f32_16x16x32_bf16 v[72:75], v[116:119], v[224:227], v[72:75]
    v_fma_f32 v253, v253, s37, -v18
    v_fma_f32 v254, v254, s37, -v18
    v_fma_f32 v255, v255, s37, -v18
    v_mfma_f32_16x16x32_bf16 v[76:79], v[116:119], v[232:235], v[76:79]
    v_mfma_f32_16x16x32_bf16 v[140:143], v[26:29], v[232:235], v[140:143]
    ds_read_b64_tr_b16 v[108:109], v14 offset:28672
    ds_read_b64_tr_b16 v[110:111], v14 offset:30720
    v_exp_f32 v248, v248
    v_exp_f32 v249, v249
    s_waitcnt lgkmcnt(10)
    v_mfma_f32_16x16x32_bf16 v[80:83], v[120:123], v[224:227], v[80:83]
    v_exp_f32 v250, v250
    v_exp_f32 v251, v251
    v_exp_f32 v252, v252
    v_mfma_f32_16x16x32_bf16 v[84:87], v[120:123], v[232:235], v[84:87]
    ds_read_b64_tr_b16 v[112:113], v11 offset:45056
    ds_read_b64_tr_b16 v[114:115], v11 offset:47104
    v_exp_f32 v253, v253
    v_exp_f32 v254, v254
    s_waitcnt lgkmcnt(10)
    v_mfma_f32_16x16x32_bf16 v[88:91], v[124:127], v[224:227], v[88:91]
    v_exp_f32 v255, v255
    v_cvt_pk_bf16_f32 v248, v248, v249
    v_cvt_pk_bf16_f32 v249, v250, v251
    v_mfma_f32_16x16x32_bf16 v[92:95], v[124:127], v[232:235], v[92:95]
    ds_read_b64_tr_b16 v[116:117], v12 offset:45056
    ds_read_b64_tr_b16 v[118:119], v12 offset:47104
    v_cvt_pk_bf16_f32 v250, v252, v253
    v_cvt_pk_bf16_f32 v251, v254, v255
    s_waitcnt lgkmcnt(10)
    v_mfma_f32_16x16x32_bf16 v[64:67], v[96:99], v[240:243], v[64:67]
    v_mfma_f32_16x16x32_bf16 v[68:71], v[96:99], v[248:251], v[68:71]
    v_mfma_f32_16x16x32_bf16 v[132:135], v[26:29], v[240:243], v[132:135]
    ds_read_b64_tr_b16 v[120:121], v13 offset:45056
    ds_read_b64_tr_b16 v[122:123], v13 offset:47104
    s_waitcnt lgkmcnt(10)
    v_mfma_f32_16x16x32_bf16 v[72:75], v[100:103], v[240:243], v[72:75]
    v_mfma_f32_16x16x32_bf16 v[76:79], v[100:103], v[248:251], v[76:79]
    v_mfma_f32_16x16x32_bf16 v[140:143], v[26:29], v[248:251], v[140:143]
    ds_read_b64_tr_b16 v[124:125], v14 offset:45056
    ds_read_b64_tr_b16 v[126:127], v14 offset:47104
    s_waitcnt lgkmcnt(10)
    v_mfma_f32_16x16x32_bf16 v[80:83], v[104:107], v[240:243], v[80:83]
    v_mfma_f32_16x16x32_bf16 v[84:87], v[104:107], v[248:251], v[84:87]
    ds_read_b64_tr_b16 v[96:97], v11 offset:49152
    ds_read_b64_tr_b16 v[98:99], v11 offset:51200
    s_waitcnt lgkmcnt(10)
    v_mfma_f32_16x16x32_bf16 v[88:91], v[108:111], v[240:243], v[88:91]
    v_mfma_f32_16x16x32_bf16 v[92:95], v[108:111], v[248:251], v[92:95]
    ds_read_b64_tr_b16 v[100:101], v12 offset:49152
    ds_read_b64_tr_b16 v[102:103], v12 offset:51200
    v_rcp_f32 v19, v132
    v_rcp_f32 v20, v140
    v_add_u32 v21, s40, v15
    v_add_u32 v25, s40, v16
    v_xor_b32 v22, 32, v21
    s_waitcnt lgkmcnt(10)
    v_mfma_f32_16x16x32_bf16 v[32:35], v[112:115], v[176:179], v[32:35]
    v_xor_b32 v23, 64, v21
    v_xor_b32 v24, 96, v21
    v_mul_f32 v64, v64, v19
    v_mul_f32 v65, v65, v19
    v_mul_f32 v66, v66, v19
    v_mfma_f32_16x16x32_bf16 v[36:39], v[112:115], v[184:187], v[36:39]
    ds_read_b64_tr_b16 v[104:105], v13 offset:49152
    ds_read_b64_tr_b16 v[106:107], v13 offset:51200
    v_mul_f32 v67, v67, v19
    v_cvt_pk_bf16_f32 v64, v64, v65
    v_cvt_pk_bf16_f32 v65, v66, v67
    ds_write_b64 v21, v[64:65] offset:0
    v_mul_f32 v68, v68, v20
    s_waitcnt lgkmcnt(11)
    v_mfma_f32_16x16x32_bf16 v[40:43], v[116:119], v[176:179], v[40:43]
    v_mul_f32 v69, v69, v20
    v_mul_f32 v70, v70, v20
    v_mul_f32 v71, v71, v20
    v_cvt_pk_bf16_f32 v68, v68, v69
    v_cvt_pk_bf16_f32 v69, v70, v71
    v_mfma_f32_16x16x32_bf16 v[44:47], v[116:119], v[184:187], v[44:47]
    ds_read_b64_tr_b16 v[108:109], v14 offset:49152
    ds_read_b64_tr_b16 v[110:111], v14 offset:51200
    ds_write_b64 v21, v[68:69] offset:2048
    v_mul_f32 v72, v72, v19
    v_mul_f32 v73, v73, v19
    v_mul_f32 v74, v74, v19
    v_mul_f32 v75, v75, v19
    s_waitcnt lgkmcnt(12)
    v_mfma_f32_16x16x32_bf16 v[48:51], v[120:123], v[176:179], v[48:51]
    v_cvt_pk_bf16_f32 v72, v72, v73
    v_cvt_pk_bf16_f32 v73, v74, v75
    ds_write_b64 v22, v[72:73] offset:0
    v_mul_f32 v76, v76, v20
    v_mul_f32 v77, v77, v20
    v_mfma_f32_16x16x32_bf16 v[52:55], v[120:123], v[184:187], v[52:55]
    ds_read_b64_tr_b16 v[112:113], v11 offset:53248
    ds_read_b64_tr_b16 v[114:115], v11 offset:55296
    v_mul_f32 v78, v78, v20
    v_mul_f32 v79, v79, v20
    v_cvt_pk_bf16_f32 v76, v76, v77
    v_cvt_pk_bf16_f32 v77, v78, v79
    s_waitcnt lgkmcnt(14)
    ds_write_b64 v22, v[76:77] offset:2048
    s_waitcnt lgkmcnt(14)
    v_mfma_f32_16x16x32_bf16 v[56:59], v[124:127], v[176:179], v[56:59]
    v_mul_f32 v80, v80, v19
    v_mul_f32 v81, v81, v19
    v_mul_f32 v82, v82, v19
    v_mul_f32 v83, v83, v19
    v_cvt_pk_bf16_f32 v80, v80, v81
    v_mfma_f32_16x16x32_bf16 v[60:63], v[124:127], v[184:187], v[60:63]
    ds_read_b64_tr_b16 v[116:117], v12 offset:53248
    s_waitcnt lgkmcnt(14)
    ds_read_b64_tr_b16 v[118:119], v12 offset:55296
    v_cvt_pk_bf16_f32 v81, v82, v83
    s_waitcnt lgkmcnt(14)
    ds_write_b64 v23, v[80:81] offset:0
    v_mul_f32 v84, v84, v20
    v_mul_f32 v85, v85, v20
    v_mul_f32 v86, v86, v20
    v_mfma_f32_16x16x32_bf16 v[32:35], v[96:99], v[192:195], v[32:35]
    v_mul_f32 v87, v87, v20
    v_cvt_pk_bf16_f32 v84, v84, v85
    v_cvt_pk_bf16_f32 v85, v86, v87
    s_waitcnt lgkmcnt(14)
    ds_write_b64 v23, v[84:85] offset:2048
    v_mul_f32 v88, v88, v19
    v_mfma_f32_16x16x32_bf16 v[36:39], v[96:99], v[200:203], v[36:39]
    s_waitcnt lgkmcnt(14)
    ds_read_b64_tr_b16 v[120:121], v13 offset:53248
    s_waitcnt lgkmcnt(14)
    ds_read_b64_tr_b16 v[122:123], v13 offset:55296
    v_mul_f32 v89, v89, v19
    v_mul_f32 v90, v90, v19
    v_mul_f32 v91, v91, v19
    v_cvt_pk_bf16_f32 v88, v88, v89
    v_cvt_pk_bf16_f32 v89, v90, v91
    v_mfma_f32_16x16x32_bf16 v[40:43], v[100:103], v[192:195], v[40:43]
    s_waitcnt lgkmcnt(14)
    ds_write_b64 v24, v[88:89] offset:0
    v_mul_f32 v92, v92, v20
    v_mul_f32 v93, v93, v20
    v_mul_f32 v94, v94, v20
    v_mul_f32 v95, v95, v20
    v_mfma_f32_16x16x32_bf16 v[44:47], v[100:103], v[200:203], v[44:47]
    s_waitcnt lgkmcnt(14)
    ds_read_b64_tr_b16 v[124:125], v14 offset:53248
    s_waitcnt lgkmcnt(14)
    ds_read_b64_tr_b16 v[126:127], v14 offset:55296
    v_cvt_pk_bf16_f32 v92, v92, v93
    v_cvt_pk_bf16_f32 v93, v94, v95
    s_waitcnt lgkmcnt(14)
    ds_write_b64 v24, v[92:93] offset:2048
    v_mfma_f32_16x16x32_bf16 v[48:51], v[104:107], v[192:195], v[48:51]
    s_waitcnt lgkmcnt(14)
    ds_read_b128 v[80:83], v25 offset:0
    s_waitcnt lgkmcnt(14)
    ds_read_b128 v[84:87], v25 offset:1024
    s_waitcnt lgkmcnt(14)
    ds_read_b128 v[88:91], v25 offset:2048
    s_waitcnt lgkmcnt(14)
    ds_read_b128 v[92:95], v25 offset:3072
    v_mfma_f32_16x16x32_bf16 v[52:55], v[104:107], v[200:203], v[52:55]
    s_waitcnt lgkmcnt(14)
    ds_read_b64_tr_b16 v[96:97], v11 offset:57344
    s_waitcnt lgkmcnt(14)
    ds_read_b64_tr_b16 v[98:99], v11 offset:59392
    v_mfma_f32_16x16x32_bf16 v[56:59], v[108:111], v[192:195], v[56:59]
    v_mfma_f32_16x16x32_bf16 v[60:63], v[108:111], v[200:203], v[60:63]
    s_waitcnt lgkmcnt(14)
    ds_read_b64_tr_b16 v[100:101], v12 offset:57344
    s_waitcnt lgkmcnt(14)
    ds_read_b64_tr_b16 v[102:103], v12 offset:59392
    s_waitcnt lgkmcnt(7)
    buffer_store_dwordx4 v[80:83], v1, s[24:27], s32 offen offset:0 sc1
    v_mfma_f32_16x16x32_bf16 v[32:35], v[112:115], v[208:211], v[32:35]
    v_mfma_f32_16x16x32_bf16 v[36:39], v[112:115], v[216:219], v[36:39]
    ds_read_b64_tr_b16 v[104:105], v13 offset:57344
    ds_read_b64_tr_b16 v[106:107], v13 offset:59392
    v_mfma_f32_16x16x32_bf16 v[40:43], v[116:119], v[208:211], v[40:43]
    v_mfma_f32_16x16x32_bf16 v[44:47], v[116:119], v[216:219], v[44:47]
    ds_read_b64_tr_b16 v[108:109], v14 offset:57344
    ds_read_b64_tr_b16 v[110:111], v14 offset:59392
    v_mfma_f32_16x16x32_bf16 v[48:51], v[120:123], v[208:211], v[48:51]
    v_mfma_f32_16x16x32_bf16 v[52:55], v[120:123], v[216:219], v[52:55]
    ds_read_b64_tr_b16 v[112:113], v11 offset:61440
    ds_read_b64_tr_b16 v[114:115], v11 offset:63488
    v_mfma_f32_16x16x32_bf16 v[56:59], v[124:127], v[208:211], v[56:59]
    s_waitcnt lgkmcnt(12)
    buffer_store_dwordx4 v[84:87], v2, s[24:27], s32 offen offset:0 sc1
    v_mfma_f32_16x16x32_bf16 v[60:63], v[124:127], v[216:219], v[60:63]
    ds_read_b64_tr_b16 v[116:117], v12 offset:61440
    ds_read_b64_tr_b16 v[118:119], v12 offset:63488
    s_waitcnt lgkmcnt(10)
    v_mfma_f32_16x16x32_bf16 v[32:35], v[96:99], v[224:227], v[32:35]
    v_mfma_f32_16x16x32_bf16 v[36:39], v[96:99], v[232:235], v[36:39]
    ds_read_b64_tr_b16 v[120:121], v13 offset:61440
    ds_read_b64_tr_b16 v[122:123], v13 offset:63488
    s_waitcnt lgkmcnt(10)
    v_mfma_f32_16x16x32_bf16 v[40:43], v[100:103], v[224:227], v[40:43]
    s_waitcnt vmcnt(2)
    s_barrier
    v_mfma_f32_16x16x32_bf16 v[44:47], v[100:103], v[232:235], v[44:47]
    ds_read_b64_tr_b16 v[124:125], v14 offset:61440
    ds_read_b64_tr_b16 v[126:127], v14 offset:63488
    v_add_u32 v11, s42, v7
    v_add_u32 v12, s42, v8
    v_add_u32 v13, s42, v9
    v_add_u32 v14, s42, v10
    s_add_u32 s42, s42, 32768
    s_cmp_eq_u32 s42, 163840
    s_cselect_b32 s42, 0, s42
    s_waitcnt lgkmcnt(10)
    v_mfma_f32_16x16x32_bf16 v[48:51], v[104:107], v[224:227], v[48:51]
    v_mfma_f32_16x16x32_bf16 v[52:55], v[104:107], v[232:235], v[52:55]
    ds_read_b64_tr_b16 v[96:97], v11 offset:0
    ds_read_b64_tr_b16 v[98:99], v11 offset:2048
    buffer_store_dwordx4 v[88:91], v3, s[24:27], s32 offen offset:0 sc1
    s_waitcnt lgkmcnt(10)
    v_mfma_f32_16x16x32_bf16 v[56:59], v[108:111], v[224:227], v[56:59]
    v_mfma_f32_16x16x32_bf16 v[60:63], v[108:111], v[232:235], v[60:63]
    ds_read_b64_tr_b16 v[100:101], v12 offset:0
    ds_read_b64_tr_b16 v[102:103], v12 offset:2048
    s_waitcnt lgkmcnt(10)
    v_mfma_f32_16x16x32_bf16 v[32:35], v[112:115], v[240:243], v[32:35]
    v_mfma_f32_16x16x32_bf16 v[36:39], v[112:115], v[248:251], v[36:39]
    ds_read_b64_tr_b16 v[104:105], v13 offset:0
    ds_read_b64_tr_b16 v[106:107], v13 offset:2048
    s_waitcnt lgkmcnt(10)
    v_mfma_f32_16x16x32_bf16 v[40:43], v[116:119], v[240:243], v[40:43]
    v_mfma_f32_16x16x32_bf16 v[44:47], v[116:119], v[248:251], v[44:47]
    ds_read_b64_tr_b16 v[108:109], v14 offset:0
    ds_read_b64_tr_b16 v[110:111], v14 offset:2048
    s_waitcnt lgkmcnt(10)
    v_mfma_f32_16x16x32_bf16 v[48:51], v[120:123], v[240:243], v[48:51]
    buffer_store_dwordx4 v[92:95], v4, s[24:27], s32 offen offset:0 sc1
    v_mfma_f32_16x16x32_bf16 v[52:55], v[120:123], v[248:251], v[52:55]
    ds_read_b64_tr_b16 v[112:113], v11 offset:4096
    ds_read_b64_tr_b16 v[114:115], v11 offset:6144
    s_waitcnt lgkmcnt(10)
    v_mfma_f32_16x16x32_bf16 v[56:59], v[124:127], v[240:243], v[56:59]
    v_mfma_f32_16x16x32_bf16 v[60:63], v[124:127], v[248:251], v[60:63]
    ds_read_b64_tr_b16 v[116:117], v12 offset:4096
    ds_read_b64_tr_b16 v[118:119], v12 offset:6144
    s_waitcnt lgkmcnt(10)
    v_mfma_f32_16x16x32_bf16 v[64:67], v[96:99], v[128:131], 0
    v_add_u32 v21, s40, v15
    v_add_u32 v25, s40, v16
    v_xor_b32 v22, 32, v21
    v_xor_b32 v23, 64, v21
    v_xor_b32 v24, 96, v21
    v_mfma_f32_16x16x32_bf16 v[68:71], v[96:99], v[136:139], 0
    ds_read_b64_tr_b16 v[120:121], v13 offset:4096
    ds_read_b64_tr_b16 v[122:123], v13 offset:6144
    v_mul_f32 v32, v32, v19
    v_mul_f32 v33, v33, v19
    v_mul_f32 v34, v34, v19
    v_mul_f32 v35, v35, v19
    v_cvt_pk_bf16_f32 v32, v32, v33
    s_waitcnt lgkmcnt(10)
    v_mfma_f32_16x16x32_bf16 v[72:75], v[100:103], v[128:131], 0
    buffer_store_dwordx4 v[148:151], v1, s[24:27], s34 offen offset:128 sc1
    v_cvt_pk_bf16_f32 v33, v34, v35
    ds_write_b64 v21, v[32:33] offset:0
    v_mul_f32 v36, v36, v20
    v_mul_f32 v37, v37, v20
    v_mul_f32 v38, v38, v20
    v_mfma_f32_16x16x32_bf16 v[76:79], v[100:103], v[136:139], 0
    ds_read_b64_tr_b16 v[124:125], v14 offset:4096
    ds_read_b64_tr_b16 v[126:127], v14 offset:6144
    v_mul_f32 v39, v39, v20
    v_cvt_pk_bf16_f32 v36, v36, v37
    v_cvt_pk_bf16_f32 v37, v38, v39
    ds_write_b64 v21, v[36:37] offset:2048
    v_mul_f32 v40, v40, v19
    s_waitcnt lgkmcnt(12)
    v_mfma_f32_16x16x32_bf16 v[80:83], v[104:107], v[128:131], 0
    v_mul_f32 v41, v41, v19
    v_mul_f32 v42, v42, v19
    v_mul_f32 v43, v43, v19
    v_cvt_pk_bf16_f32 v40, v40, v41
    v_cvt_pk_bf16_f32 v41, v42, v43
    v_mfma_f32_16x16x32_bf16 v[84:87], v[104:107], v[136:139], 0
    ds_read_b64_tr_b16 v[96:97], v11 offset:8192
    ds_read_b64_tr_b16 v[98:99], v11 offset:10240
    ds_write_b64 v22, v[40:41] offset:0
    v_mul_f32 v44, v44, v20
    v_mul_f32 v45, v45, v20
    v_mul_f32 v46, v46, v20
    v_mul_f32 v47, v47, v20
    s_waitcnt lgkmcnt(13)
    v_mfma_f32_16x16x32_bf16 v[88:91], v[108:111], v[128:131], 0
    v_cvt_pk_bf16_f32 v44, v44, v45
    v_cvt_pk_bf16_f32 v45, v46, v47
    ds_write_b64 v22, v[44:45] offset:2048
    v_mul_f32 v48, v48, v19
    v_mul_f32 v49, v49, v19
    v_mfma_f32_16x16x32_bf16 v[92:95], v[108:111], v[136:139], 0
    ds_read_b64_tr_b16 v[100:101], v12 offset:8192
    s_waitcnt lgkmcnt(14)
    ds_read_b64_tr_b16 v[102:103], v12 offset:10240
    v_mul_f32 v50, v50, v19
    v_mul_f32 v51, v51, v19
    v_cvt_pk_bf16_f32 v48, v48, v49
    v_cvt_pk_bf16_f32 v49, v50, v51
    s_waitcnt lgkmcnt(14)
    ds_write_b64 v23, v[48:49] offset:0
    v_mfma_f32_16x16x32_bf16 v[64:67], v[112:115], v[144:147], v[64:67]
    v_mul_f32 v52, v52, v20
    v_mul_f32 v53, v53, v20
    v_mul_f32 v54, v54, v20
    v_mul_f32 v55, v55, v20
    v_cvt_pk_bf16_f32 v52, v52, v53
    v_mfma_f32_16x16x32_bf16 v[68:71], v[112:115], v[152:155], v[68:71]
    s_waitcnt lgkmcnt(14)
    ds_read_b64_tr_b16 v[104:105], v13 offset:8192
    s_waitcnt lgkmcnt(14)
    ds_read_b64_tr_b16 v[106:107], v13 offset:10240
    v_cvt_pk_bf16_f32 v53, v54, v55
    s_waitcnt lgkmcnt(14)
    ds_write_b64 v23, v[52:53] offset:2048
    v_mul_f32 v56, v56, v19
    v_mul_f32 v57, v57, v19
    v_mul_f32 v58, v58, v19
    v_mfma_f32_16x16x32_bf16 v[72:75], v[116:119], v[144:147], v[72:75]
    buffer_store_dwordx4 v[156:159], v2, s[24:27], s34 offen offset:128 sc1
    v_mul_f32 v59, v59, v19
    v_cvt_pk_bf16_f32 v56, v56, v57
    v_cvt_pk_bf16_f32 v57, v58, v59
    s_waitcnt lgkmcnt(14)
    ds_write_b64 v24, v[56:57] offset:0
    v_mul_f32 v60, v60, v20
    v_mfma_f32_16x16x32_bf16 v[76:79], v[116:119], v[152:155], v[76:79]
    s_waitcnt lgkmcnt(14)
    ds_read_b64_tr_b16 v[108:109], v14 offset:8192
    s_waitcnt lgkmcnt(14)
    ds_read_b64_tr_b16 v[110:111], v14 offset:10240
    v_mul_f32 v61, v61, v20
    v_mul_f32 v62, v62, v20
    v_mul_f32 v63, v63, v20
    v_cvt_pk_bf16_f32 v60, v60, v61
    v_cvt_pk_bf16_f32 v61, v62, v63
    v_mfma_f32_16x16x32_bf16 v[80:83], v[120:123], v[144:147], v[80:83]
    s_waitcnt lgkmcnt(14)
    ds_write_b64 v24, v[60:61] offset:2048
    v_mfma_f32_16x16x32_bf16 v[84:87], v[120:123], v[152:155], v[84:87]
    s_waitcnt lgkmcnt(14)
    ds_read_b64_tr_b16 v[112:113], v11 offset:12288
    s_waitcnt lgkmcnt(14)
    ds_read_b64_tr_b16 v[114:115], v11 offset:14336
    s_waitcnt lgkmcnt(14)
    ds_read_b128 v[48:51], v25 offset:0
    s_waitcnt lgkmcnt(14)
    ds_read_b128 v[52:55], v25 offset:1024
    s_waitcnt lgkmcnt(14)
    ds_read_b128 v[56:59], v25 offset:2048
    s_waitcnt lgkmcnt(14)
    ds_read_b128 v[60:63], v25 offset:3072
    v_mfma_f32_16x16x32_bf16 v[88:91], v[124:127], v[144:147], v[88:91]
    v_mfma_f32_16x16x32_bf16 v[92:95], v[124:127], v[152:155], v[92:95]
    s_waitcnt lgkmcnt(14)
    ds_read_b64_tr_b16 v[116:117], v12 offset:12288
    s_waitcnt lgkmcnt(14)
    ds_read_b64_tr_b16 v[118:119], v12 offset:14336
    v_mfma_f32_16x16x32_bf16 v[64:67], v[96:99], v[160:163], v[64:67]
    s_waitcnt lgkmcnt(5)
    buffer_store_dwordx4 v[48:51], v1, s[24:27], s32 offen offset:128 sc1
    v_mfma_f32_16x16x32_bf16 v[68:71], v[96:99], v[168:171], v[68:71]
    ds_read_b64_tr_b16 v[120:121], v13 offset:12288
    ds_read_b64_tr_b16 v[122:123], v13 offset:14336
    v_mfma_f32_16x16x32_bf16 v[72:75], v[100:103], v[160:163], v[72:75]
    buffer_store_dwordx4 v[164:167], v3, s[24:27], s34 offen offset:128 sc1
    v_mfma_f32_16x16x32_bf16 v[76:79], v[100:103], v[168:171], v[76:79]
    ds_read_b64_tr_b16 v[124:125], v14 offset:12288
    ds_read_b64_tr_b16 v[126:127], v14 offset:14336
    v_mfma_f32_16x16x32_bf16 v[80:83], v[104:107], v[160:163], v[80:83]
    v_mfma_f32_16x16x32_bf16 v[84:87], v[104:107], v[168:171], v[84:87]
    ds_read_b64_tr_b16 v[96:97], v11 offset:16384
    ds_read_b64_tr_b16 v[98:99], v11 offset:18432
    v_mfma_f32_16x16x32_bf16 v[88:91], v[108:111], v[160:163], v[88:91]
    v_mfma_f32_16x16x32_bf16 v[92:95], v[108:111], v[168:171], v[92:95]
    ds_read_b64_tr_b16 v[100:101], v12 offset:16384
    ds_read_b64_tr_b16 v[102:103], v12 offset:18432
    v_mfma_f32_16x16x32_bf16 v[64:67], v[112:115], v[176:179], v[64:67]
    v_mfma_f32_16x16x32_bf16 v[68:71], v[112:115], v[184:187], v[68:71]
    ds_read_b64_tr_b16 v[104:105], v13 offset:16384
    ds_read_b64_tr_b16 v[106:107], v13 offset:18432
    s_waitcnt lgkmcnt(10)
    v_mfma_f32_16x16x32_bf16 v[72:75], v[116:119], v[176:179], v[72:75]
    buffer_store_dwordx4 v[172:175], v4, s[24:27], s34 offen offset:128 sc1
    v_mfma_f32_16x16x32_bf16 v[76:79], v[116:119], v[184:187], v[76:79]
    ds_read_b64_tr_b16 v[108:109], v14 offset:16384
    ds_read_b64_tr_b16 v[110:111], v14 offset:18432
    s_waitcnt lgkmcnt(10)
    v_mfma_f32_16x16x32_bf16 v[80:83], v[120:123], v[176:179], v[80:83]
    v_mfma_f32_16x16x32_bf16 v[84:87], v[120:123], v[184:187], v[84:87]
    ds_read_b64_tr_b16 v[112:113], v11 offset:20480
    ds_read_b64_tr_b16 v[114:115], v11 offset:22528
    s_waitcnt lgkmcnt(10)
    v_mfma_f32_16x16x32_bf16 v[88:91], v[124:127], v[176:179], v[88:91]
    buffer_store_dwordx4 v[52:55], v2, s[24:27], s32 offen offset:128 sc1
    v_mfma_f32_16x16x32_bf16 v[92:95], v[124:127], v[184:187], v[92:95]
    ds_read_b64_tr_b16 v[116:117], v12 offset:20480
    ds_read_b64_tr_b16 v[118:119], v12 offset:22528
    s_waitcnt lgkmcnt(10)
    v_mfma_f32_16x16x32_bf16 v[64:67], v[96:99], v[192:195], v[64:67]
    v_mfma_f32_16x16x32_bf16 v[68:71], v[96:99], v[200:203], v[68:71]
    ds_read_b64_tr_b16 v[120:121], v13 offset:20480
    ds_read_b64_tr_b16 v[122:123], v13 offset:22528
    s_waitcnt lgkmcnt(10)
    v_mfma_f32_16x16x32_bf16 v[72:75], v[100:103], v[192:195], v[72:75]
    v_mfma_f32_16x16x32_bf16 v[76:79], v[100:103], v[200:203], v[76:79]
    ds_read_b64_tr_b16 v[124:125], v14 offset:20480
    ds_read_b64_tr_b16 v[126:127], v14 offset:22528
    buffer_store_dwordx4 v[180:183], v1, s[24:27], s34 offen offset:256 sc1
    s_waitcnt lgkmcnt(10)
    v_mfma_f32_16x16x32_bf16 v[80:83], v[104:107], v[192:195], v[80:83]
    v_mfma_f32_16x16x32_bf16 v[84:87], v[104:107], v[200:203], v[84:87]
    ds_read_b64_tr_b16 v[96:97], v11 offset:24576
    ds_read_b64_tr_b16 v[98:99], v11 offset:26624
    s_waitcnt lgkmcnt(10)
    v_mfma_f32_16x16x32_bf16 v[88:91], v[108:111], v[192:195], v[88:91]
    v_mfma_f32_16x16x32_bf16 v[92:95], v[108:111], v[200:203], v[92:95]
    ds_read_b64_tr_b16 v[100:101], v12 offset:24576
    ds_read_b64_tr_b16 v[102:103], v12 offset:26624
    s_waitcnt lgkmcnt(10)
    v_mfma_f32_16x16x32_bf16 v[64:67], v[112:115], v[208:211], v[64:67]
    v_mfma_f32_16x16x32_bf16 v[68:71], v[112:115], v[216:219], v[68:71]
    ds_read_b64_tr_b16 v[104:105], v13 offset:24576
    ds_read_b64_tr_b16 v[106:107], v13 offset:26624
    s_waitcnt lgkmcnt(10)
    v_mfma_f32_16x16x32_bf16 v[72:75], v[116:119], v[208:211], v[72:75]
    v_mfma_f32_16x16x32_bf16 v[76:79], v[116:119], v[216:219], v[76:79]
    ds_read_b64_tr_b16 v[108:109], v14 offset:24576
    ds_read_b64_tr_b16 v[110:111], v14 offset:26624
    buffer_store_dwordx4 v[188:191], v2, s[24:27], s34 offen offset:256 sc1
    s_waitcnt lgkmcnt(10)
    v_mfma_f32_16x16x32_bf16 v[80:83], v[120:123], v[208:211], v[80:83]
    v_mfma_f32_16x16x32_bf16 v[84:87], v[120:123], v[216:219], v[84:87]
    ds_read_b64_tr_b16 v[112:113], v11 offset:28672
    ds_read_b64_tr_b16 v[114:115], v11 offset:30720
    buffer_store_dwordx4 v[56:59], v3, s[24:27], s32 offen offset:128 sc1
    s_waitcnt lgkmcnt(10)
    v_mfma_f32_16x16x32_bf16 v[88:91], v[124:127], v[208:211], v[88:91]
    v_mfma_f32_16x16x32_bf16 v[92:95], v[124:127], v[216:219], v[92:95]
    ds_read_b64_tr_b16 v[116:117], v12 offset:28672
    ds_read_b64_tr_b16 v[118:119], v12 offset:30720
    s_waitcnt lgkmcnt(10)
    v_mfma_f32_16x16x32_bf16 v[64:67], v[96:99], v[224:227], v[64:67]
    v_mfma_f32_16x16x32_bf16 v[68:71], v[96:99], v[232:235], v[68:71]
    ds_read_b64_tr_b16 v[120:121], v13 offset:28672
    ds_read_b64_tr_b16 v[122:123], v13 offset:30720
    s_waitcnt lgkmcnt(10)
    v_mfma_f32_16x16x32_bf16 v[72:75], v[100:103], v[224:227], v[72:75]
    v_mfma_f32_16x16x32_bf16 v[76:79], v[100:103], v[232:235], v[76:79]
    ds_read_b64_tr_b16 v[124:125], v14 offset:28672
    ds_read_b64_tr_b16 v[126:127], v14 offset:30720
    buffer_store_dwordx4 v[196:199], v3, s[24:27], s34 offen offset:256 sc1
    s_waitcnt lgkmcnt(10)
    v_mfma_f32_16x16x32_bf16 v[80:83], v[104:107], v[224:227], v[80:83]
    v_mfma_f32_16x16x32_bf16 v[84:87], v[104:107], v[232:235], v[84:87]
    s_waitcnt lgkmcnt(8)
    v_mfma_f32_16x16x32_bf16 v[88:91], v[108:111], v[224:227], v[88:91]
    v_mfma_f32_16x16x32_bf16 v[92:95], v[108:111], v[232:235], v[92:95]
    s_waitcnt lgkmcnt(6)
    v_mfma_f32_16x16x32_bf16 v[64:67], v[112:115], v[240:243], v[64:67]
    v_mfma_f32_16x16x32_bf16 v[68:71], v[112:115], v[248:251], v[68:71]
    s_waitcnt lgkmcnt(4)
    v_mfma_f32_16x16x32_bf16 v[72:75], v[116:119], v[240:243], v[72:75]
    v_mfma_f32_16x16x32_bf16 v[76:79], v[116:119], v[248:251], v[76:79]
    s_waitcnt lgkmcnt(2)
    v_mfma_f32_16x16x32_bf16 v[80:83], v[120:123], v[240:243], v[80:83]
    buffer_store_dwordx4 v[204:207], v4, s[24:27], s34 offen offset:256 sc1
    buffer_store_dwordx4 v[60:63], v4, s[24:27], s32 offen offset:128 sc1
    v_mfma_f32_16x16x32_bf16 v[84:87], v[120:123], v[248:251], v[84:87]
    s_waitcnt lgkmcnt(0)
    v_mfma_f32_16x16x32_bf16 v[88:91], v[124:127], v[240:243], v[88:91]
    v_mfma_f32_16x16x32_bf16 v[92:95], v[124:127], v[248:251], v[92:95]
    s_mov_b32 s34, s32
    v_add_u32 v21, s40, v15
    v_add_u32 v25, s40, v16
    v_xor_b32 v22, 32, v21
    v_xor_b32 v23, 64, v21
    v_xor_b32 v24, 96, v21
    v_mul_f32 v64, v64, v19
    v_mul_f32 v65, v65, v19
    v_mul_f32 v66, v66, v19
    v_mul_f32 v67, v67, v19
    v_cvt_pk_bf16_f32 v64, v64, v65
    v_cvt_pk_bf16_f32 v65, v66, v67
    ds_write_b64 v21, v[64:65] offset:0
    v_mul_f32 v68, v68, v20
    v_mul_f32 v69, v69, v20
    v_mul_f32 v70, v70, v20
    v_mul_f32 v71, v71, v20
    v_cvt_pk_bf16_f32 v68, v68, v69
    v_cvt_pk_bf16_f32 v69, v70, v71
    ds_write_b64 v21, v[68:69] offset:2048
    v_mul_f32 v72, v72, v19
    v_mul_f32 v73, v73, v19
    v_mul_f32 v74, v74, v19
    v_mul_f32 v75, v75, v19
    v_cvt_pk_bf16_f32 v72, v72, v73
    v_cvt_pk_bf16_f32 v73, v74, v75
    ds_write_b64 v22, v[72:73] offset:0
    v_mul_f32 v76, v76, v20
    v_mul_f32 v77, v77, v20
    v_mul_f32 v78, v78, v20
    v_mul_f32 v79, v79, v20
    v_cvt_pk_bf16_f32 v76, v76, v77
    v_cvt_pk_bf16_f32 v77, v78, v79
    ds_write_b64 v22, v[76:77] offset:2048
    v_mul_f32 v80, v80, v19
    v_mul_f32 v81, v81, v19
    v_mul_f32 v82, v82, v19
    v_mul_f32 v83, v83, v19
    v_cvt_pk_bf16_f32 v80, v80, v81
    v_cvt_pk_bf16_f32 v81, v82, v83
    ds_write_b64 v23, v[80:81] offset:0
    v_mul_f32 v84, v84, v20
    v_mul_f32 v85, v85, v20
    v_mul_f32 v86, v86, v20
    v_mul_f32 v87, v87, v20
    v_cvt_pk_bf16_f32 v84, v84, v85
    v_cvt_pk_bf16_f32 v85, v86, v87
    ds_write_b64 v23, v[84:85] offset:2048
    v_mul_f32 v88, v88, v19
    v_mul_f32 v89, v89, v19
    v_mul_f32 v90, v90, v19
    v_mul_f32 v91, v91, v19
    v_cvt_pk_bf16_f32 v88, v88, v89
    v_cvt_pk_bf16_f32 v89, v90, v91
    ds_write_b64 v24, v[88:89] offset:0
    v_mul_f32 v92, v92, v20
    v_mul_f32 v93, v93, v20
    v_mul_f32 v94, v94, v20
    v_mul_f32 v95, v95, v20
    v_cvt_pk_bf16_f32 v92, v92, v93
    v_cvt_pk_bf16_f32 v93, v94, v95
    ds_write_b64 v24, v[92:93] offset:2048
    ds_read_b128 v[80:83], v25 offset:0
    ds_read_b128 v[84:87], v25 offset:1024
    ds_read_b128 v[88:91], v25 offset:2048
    ds_read_b128 v[92:95], v25 offset:3072
    s_waitcnt lgkmcnt(3)
    buffer_store_dwordx4 v[80:83], v1, s[24:27], s34 offen offset:256 sc1
    s_waitcnt lgkmcnt(2)
    buffer_store_dwordx4 v[84:87], v2, s[24:27], s34 offen offset:256 sc1
    s_waitcnt lgkmcnt(1)
    buffer_store_dwordx4 v[88:91], v3, s[24:27], s34 offen offset:256 sc1
    s_waitcnt lgkmcnt(0)
    buffer_store_dwordx4 v[92:95], v4, s[24:27], s34 offen offset:256 sc1
L_end:
    s_endpgm
.p2align 6
LV1_entry:
    s_cmp_ge_u32 s2, 256
    s_cbranch_scc1 L_end
    s_load_dwordx8 s[4:11], s[0:1], 0
    v_lshrrev_b32 v128, 6, v0
    v_and_b32 v0, 63, v0
    v_readfirstlane_b32 s38, v128
    v_lshrrev_b32 v129, 3, v0
    v_lshl_add_u32 v130, v128, 5, v129
    v_and_b32 v131, 7, v0
    v_xor_b32 v131, v131, v129
    v_mul_u32_u24 v130, 171, v130
    v_and_b32 v132, 0xff, v130
    v_mul_u32_u24 v132, 0x180, v132
    v_lshl_add_u32 v1, v131, 4, v132
    v_add_u32 v130, 1368, v130
    v_and_b32 v132, 0xff, v130
    v_mul_u32_u24 v132, 0x180, v132
    v_lshl_add_u32 v2, v131, 4, v132
    v_add_u32 v130, 1368, v130
    v_and_b32 v132, 0xff, v130
    v_mul_u32_u24 v132, 0x180, v132
    v_lshl_add_u32 v3, v131, 4, v132
    v_add_u32 v130, 1368, v130
    v_and_b32 v132, 0xff, v130
    v_mul_u32_u24 v132, 0x180, v132
    v_lshl_add_u32 v4, v131, 4, v132
    s_lshl_b32 s35, s38, 12
    s_xor_b32 s39, s2, 0
    s_and_b32 s32, s39, 7
    s_lshr_b32 s39, s39, 3
    s_mul_i32 s32, s32, 3145728
    s_mul_i32 s39, s39, 98304
    s_add_u32 s32, s32, s39
    s_and_b32 s30, s2, 7
    s_lshl_b32 s30, s30, 5
    s_lshr_b32 s31, s2, 3
    s_add_u32 s30, s30, s31
    s_mov_b32 s43, 100663296
    s_mov_b32 s40, s35
    s_add_u32 s41, s35, 163840
    s_waitcnt lgkmcnt(0)
    s_mov_b32 s12, s4
    s_and_b32 s13, s5, 0xffff
    s_mov_b32 s14, 100663296
    s_mov_b32 s15, 0x20000
    s_mov_b32 s16, s6
    s_and_b32 s17, s7, 0xffff
    s_mov_b32 s18, 100663296
    s_mov_b32 s19, 0x20000
    s_mov_b32 s20, s8
    s_and_b32 s21, s9, 0xffff
    s_mov_b32 s22, 100663296
    s_mov_b32 s23, 0x20000
    s_mov_b32 s24, s10
    s_and_b32 s25, s11, 0xffff
    s_mov_b32 s26, 100663296
    s_mov_b32 s27, 0x20000
    s_mov_b32 m0, s40
    s_add_u32 s40, s40, 32768
    s_cmp_eq_u32 s40, s41
    s_cselect_b32 s40, s35, s40
    buffer_load_dwordx4 v1, s[12:15], s32 offen offset:0 nt lds
    s_add_u32 m0, m0, 1024
    s_nop 0
    buffer_load_dwordx4 v2, s[12:15], s32 offen offset:0 nt lds
    s_add_u32 m0, m0, 1024
    s_nop 0
    buffer_load_dwordx4 v3, s[12:15], s32 offen offset:0 nt lds
    s_add_u32 m0, m0, 1024
    s_nop 0
    buffer_load_dwordx4 v4, s[12:15], s32 offen offset:0 nt lds
    s_mov_b32 m0, s40
    s_add_u32 s40, s40, 32768
    s_cmp_eq_u32 s40, s41
    s_cselect_b32 s40, s35, s40
    buffer_load_dwordx4 v1, s[16:19], s32 offen offset:0 nt lds
    s_add_u32 m0, m0, 1024
    s_nop 0
    buffer_load_dwordx4 v2, s[16:19], s32 offen offset:0 nt lds
    s_add_u32 m0, m0, 1024
    s_nop 0
    buffer_load_dwordx4 v3, s[16:19], s32 offen offset:0 nt lds
    s_add_u32 m0, m0, 1024
    s_nop 0
    buffer_load_dwordx4 v4, s[16:19], s32 offen offset:0 nt lds
    v_and_b32 v129, 15, v0
    v_lshrrev_b32 v130, 4, v0
    v_and_b32 v131, 7, v0
    v_xor_b32 v132, v130, v131
    v_lshlrev_b32 v133, 7, v129
    v_lshl_add_u32 v5, v132, 4, v133
    v_xor_b32 v6, 64, v5
    v_lshrrev_b32 v132, 1, v130
    v_xor_b32 v132, v132, v131
    v_lshl_add_u32 v132, v132, 4, v133
    v_and_b32 v134, 1, v130
    v_lshl_add_u32 v15, v134, 3, v132
    v_lshlrev_b32 v16, 4, v0
    v_lshrrev_b32 v129, 2, v0
    v_and_b32 v131, 7, v129
    v_bfe_u32 v132, v0, 1, 1
    v_xor_b32 v132, v132, v131
    v_lshlrev_b32 v133, 7, v129
    v_lshl_add_u32 v132, v132, 4, v133
    v_and_b32 v134, 1, v0
    v_lshl_add_u32 v7, v134, 3, v132
    v_xor_b32 v8, 32, v7
    v_xor_b32 v9, 64, v7
    v_xor_b32 v10, 96, v7
    v_mov_b32 v26, 0x3f803f80
    v_mov_b32 v27, 0x3f803f80
    v_mov_b32 v28, 0x3f803f80
    v_mov_b32 v29, 0x3f803f80
    s_mov_b32 s37, 0x3dd53b95
    s_mov_b32 s36, 0
    s_mov_b32 s42, 0
    s_mov_b32 s34, 0
    s_add_u32 s28, s42, s35
    s_add_u32 s42, s42, 32768
    s_cmp_eq_u32 s42, 163840
    s_cselect_b32 s42, 0, s42
    v_add_u32 v13, s28, v5
    v_add_u32 v11, s42, v5
    v_add_u32 v14, s28, v6
    v_add_u32 v12, s42, v6
    s_add_u32 s42, s42, 32768
    s_cmp_eq_u32 s42, 163840
    s_cselect_b32 s42, 0, s42
    s_waitcnt vmcnt(0)
    s_barrier
    ds_read_b128 v[96:99], v13 offset:0
    ds_read_b128 v[64:67], v11 offset:0
    ds_read_b128 v[100:103], v13 offset:2048
    ds_read_b128 v[68:71], v11 offset:2048
    ds_read_b128 v[72:75], v11 offset:4096
    ds_read_b128 v[76:79], v11 offset:6144
    ds_read_b128 v[80:83], v11 offset:8192
    ds_read_b128 v[84:87], v11 offset:10240
    ds_read_b128 v[88:91], v11 offset:12288
    ds_read_b128 v[92:95], v11 offset:14336
    ds_read_b128 v[104:107], v14 offset:0
    s_add_u32 s3, s36, 1
    s_mul_i32 s31, s3, 33
    s_xor_b32 s31, s31, s30
    s_lshl_b32 s3, s3, 8
    s_add_u32 s31, s31, s3
    s_mul_i32 s33, s31, 98304
    s_waitcnt lgkmcnt(9)
    v_mfma_f32_16x16x32_bf16 v[128:131], v[64:67], v[96:99], 0
    s_waitcnt lgkmcnt(8)
    v_mfma_f32_16x16x32_bf16 v[136:139], v[64:67], v[100:103], 0
    ds_read_b128 v[112:115], v12 offset:0
    ds_read_b128 v[108:111], v14 offset:2048
    s_add_u32 s39, s32, 128
    s_mov_b32 m0, s40
    s_add_u32 s40, s40, 32768
    s_cmp_eq_u32 s40, s41
    s_cselect_b32 s40, s35, s40
    buffer_load_dwordx4 v1, s[12:15], s39 offen offset:0 nt lds
    s_add_u32 m0, m0, 1024
    s_waitcnt lgkmcnt(9)
    v_mfma_f32_16x16x32_bf16 v[132:135], v[68:71], v[96:99], 0
    v_mfma_f32_16x16x32_bf16 v[140:143], v[68:71], v[100:103], 0
    ds_read_b128 v[116:119], v12 offset:2048
    s_waitcnt lgkmcnt(9)
    v_mfma_f32_16x16x32_bf16 v[144:147], v[72:75], v[96:99], 0
    v_mfma_f32_16x16x32_bf16 v[152:155], v[72:75], v[100:103], 0
    ds_read_b128 v[120:123], v12 offset:4096
    s_waitcnt lgkmcnt(9)
    v_mfma_f32_16x16x32_bf16 v[148:151], v[76:79], v[96:99], 0
    buffer_load_dwordx4 v2, s[12:15], s39 offen offset:0 nt lds
    s_add_u32 m0, m0, 1024
    v_mfma_f32_16x16x32_bf16 v[156:159], v[76:79], v[100:103], 0
    ds_read_b128 v[124:127], v12 offset:6144
    s_waitcnt lgkmcnt(9)
    v_mfma_f32_16x16x32_bf16 v[160:163], v[80:83], v[96:99], 0
    v_mfma_f32_16x16x32_bf16 v[168:171], v[80:83], v[100:103], 0
    ds_read_b128 v[64:67], v12 offset:8192
    s_waitcnt lgkmcnt(9)
    v_mfma_f32_16x16x32_bf16 v[164:167], v[84:87], v[96:99], 0
    v_mfma_f32_16x16x32_bf16 v[172:175], v[84:87], v[100:103], 0
    ds_read_b128 v[68:71], v12 offset:10240
    buffer_load_dwordx4 v3, s[12:15], s39 offen offset:0 nt lds
    s_add_u32 m0, m0, 1024
    s_waitcnt lgkmcnt(9)
    v_mfma_f32_16x16x32_bf16 v[176:179], v[88:91], v[96:99], 0
    v_mfma_f32_16x16x32_bf16 v[184:187], v[88:91], v[100:103], 0
    ds_read_b128 v[72:75], v12 offset:12288
    s_waitcnt lgkmcnt(9)
    v_mfma_f32_16x16x32_bf16 v[180:183], v[92:95], v[96:99], 0
    v_mfma_f32_16x16x32_bf16 v[188:191], v[92:95], v[100:103], 0
    ds_read_b128 v[76:79], v12 offset:14336
    s_waitcnt lgkmcnt(8)
    v_mfma_f32_16x16x32_bf16 v[128:131], v[112:115], v[104:107], v[128:131]
    s_waitcnt lgkmcnt(7)
    v_mfma_f32_16x16x32_bf16 v[136:139], v[112:115], v[108:111], v[136:139]
    ds_read_b128 v[80:83], v11 offset:16384
    buffer_load_dwordx4 v4, s[12:15], s39 offen offset:0 nt lds
    s_waitcnt lgkmcnt(7)
    v_mfma_f32_16x16x32_bf16 v[132:135], v[116:119], v[104:107], v[132:135]
    v_mfma_f32_16x16x32_bf16 v[140:143], v[116:119], v[108:111], v[140:143]
    ds_read_b128 v[84:87], v11 offset:18432
    s_waitcnt lgkmcnt(7)
    v_mfma_f32_16x16x32_bf16 v[144:147], v[120:123], v[104:107], v[144:147]
    v_mfma_f32_16x16x32_bf16 v[152:155], v[120:123], v[108:111], v[152:155]
    ds_read_b128 v[88:91], v11 offset:20480
    s_waitcnt lgkmcnt(7)
    v_mfma_f32_16x16x32_bf16 v[148:151], v[124:127], v[104:107], v[148:151]
    s_add_u32 s39, s32, 128
    s_mov_b32 m0, s40
    s_add_u32 s40, s40, 32768
    s_cmp_eq_u32 s40, s41
    s_cselect_b32 s40, s35, s40
    buffer_load_dwordx4 v1, s[16:19], s39 offen offset:0 nt lds
    s_add_u32 m0, m0, 1024
    v_mfma_f32_16x16x32_bf16 v[156:159], v[124:127], v[108:111], v[156:159]
    ds_read_b128 v[92:95], v11 offset:22528
    s_waitcnt lgkmcnt(7)
    v_mfma_f32_16x16x32_bf16 v[160:163], v[64:67], v[104:107], v[160:163]
    v_mfma_f32_16x16x32_bf16 v[168:171], v[64:67], v[108:111], v[168:171]
    ds_read_b128 v[112:115], v11 offset:24576
    s_waitcnt lgkmcnt(7)
    v_mfma_f32_16x16x32_bf16 v[164:167], v[68:71], v[104:107], v[164:167]
    v_mfma_f32_16x16x32_bf16 v[172:175], v[68:71], v[108:111], v[172:175]
    ds_read_b128 v[116:119], v11 offset:26624
    buffer_load_dwordx4 v2, s[16:19], s39 offen offset:0 nt lds
    s_add_u32 m0, m0, 1024
    s_waitcnt lgkmcnt(7)
    v_mfma_f32_16x16x32_bf16 v[176:179], v[72:75], v[104:107], v[176:179]
    v_mfma_f32_16x16x32_bf16 v[184:187], v[72:75], v[108:111], v[184:187]
    ds_read_b128 v[120:123], v11 offset:28672
    s_waitcnt lgkmcnt(7)
    v_mfma_f32_16x16x32_bf16 v[180:183], v[76:79], v[104:107], v[180:183]
    v_mfma_f32_16x16x32_bf16 v[188:191], v[76:79], v[108:111], v[188:191]
    ds_read_b128 v[124:127], v11 offset:30720
    s_waitcnt lgkmcnt(7)
    v_mfma_f32_16x16x32_bf16 v[192:195], v[80:83], v[96:99], 0
    v_mfma_f32_16x16x32_bf16 v[200:203], v[80:83], v[100:103], 0
    ds_read_b128 v[64:67], v12 offset:16384
    buffer_load_dwordx4 v3, s[16:19], s39 offen offset:0 nt lds
    s_add_u32 m0, m0, 1024
    s_waitcnt lgkmcnt(7)
    v_mfma_f32_16x16x32_bf16 v[196:199], v[84:87], v[96:99], 0
    v_mfma_f32_16x16x32_bf16 v[204:207], v[84:87], v[100:103], 0
    ds_read_b128 v[68:71], v12 offset:18432
    s_waitcnt lgkmcnt(7)
    v_mfma_f32_16x16x32_bf16 v[208:211], v[88:91], v[96:99], 0
    v_mfma_f32_16x16x32_bf16 v[216:219], v[88:91], v[100:103], 0
    ds_read_b128 v[72:75], v12 offset:20480
    s_waitcnt lgkmcnt(7)
    v_mfma_f32_16x16x32_bf16 v[212:215], v[92:95], v[96:99], 0
    buffer_load_dwordx4 v4, s[16:19], s39 offen offset:0 nt lds
    v_mfma_f32_16x16x32_bf16 v[220:223], v[92:95], v[100:103], 0
    ds_read_b128 v[76:79], v12 offset:22528
    s_waitcnt lgkmcnt(7)
    v_mfma_f32_16x16x32_bf16 v[224:227], v[112:115], v[96:99], 0
    v_mfma_f32_16x16x32_bf16 v[232:235], v[112:115], v[100:103], 0
    ds_read_b128 v[80:83], v12 offset:24576
    s_waitcnt lgkmcnt(7)
    v_mfma_f32_16x16x32_bf16 v[228:231], v[116:119], v[96:99], 0
    v_mfma_f32_16x16x32_bf16 v[236:239], v[116:119], v[100:103], 0
    ds_read_b128 v[84:87], v12 offset:26624
    s_add_u32 s39, s32, 256
    s_mov_b32 m0, s40
    s_add_u32 s40, s40, 32768
    s_cmp_eq_u32 s40, s41
    s_cselect_b32 s40, s35, s40
    buffer_load_dwordx4 v1, s[12:15], s39 offen offset:0 nt lds
    s_add_u32 m0, m0, 1024
    s_waitcnt lgkmcnt(7)
    v_mfma_f32_16x16x32_bf16 v[240:243], v[120:123], v[96:99], 0
    v_mfma_f32_16x16x32_bf16 v[248:251], v[120:123], v[100:103], 0
    ds_read_b128 v[88:91], v12 offset:28672
    s_waitcnt lgkmcnt(7)
    v_mfma_f32_16x16x32_bf16 v[244:247], v[124:127], v[96:99], 0
    v_mfma_f32_16x16x32_bf16 v[252:255], v[124:127], v[100:103], 0
    ds_read_b128 v[92:95], v12 offset:30720
    s_waitcnt lgkmcnt(7)
    v_mfma_f32_16x16x32_bf16 v[192:195], v[64:67], v[104:107], v[192:195]
    v_mfma_f32_16x16x32_bf16 v[200:203], v[64:67], v[108:111], v[200:203]
    buffer_load_dwordx4 v2, s[12:15], s39 offen offset:0 nt lds
    s_add_u32 m0, m0, 1024
    s_waitcnt lgkmcnt(6)
    v_mfma_f32_16x16x32_bf16 v[196:199], v[68:71], v[104:107], v[196:199]
    v_mfma_f32_16x16x32_bf16 v[204:207], v[68:71], v[108:111], v[204:207]
    s_waitcnt lgkmcnt(5)
    v_mfma_f32_16x16x32_bf16 v[208:211], v[72:75], v[104:107], v[208:211]
    v_mfma_f32_16x16x32_bf16 v[216:219], v[72:75], v[108:111], v[216:219]
    s_waitcnt lgkmcnt(4)
    v_mfma_f32_16x16x32_bf16 v[212:215], v[76:79], v[104:107], v[212:215]
    buffer_load_dwordx4 v3, s[12:15], s39 offen offset:0 nt lds
    s_add_u32 m0, m0, 1024
    v_mfma_f32_16x16x32_bf16 v[220:223], v[76:79], v[108:111], v[220:223]
    s_waitcnt lgkmcnt(3)
    v_mfma_f32_16x16x32_bf16 v[224:227], v[80:83], v[104:107], v[224:227]
    v_mfma_f32_16x16x32_bf16 v[232:235], v[80:83], v[108:111], v[232:235]
    s_waitcnt lgkmcnt(2)
    v_mfma_f32_16x16x32_bf16 v[228:231], v[84:87], v[104:107], v[228:231]
    v_mfma_f32_16x16x32_bf16 v[236:239], v[84:87], v[108:111], v[236:239]
    s_waitcnt lgkmcnt(1)
    v_mfma_f32_16x16x32_bf16 v[240:243], v[88:91], v[104:107], v[240:243]
    buffer_load_dwordx4 v4, s[12:15], s39 offen offset:0 nt lds
    v_mfma_f32_16x16x32_bf16 v[248:251], v[88:91], v[108:111], v[248:251]
    s_waitcnt lgkmcnt(0)
    v_mfma_f32_16x16x32_bf16 v[244:247], v[92:95], v[104:107], v[244:247]
    v_mfma_f32_16x16x32_bf16 v[252:255], v[92:95], v[108:111], v[252:255]
    s_add_u32 s28, s42, s35
    s_add_u32 s42, s42, 32768
    s_cmp_eq_u32 s42, 163840
    s_cselect_b32 s42, 0, s42
    v_add_u32 v13, s28, v5
    v_add_u32 v11, s42, v5
    v_add_u32 v14, s28, v6
    v_add_u32 v12, s42, v6
    s_add_u32 s42, s42, 32768
    s_cmp_eq_u32 s42, 163840
    s_cselect_b32 s42, 0, s42
    s_waitcnt vmcnt(4)
    s_barrier
    ds_read_b128 v[96:99], v13 offset:0
    ds_read_b128 v[112:115], v11 offset:0
    ds_read_b128 v[100:103], v13 offset:2048
    ds_read_b128 v[116:119], v11 offset:2048
    ds_read_b128 v[120:123], v11 offset:4096
    ds_read_b128 v[124:127], v11 offset:6144
    ds_read_b128 v[64:67], v11 offset:8192
    ds_read_b128 v[68:71], v11 offset:10240
    ds_read_b128 v[72:75], v11 offset:12288
    ds_read_b128 v[76:79], v11 offset:14336
    ds_read_b128 v[104:107], v14 offset:0
    s_waitcnt lgkmcnt(9)
    v_mfma_f32_16x16x32_bf16 v[128:131], v[112:115], v[96:99], v[128:131]
    s_waitcnt lgkmcnt(8)
    v_mfma_f32_16x16x32_bf16 v[136:139], v[112:115], v[100:103], v[136:139]
    ds_read_b128 v[80:83], v12 offset:0
    ds_read_b128 v[108:111], v14 offset:2048
    s_add_u32 s39, s32, 256
    s_mov_b32 m0, s40
    s_add_u32 s40, s40, 32768
    s_cmp_eq_u32 s40, s41
    s_cselect_b32 s40, s35, s40
    buffer_load_dwordx4 v1, s[16:19], s39 offen offset:0 nt lds
    s_add_u32 m0, m0, 1024
    s_waitcnt lgkmcnt(9)
    v_mfma_f32_16x16x32_bf16 v[132:135], v[116:119], v[96:99], v[132:135]
    v_mfma_f32_16x16x32_bf16 v[140:143], v[116:119], v[100:103], v[140:143]
    ds_read_b128 v[84:87], v12 offset:2048
    s_waitcnt lgkmcnt(9)
    v_mfma_f32_16x16x32_bf16 v[144:147], v[120:123], v[96:99], v[144:147]
    v_mfma_f32_16x16x32_bf16 v[152:155], v[120:123], v[100:103], v[152:155]
    ds_read_b128 v[88:91], v12 offset:4096
    s_waitcnt lgkmcnt(9)
    v_mfma_f32_16x16x32_bf16 v[148:151], v[124:127], v[96:99], v[148:151]
    v_mfma_f32_16x16x32_bf16 v[156:159], v[124:127], v[100:103], v[156:159]
    ds_read_b128 v[92:95], v12 offset:6144
    s_waitcnt lgkmcnt(9)
    v_mfma_f32_16x16x32_bf16 v[160:163], v[64:67], v[96:99], v[160:163]
    v_mfma_f32_16x16x32_bf16 v[168:171], v[64:67], v[100:103], v[168:171]
    ds_read_b128 v[112:115], v12 offset:8192
    buffer_load_dwordx4 v2, s[16:19], s39 offen offset:0 nt lds
    s_add_u32 m0, m0, 1024
    s_waitcnt lgkmcnt(9)
    v_mfma_f32_16x16x32_bf16 v[164:167], v[68:71], v[96:99], v[164:167]
    v_mfma_f32_16x16x32_bf16 v[172:175], v[68:71], v[100:103], v[172:175]
    ds_read_b128 v[116:119], v12 offset:10240
    s_waitcnt lgkmcnt(9)
    v_mfma_f32_16x16x32_bf16 v[176:179], v[72:75], v[96:99], v[176:179]
    v_mfma_f32_16x16x32_bf16 v[184:187], v[72:75], v[100:103], v[184:187]
    ds_read_b128 v[120:123], v12 offset:12288
    s_waitcnt lgkmcnt(9)
    v_mfma_f32_16x16x32_bf16 v[180:183], v[76:79], v[96:99], v[180:183]
    v_mfma_f32_16x16x32_bf16 v[188:191], v[76:79], v[100:103], v[188:191]
    ds_read_b128 v[124:127], v12 offset:14336
    s_waitcnt lgkmcnt(8)
    v_mfma_f32_16x16x32_bf16 v[128:131], v[80:83], v[104:107], v[128:131]
    s_waitcnt lgkmcnt(7)
    v_mfma_f32_16x16x32_bf16 v[136:139], v[80:83], v[108:111], v[136:139]
    ds_read_b128 v[64:67], v11 offset:16384
    buffer_load_dwordx4 v3, s[16:19], s39 offen offset:0 nt lds
    s_add_u32 m0, m0, 1024
    s_waitcnt lgkmcnt(7)
    v_mfma_f32_16x16x32_bf16 v[132:135], v[84:87], v[104:107], v[132:135]
    v_mfma_f32_16x16x32_bf16 v[140:143], v[84:87], v[108:111], v[140:143]
    ds_read_b128 v[68:71], v11 offset:18432
    s_waitcnt lgkmcnt(7)
    v_mfma_f32_16x16x32_bf16 v[144:147], v[88:91], v[104:107], v[144:147]
    v_mfma_f32_16x16x32_bf16 v[152:155], v[88:91], v[108:111], v[152:155]
    ds_read_b128 v[72:75], v11 offset:20480
    s_waitcnt lgkmcnt(7)
    v_mfma_f32_16x16x32_bf16 v[148:151], v[92:95], v[104:107], v[148:151]
    v_mfma_f32_16x16x32_bf16 v[156:159], v[92:95], v[108:111], v[156:159]
    ds_read_b128 v[76:79], v11 offset:22528
    s_waitcnt lgkmcnt(7)
    v_mfma_f32_16x16x32_bf16 v[160:163], v[112:115], v[104:107], v[160:163]
    v_mfma_f32_16x16x32_bf16 v[168:171], v[112:115], v[108:111], v[168:171]
    ds_read_b128 v[80:83], v11 offset:24576
    s_waitcnt lgkmcnt(7)
    v_mfma_f32_16x16x32_bf16 v[164:167], v[116:119], v[104:107], v[164:167]
    buffer_load_dwordx4 v4, s[16:19], s39 offen offset:0 nt lds
    v_mfma_f32_16x16x32_bf16 v[172:175], v[116:119], v[108:111], v[172:175]
    ds_read_b128 v[84:87], v11 offset:26624
    s_waitcnt lgkmcnt(7)
    v_mfma_f32_16x16x32_bf16 v[176:179], v[120:123], v[104:107], v[176:179]
    v_mfma_f32_16x16x32_bf16 v[184:187], v[120:123], v[108:111], v[184:187]
    ds_read_b128 v[88:91], v11 offset:28672
    s_waitcnt lgkmcnt(7)
    v_mfma_f32_16x16x32_bf16 v[180:183], v[124:127], v[104:107], v[180:183]
    v_mfma_f32_16x16x32_bf16 v[188:191], v[124:127], v[108:111], v[188:191]
    ds_read_b128 v[92:95], v11 offset:30720
    s_waitcnt lgkmcnt(7)
    v_mfma_f32_16x16x32_bf16 v[192:195], v[64:67], v[96:99], v[192:195]
    v_mfma_f32_16x16x32_bf16 v[200:203], v[64:67], v[100:103], v[200:203]
    ds_read_b128 v[112:115], v12 offset:16384
    s_waitcnt lgkmcnt(7)
    v_mfma_f32_16x16x32_bf16 v[196:199], v[68:71], v[96:99], v[196:199]
    s_mov_b32 m0, s40
    s_add_u32 s40, s40, 32768
    s_cmp_eq_u32 s40, s41
    s_cselect_b32 s40, s35, s40
    buffer_load_dwordx4 v1, s[20:23], s32 offen offset:0 nt lds
    s_add_u32 m0, m0, 1024
    v_mfma_f32_16x16x32_bf16 v[204:207], v[68:71], v[100:103], v[204:207]
    ds_read_b128 v[116:119], v12 offset:18432
    s_waitcnt lgkmcnt(7)
    v_mfma_f32_16x16x32_bf16 v[208:211], v[72:75], v[96:99], v[208:211]
    v_mfma_f32_16x16x32_bf16 v[216:219], v[72:75], v[100:103], v[216:219]
    ds_read_b128 v[120:123], v12 offset:20480
    s_waitcnt lgkmcnt(7)
    v_mfma_f32_16x16x32_bf16 v[212:215], v[76:79], v[96:99], v[212:215]
    v_mfma_f32_16x16x32_bf16 v[220:223], v[76:79], v[100:103], v[220:223]
    ds_read_b128 v[124:127], v12 offset:22528
    s_waitcnt lgkmcnt(7)
    v_mfma_f32_16x16x32_bf16 v[224:227], v[80:83], v[96:99], v[224:227]
    v_mfma_f32_16x16x32_bf16 v[232:235], v[80:83], v[100:103], v[232:235]
    ds_read_b128 v[64:67], v12 offset:24576
    s_waitcnt lgkmcnt(7)
    v_mfma_f32_16x16x32_bf16 v[228:231], v[84:87], v[96:99], v[228:231]
    v_mfma_f32_16x16x32_bf16 v[236:239], v[84:87], v[100:103], v[236:239]
    ds_read_b128 v[68:71], v12 offset:26624
    buffer_load_dwordx4 v2, s[20:23], s32 offen offset:0 nt lds
    s_add_u32 m0, m0, 1024
    s_waitcnt lgkmcnt(7)
    v_mfma_f32_16x16x32_bf16 v[240:243], v[88:91], v[96:99], v[240:243]
    v_mfma_f32_16x16x32_bf16 v[248:251], v[88:91], v[100:103], v[248:251]
    ds_read_b128 v[72:75], v12 offset:28672
    s_waitcnt lgkmcnt(7)
    v_mfma_f32_16x16x32_bf16 v[244:247], v[92:95], v[96:99], v[244:247]
    v_mfma_f32_16x16x32_bf16 v[252:255], v[92:95], v[100:103], v[252:255]
    ds_read_b128 v[76:79], v12 offset:30720
    s_waitcnt lgkmcnt(7)
    v_mfma_f32_16x16x32_bf16 v[192:195], v[112:115], v[104:107], v[192:195]
    v_mfma_f32_16x16x32_bf16 v[200:203], v[112:115], v[108:111], v[200:203]
    s_waitcnt lgkmcnt(6)
    v_mfma_f32_16x16x32_bf16 v[196:199], v[116:119], v[104:107], v[196:199]
    v_mfma_f32_16x16x32_bf16 v[204:207], v[116:119], v[108:111], v[204:207]
    buffer_load_dwordx4 v3, s[20:23], s32 offen offset:0 nt lds
    s_add_u32 m0, m0, 1024
    s_waitcnt lgkmcnt(5)
    v_mfma_f32_16x16x32_bf16 v[208:211], v[120:123], v[104:107], v[208:211]
    v_mfma_f32_16x16x32_bf16 v[216:219], v[120:123], v[108:111], v[216:219]
    s_waitcnt lgkmcnt(4)
    v_mfma_f32_16x16x32_bf16 v[212:215], v[124:127], v[104:107], v[212:215]
    v_mfma_f32_16x16x32_bf16 v[220:223], v[124:127], v[108:111], v[220:223]
    s_waitcnt lgkmcnt(3)
    v_mfma_f32_16x16x32_bf16 v[224:227], v[64:67], v[104:107], v[224:227]
    v_mfma_f32_16x16x32_bf16 v[232:235], v[64:67], v[108:111], v[232:235]
    s_waitcnt lgkmcnt(2)
    v_mfma_f32_16x16x32_bf16 v[228:231], v[68:71], v[104:107], v[228:231]
    v_mfma_f32_16x16x32_bf16 v[236:239], v[68:71], v[108:111], v[236:239]
    s_waitcnt lgkmcnt(1)
    v_mfma_f32_16x16x32_bf16 v[240:243], v[72:75], v[104:107], v[240:243]
    buffer_load_dwordx4 v4, s[20:23], s32 offen offset:0 nt lds
    v_mfma_f32_16x16x32_bf16 v[248:251], v[72:75], v[108:111], v[248:251]
    s_waitcnt lgkmcnt(0)
    v_mfma_f32_16x16x32_bf16 v[244:247], v[76:79], v[104:107], v[244:247]
    v_mfma_f32_16x16x32_bf16 v[252:255], v[76:79], v[108:111], v[252:255]
    s_add_u32 s28, s42, s35
    s_add_u32 s42, s42, 32768
    s_cmp_eq_u32 s42, 163840
    s_cselect_b32 s42, 0, s42
    v_add_u32 v13, s28, v5
    v_add_u32 v11, s42, v5
    v_add_u32 v14, s28, v6
    v_add_u32 v12, s42, v6
    s_add_u32 s42, s42, 32768
    s_cmp_eq_u32 s42, 163840
    s_cselect_b32 s42, 0, s42
    s_waitcnt vmcnt(4)
    s_barrier
    ds_read_b128 v[96:99], v13 offset:0
    ds_read_b128 v[80:83], v11 offset:0
    ds_read_b128 v[100:103], v13 offset:2048
    ds_read_b128 v[84:87], v11 offset:2048
    ds_read_b128 v[88:91], v11 offset:4096
    ds_read_b128 v[92:95], v11 offset:6144
    ds_read_b128 v[112:115], v11 offset:8192
    ds_read_b128 v[116:119], v11 offset:10240
    ds_read_b128 v[120:123], v11 offset:12288
    ds_read_b128 v[124:127], v11 offset:14336
    ds_read_b128 v[104:107], v14 offset:0
    s_waitcnt lgkmcnt(9)
    v_mfma_f32_16x16x32_bf16 v[128:131], v[80:83], v[96:99], v[128:131]
    s_waitcnt lgkmcnt(8)
    v_mfma_f32_16x16x32_bf16 v[136:139], v[80:83], v[100:103], v[136:139]
    ds_read_b128 v[64:67], v12 offset:0
    ds_read_b128 v[108:111], v14 offset:2048
    s_add_u32 s39, s32, 128
    s_mov_b32 m0, s40
    s_add_u32 s40, s40, 32768
    s_cmp_eq_u32 s40, s41
    s_cselect_b32 s40, s35, s40
    buffer_load_dwordx4 v1, s[20:23], s39 offen offset:0 nt lds
    s_add_u32 m0, m0, 1024
    s_waitcnt lgkmcnt(9)
    v_mfma_f32_16x16x32_bf16 v[132:135], v[84:87], v[96:99], v[132:135]
    v_mfma_f32_16x16x32_bf16 v[140:143], v[84:87], v[100:103], v[140:143]
    ds_read_b128 v[68:71], v12 offset:2048
    s_waitcnt lgkmcnt(9)
    v_mfma_f32_16x16x32_bf16 v[144:147], v[88:91], v[96:99], v[144:147]
    v_mfma_f32_16x16x32_bf16 v[152:155], v[88:91], v[100:103], v[152:155]
    ds_read_b128 v[72:75], v12 offset:4096
    s_waitcnt lgkmcnt(9)
    v_mfma_f32_16x16x32_bf16 v[148:151], v[92:95], v[96:99], v[148:151]
    v_mfma_f32_16x16x32_bf16 v[156:159], v[92:95], v[100:103], v[156:159]
    ds_read_b128 v[76:79], v12 offset:6144
    s_waitcnt lgkmcnt(9)
    v_mfma_f32_16x16x32_bf16 v[160:163], v[112:115], v[96:99], v[160:163]
    v_mfma_f32_16x16x32_bf16 v[168:171], v[112:115], v[100:103], v[168:171]
    ds_read_b128 v[80:83], v12 offset:8192
    s_waitcnt lgkmcnt(9)
    v_mfma_f32_16x16x32_bf16 v[164:167], v[116:119], v[96:99], v[164:167]
    v_mfma_f32_16x16x32_bf16 v[172:175], v[116:119], v[100:103], v[172:175]
    ds_read_b128 v[84:87], v12 offset:10240
    s_waitcnt lgkmcnt(9)
    v_mfma_f32_16x16x32_bf16 v[176:179], v[120:123], v[96:99], v[176:179]
    v_mfma_f32_16x16x32_bf16 v[184:187], v[120:123], v[100:103], v[184:187]
    ds_read_b128 v[88:91], v12 offset:12288
    s_waitcnt lgkmcnt(9)
    v_mfma_f32_16x16x32_bf16 v[180:183], v[124:127], v[96:99], v[180:183]
    v_mfma_f32_16x16x32_bf16 v[188:191], v[124:127], v[100:103], v[188:191]
    ds_read_b128 v[92:95], v12 offset:14336
    s_waitcnt lgkmcnt(8)
    v_mfma_f32_16x16x32_bf16 v[128:131], v[64:67], v[104:107], v[128:131]
    buffer_load_dwordx4 v2, s[20:23], s39 offen offset:0 nt lds
    s_add_u32 m0, m0, 1024
    s_waitcnt lgkmcnt(7)
    v_mfma_f32_16x16x32_bf16 v[136:139], v[64:67], v[108:111], v[136:139]
    ds_read_b128 v[112:115], v11 offset:16384
    s_waitcnt lgkmcnt(7)
    v_mfma_f32_16x16x32_bf16 v[132:135], v[68:71], v[104:107], v[132:135]
    v_mfma_f32_16x16x32_bf16 v[140:143], v[68:71], v[108:111], v[140:143]
    ds_read_b128 v[116:119], v12 offset:16384
    s_waitcnt lgkmcnt(7)
    v_mfma_f32_16x16x32_bf16 v[144:147], v[72:75], v[104:107], v[144:147]
    v_max_f32 v17, v128, v129
    v_mfma_f32_16x16x32_bf16 v[152:155], v[72:75], v[108:111], v[152:155]
    ds_read_b128 v[120:123], v11 offset:18432
    v_max3_f32 v17, v17, v130, v131
    s_waitcnt lgkmcnt(7)
    v_mfma_f32_16x16x32_bf16 v[148:151], v[76:79], v[104:107], v[148:151]
    v_max_f32 v18, v136, v137
    v_mfma_f32_16x16x32_bf16 v[156:159], v[76:79], v[108:111], v[156:159]
    ds_read_b128 v[124:127], v12 offset:18432
    v_max3_f32 v18, v18, v138, v139
    s_waitcnt lgkmcnt(7)
    v_mfma_f32_16x16x32_bf16 v[160:163], v[80:83], v[104:107], v[160:163]
    v_max3_f32 v17, v17, v132, v133
    v_mfma_f32_16x16x32_bf16 v[168:171], v[80:83], v[108:111], v[168:171]
    ds_read_b128 v[64:67], v11 offset:20480
    v_max3_f32 v17, v17, v134, v135
    s_waitcnt lgkmcnt(7)
    v_mfma_f32_16x16x32_bf16 v[164:167], v[84:87], v[104:107], v[164:167]
    v_max3_f32 v18, v18, v140, v141
    v_mfma_f32_16x16x32_bf16 v[172:175], v[84:87], v[108:111], v[172:175]
    ds_read_b128 v[68:71], v12 offset:20480
    v_max3_f32 v18, v18, v142, v143
    s_waitcnt lgkmcnt(7)
    v_mfma_f32_16x16x32_bf16 v[176:179], v[88:91], v[104:107], v[176:179]
    v_max3_f32 v17, v17, v144, v145
    v_mfma_f32_16x16x32_bf16 v[184:187], v[88:91], v[108:111], v[184:187]
    ds_read_b128 v[72:75], v11 offset:22528
    v_max3_f32 v17, v17, v146, v147
    s_waitcnt lgkmcnt(7)
    v_mfma_f32_16x16x32_bf16 v[180:183], v[92:95], v[104:107], v[180:183]
    v_max3_f32 v18, v18, v152, v153
    v_mfma_f32_16x16x32_bf16 v[188:191], v[92:95], v[108:111], v[188:191]
    ds_read_b128 v[76:79], v12 offset:22528
    v_max3_f32 v18, v18, v154, v155
    s_waitcnt lgkmcnt(7)
    v_mfma_f32_16x16x32_bf16 v[192:195], v[112:115], v[96:99], v[192:195]
    v_max3_f32 v17, v17, v148, v149
    buffer_load_dwordx4 v3, s[20:23], s39 offen offset:0 nt lds
    s_add_u32 m0, m0, 1024
    v_mfma_f32_16x16x32_bf16 v[200:203], v[112:115], v[100:103], v[200:203]
    ds_read_b128 v[80:83], v11 offset:24576
    v_max3_f32 v17, v17, v150, v151
    s_waitcnt lgkmcnt(7)
    v_mfma_f32_16x16x32_bf16 v[192:195], v[116:119], v[104:107], v[192:195]
    v_max3_f32 v18, v18, v156, v157
    v_mfma_f32_16x16x32_bf16 v[200:203], v[116:119], v[108:111], v[200:203]
    ds_read_b128 v[84:87], v12 offset:24576
    v_max3_f32 v18, v18, v158, v159
    s_waitcnt lgkmcnt(7)
    v_mfma_f32_16x16x32_bf16 v[196:199], v[120:123], v[96:99], v[196:199]
    v_max3_f32 v17, v17, v160, v161
    v_mfma_f32_16x16x32_bf16 v[204:207], v[120:123], v[100:103], v[204:207]
    ds_read_b128 v[88:91], v11 offset:26624
    v_max3_f32 v17, v17, v162, v163
    s_waitcnt lgkmcnt(7)
    v_mfma_f32_16x16x32_bf16 v[196:199], v[124:127], v[104:107], v[196:199]
    v_max3_f32 v18, v18, v168, v169
    v_mfma_f32_16x16x32_bf16 v[204:207], v[124:127], v[108:111], v[204:207]
    ds_read_b128 v[92:95], v12 offset:26624
    v_max3_f32 v18, v18, v170, v171
    v_max3_f32 v17, v17, v164, v165
    s_waitcnt lgkmcnt(7)
    v_mfma_f32_16x16x32_bf16 v[208:211], v[64:67], v[96:99], v[208:211]
    v_max3_f32 v17, v17, v166, v167
    v_mfma_f32_16x16x32_bf16 v[216:219], v[64:67], v[100:103], v[216:219]
    ds_read_b128 v[112:115], v11 offset:28672
    v_max3_f32 v18, v18, v172, v173
    s_waitcnt lgkmcnt(7)
    v_mfma_f32_16x16x32_bf16 v[208:211], v[68:71], v[104:107], v[208:211]
    v_max3_f32 v18, v18, v174, v175
    v_max3_f32 v17, v17, v176, v177
    v_mfma_f32_16x16x32_bf16 v[216:219], v[68:71], v[108:111], v[216:219]
    ds_read_b128 v[116:119], v12 offset:28672
    v_max3_f32 v17, v17, v178, v179
    v_max3_f32 v18, v18, v184, v185
    s_waitcnt lgkmcnt(7)
    v_mfma_f32_16x16x32_bf16 v[212:215], v[72:75], v[96:99], v[212:215]
    v_max3_f32 v18, v18, v186, v187
    v_mfma_f32_16x16x32_bf16 v[220:223], v[72:75], v[100:103], v[220:223]
    ds_read_b128 v[120:123], v11 offset:30720
    v_max3_f32 v17, v17, v180, v181
    s_waitcnt lgkmcnt(7)
    v_mfma_f32_16x16x32_bf16 v[212:215], v[76:79], v[104:107], v[212:215]
    v_max3_f32 v17, v17, v182, v183
    v_max3_f32 v18, v18, v188, v189
    v_mfma_f32_16x16x32_bf16 v[220:223], v[76:79], v[108:111], v[220:223]
    ds_read_b128 v[124:127], v12 offset:30720
    v_max3_f32 v18, v18, v190, v191
    v_max3_f32 v17, v17, v192, v193
    s_waitcnt lgkmcnt(7)
    v_mfma_f32_16x16x32_bf16 v[224:227], v[80:83], v[96:99], v[224:227]
    v_max3_f32 v17, v17, v194, v195
    v_max3_f32 v18, v18, v200, v201
    buffer_load_dwordx4 v4, s[20:23], s39 offen offset:0 nt lds
    v_mfma_f32_16x16x32_bf16 v[232:235], v[80:83], v[100:103], v[232:235]
    v_max3_f32 v18, v18, v202, v203
    s_waitcnt lgkmcnt(6)
    v_mfma_f32_16x16x32_bf16 v[224:227], v[84:87], v[104:107], v[224:227]
    v_max3_f32 v17, v17, v196, v197
    v_max3_f32 v17, v17, v198, v199
    v_mfma_f32_16x16x32_bf16 v[232:235], v[84:87], v[108:111], v[232:235]
    v_max3_f32 v18, v18, v204, v205
    v_max3_f32 v18, v18, v206, v207
    s_waitcnt lgkmcnt(5)
    v_mfma_f32_16x16x32_bf16 v[228:231], v[88:91], v[96:99], v[228:231]
    v_max3_f32 v17, v17, v208, v209
    v_mfma_f32_16x16x32_bf16 v[236:239], v[88:91], v[100:103], v[236:239]
    v_max3_f32 v17, v17, v210, v211
    s_waitcnt lgkmcnt(4)
    v_mfma_f32_16x16x32_bf16 v[228:231], v[92:95], v[104:107], v[228:231]
    v_max3_f32 v18, v18, v216, v217
    v_max3_f32 v18, v18, v218, v219
    v_mfma_f32_16x16x32_bf16 v[236:239], v[92:95], v[108:111], v[236:239]
    v_max3_f32 v17, v17, v212, v213
    v_max3_f32 v17, v17, v214, v215
    s_waitcnt lgkmcnt(3)
    v_mfma_f32_16x16x32_bf16 v[240:243], v[112:115], v[96:99], v[240:243]
    v_max3_f32 v18, v18, v220, v221
    v_max3_f32 v18, v18, v222, v223
    v_mfma_f32_16x16x32_bf16 v[248:251], v[112:115], v[100:103], v[248:251]
    v_max3_f32 v17, v17, v224, v225
    s_waitcnt lgkmcnt(2)
    v_mfma_f32_16x16x32_bf16 v[240:243], v[116:119], v[104:107], v[240:243]
    v_max3_f32 v17, v17, v226, v227
    v_max3_f32 v18, v18, v232, v233
    v_mfma_f32_16x16x32_bf16 v[248:251], v[116:119], v[108:111], v[248:251]
    v_max3_f32 v18, v18, v234, v235
    v_max3_f32 v17, v17, v228, v229
    s_waitcnt lgkmcnt(1)
    v_mfma_f32_16x16x32_bf16 v[244:247], v[120:123], v[96:99], v[244:247]
    v_max3_f32 v17, v17, v230, v231
    v_max3_f32 v18, v18, v236, v237
    v_mfma_f32_16x16x32_bf16 v[252:255], v[120:123], v[100:103], v[252:255]
    v_max3_f32 v18, v18, v238, v239
    s_waitcnt lgkmcnt(0)
    v_mfma_f32_16x16x32_bf16 v[244:247], v[124:127], v[104:107], v[244:247]
    v_max3_f32 v17, v17, v240, v241
    v_max3_f32 v17, v17, v242, v243
    v_mfma_f32_16x16x32_bf16 v[252:255], v[124:127], v[108:111], v[252:255]
    v_max3_f32 v18, v18, v248, v249
    v_max3_f32 v18, v18, v250, v251
    s_nop 2
    v_max3_f32 v17, v17, v244, v245
    v_max3_f32 v17, v17, v246, v247
    s_nop 0
    v_max3_f32 v18, v18, v252, v253
    v_max3_f32 v18, v18, v254, v255
    v_mov_b32 v25, v17
    s_nop 1
    v_permlane32_swap_b32 v17, v25
    v_max_f32 v17, v17, v25
    v_mov_b32 v25, v17
    s_nop 1
    v_permlane16_swap_b32 v17, v25
    v_max_f32 v17, v17, v25
    v_mul_f32 v17, s37, v17
    v_mov_b32 v25, v18
    s_nop 1
    v_permlane32_swap_b32 v18, v25
    v_max_f32 v18, v18, v25
    v_mov_b32 v25, v18
    s_nop 1
    v_permlane16_swap_b32 v18, v25
    v_max_f32 v18, v18, v25
    v_mul_f32 v18, s37, v18
    v_fma_f32 v128, v128, s37, -v17
    v_fma_f32 v129, v129, s37, -v17
    v_fma_f32 v130, v130, s37, -v17
    v_fma_f32 v131, v131, s37, -v17
    v_fma_f32 v132, v132, s37, -v17
    v_fma_f32 v133, v133, s37, -v17
    v_fma_f32 v134, v134, s37, -v17
    v_fma_f32 v135, v135, s37, -v17
    v_exp_f32 v128, v128
    v_exp_f32 v129, v129
    v_exp_f32 v130, v130
    v_exp_f32 v131, v131
    v_exp_f32 v132, v132
    v_exp_f32 v133, v133
    v_exp_f32 v134, v134
    v_exp_f32 v135, v135
    v_cvt_pk_bf16_f32 v128, v128, v129
    v_cvt_pk_bf16_f32 v129, v130, v131
    v_cvt_pk_bf16_f32 v130, v132, v133
    v_cvt_pk_bf16_f32 v131, v134, v135
    s_add_u32 s39, s32, 256
    s_mov_b32 m0, s40
    s_add_u32 s40, s40, 32768
    s_cmp_eq_u32 s40, s41
    s_cselect_b32 s40, s35, s40
    buffer_load_dwordx4 v1, s[20:23], s39 offen offset:0 nt lds
    s_add_u32 m0, m0, 1024
    v_fma_f32 v136, v136, s37, -v18
    v_fma_f32 v137, v137, s37, -v18
    v_fma_f32 v138, v138, s37, -v18
    v_fma_f32 v139, v139, s37, -v18
    v_fma_f32 v140, v140, s37, -v18
    v_fma_f32 v141, v141, s37, -v18
    v_fma_f32 v142, v142, s37, -v18
    v_fma_f32 v143, v143, s37, -v18
    v_exp_f32 v136, v136
    v_exp_f32 v137, v137
    v_exp_f32 v138, v138
    v_exp_f32 v139, v139
    v_exp_f32 v140, v140
    v_exp_f32 v141, v141
    v_exp_f32 v142, v142
    v_exp_f32 v143, v143
    v_cvt_pk_bf16_f32 v136, v136, v137
    v_cvt_pk_bf16_f32 v137, v138, v139
    v_cvt_pk_bf16_f32 v138, v140, v141
    v_cvt_pk_bf16_f32 v139, v142, v143
    v_fma_f32 v144, v144, s37, -v17
    v_fma_f32 v145, v145, s37, -v17
    v_fma_f32 v146, v146, s37, -v17
    v_fma_f32 v147, v147, s37, -v17
    v_fma_f32 v148, v148, s37, -v17
    v_fma_f32 v149, v149, s37, -v17
    v_fma_f32 v150, v150, s37, -v17
    v_fma_f32 v151, v151, s37, -v17
    v_exp_f32 v144, v144
    v_exp_f32 v145, v145
    v_exp_f32 v146, v146
    v_exp_f32 v147, v147
    v_exp_f32 v148, v148
    v_exp_f32 v149, v149
    v_exp_f32 v150, v150
    v_exp_f32 v151, v151
    v_cvt_pk_bf16_f32 v144, v144, v145
    v_cvt_pk_bf16_f32 v145, v146, v147
    v_cvt_pk_bf16_f32 v146, v148, v149
    v_cvt_pk_bf16_f32 v147, v150, v151
    v_fma_f32 v152, v152, s37, -v18
    v_fma_f32 v153, v153, s37, -v18
    v_fma_f32 v154, v154, s37, -v18
    v_fma_f32 v155, v155, s37, -v18
    v_fma_f32 v156, v156, s37, -v18
    v_fma_f32 v157, v157, s37, -v18
    v_fma_f32 v158, v158, s37, -v18
    v_fma_f32 v159, v159, s37, -v18
    v_exp_f32 v152, v152
    v_exp_f32 v153, v153
    v_exp_f32 v154, v154
    v_exp_f32 v155, v155
    v_exp_f32 v156, v156
    v_exp_f32 v157, v157
    v_exp_f32 v158, v158
    v_exp_f32 v159, v159
    v_cvt_pk_bf16_f32 v152, v152, v153
    v_cvt_pk_bf16_f32 v153, v154, v155
    v_cvt_pk_bf16_f32 v154, v156, v157
    v_cvt_pk_bf16_f32 v155, v158, v159
    buffer_load_dwordx4 v2, s[20:23], s39 offen offset:0 nt lds
    s_add_u32 m0, m0, 1024
    v_fma_f32 v160, v160, s37, -v17
    v_fma_f32 v161, v161, s37, -v17
    v_fma_f32 v162, v162, s37, -v17
    v_fma_f32 v163, v163, s37, -v17
    v_fma_f32 v164, v164, s37, -v17
    v_fma_f32 v165, v165, s37, -v17
    v_fma_f32 v166, v166, s37, -v17
    v_fma_f32 v167, v167, s37, -v17
    v_exp_f32 v160, v160
    v_exp_f32 v161, v161
    v_exp_f32 v162, v162
    v_exp_f32 v163, v163
    v_exp_f32 v164, v164
    v_exp_f32 v165, v165
    v_exp_f32 v166, v166
    v_exp_f32 v167, v167
    v_cvt_pk_bf16_f32 v160, v160, v161
    v_cvt_pk_bf16_f32 v161, v162, v163
    v_cvt_pk_bf16_f32 v162, v164, v165
    v_cvt_pk_bf16_f32 v163, v166, v167
    v_fma_f32 v168, v168, s37, -v18
    v_fma_f32 v169, v169, s37, -v18
    v_fma_f32 v170, v170, s37, -v18
    v_fma_f32 v171, v171, s37, -v18
    v_fma_f32 v172, v172, s37, -v18
    v_fma_f32 v173, v173, s37, -v18
    v_fma_f32 v174, v174, s37, -v18
    v_fma_f32 v175, v175, s37, -v18
    v_exp_f32 v168, v168
    v_exp_f32 v169, v169
    v_exp_f32 v170, v170
    v_exp_f32 v171, v171
    v_exp_f32 v172, v172
    v_exp_f32 v173, v173
    v_exp_f32 v174, v174
    v_exp_f32 v175, v175
    v_cvt_pk_bf16_f32 v168, v168, v169
    v_cvt_pk_bf16_f32 v169, v170, v171
    v_cvt_pk_bf16_f32 v170, v172, v173
    v_cvt_pk_bf16_f32 v171, v174, v175
    v_fma_f32 v176, v176, s37, -v17
    v_fma_f32 v177, v177, s37, -v17
    v_fma_f32 v178, v178, s37, -v17
    v_fma_f32 v179, v179, s37, -v17
    v_fma_f32 v180, v180, s37, -v17
    v_fma_f32 v181, v181, s37, -v17
    v_fma_f32 v182, v182, s37, -v17
    v_fma_f32 v183, v183, s37, -v17
    v_exp_f32 v176, v176
    v_exp_f32 v177, v177
    v_exp_f32 v178, v178
    v_exp_f32 v179, v179
    v_exp_f32 v180, v180
    v_exp_f32 v181, v181
    v_exp_f32 v182, v182
    v_exp_f32 v183, v183
    v_cvt_pk_bf16_f32 v176, v176, v177
    v_cvt_pk_bf16_f32 v177, v178, v179
    v_cvt_pk_bf16_f32 v178, v180, v181
    v_cvt_pk_bf16_f32 v179, v182, v183
    buffer_load_dwordx4 v3, s[20:23], s39 offen offset:0 nt lds
    s_add_u32 m0, m0, 1024
    v_fma_f32 v184, v184, s37, -v18
    v_fma_f32 v185, v185, s37, -v18
    v_fma_f32 v186, v186, s37, -v18
    v_fma_f32 v187, v187, s37, -v18
    v_fma_f32 v188, v188, s37, -v18
    v_fma_f32 v189, v189, s37, -v18
    v_fma_f32 v190, v190, s37, -v18
    v_fma_f32 v191, v191, s37, -v18
    v_exp_f32 v184, v184
    v_exp_f32 v185, v185
    v_exp_f32 v186, v186
    v_exp_f32 v187, v187
    v_exp_f32 v188, v188
    v_exp_f32 v189, v189
    v_exp_f32 v190, v190
    v_exp_f32 v191, v191
    v_cvt_pk_bf16_f32 v184, v184, v185
    v_cvt_pk_bf16_f32 v185, v186, v187
    v_cvt_pk_bf16_f32 v186, v188, v189
    v_cvt_pk_bf16_f32 v187, v190, v191
    v_fma_f32 v192, v192, s37, -v17
    v_fma_f32 v193, v193, s37, -v17
    v_fma_f32 v194, v194, s37, -v17
    v_fma_f32 v195, v195, s37, -v17
    v_fma_f32 v196, v196, s37, -v17
    v_fma_f32 v197, v197, s37, -v17
    v_fma_f32 v198, v198, s37, -v17
    v_fma_f32 v199, v199, s37, -v17
    v_exp_f32 v192, v192
    v_exp_f32 v193, v193
    v_exp_f32 v194, v194
    v_exp_f32 v195, v195
    v_exp_f32 v196, v196
    v_exp_f32 v197, v197
    v_exp_f32 v198, v198
    v_exp_f32 v199, v199
    v_cvt_pk_bf16_f32 v192, v192, v193
    v_cvt_pk_bf16_f32 v193, v194, v195
    v_cvt_pk_bf16_f32 v194, v196, v197
    v_cvt_pk_bf16_f32 v195, v198, v199
    v_fma_f32 v200, v200, s37, -v18
    v_fma_f32 v201, v201, s37, -v18
    v_fma_f32 v202, v202, s37, -v18
    v_fma_f32 v203, v203, s37, -v18
    v_fma_f32 v204, v204, s37, -v18
    v_fma_f32 v205, v205, s37, -v18
    v_fma_f32 v206, v206, s37, -v18
    v_fma_f32 v207, v207, s37, -v18
    v_exp_f32 v200, v200
    v_exp_f32 v201, v201
    v_exp_f32 v202, v202
    v_exp_f32 v203, v203
    v_exp_f32 v204, v204
    v_exp_f32 v205, v205
    v_exp_f32 v206, v206
    v_exp_f32 v207, v207
    v_cvt_pk_bf16_f32 v200, v200, v201
    v_cvt_pk_bf16_f32 v201, v202, v203
    v_cvt_pk_bf16_f32 v202, v204, v205
    v_cvt_pk_bf16_f32 v203, v206, v207
    buffer_load_dwordx4 v4, s[20:23], s39 offen offset:0 nt lds
    v_add_u32 v11, s42, v7
    v_add_u32 v12, s42, v8
    v_add_u32 v13, s42, v9
    v_add_u32 v14, s42, v10
    s_add_u32 s42, s42, 32768
    s_cmp_eq_u32 s42, 163840
    s_cselect_b32 s42, 0, s42
    s_waitcnt vmcnt(8)
    s_barrier
    ds_read_b64_tr_b16 v[96:97], v11 offset:0
    ds_read_b64_tr_b16 v[98:99], v11 offset:2048
    ds_read_b64_tr_b16 v[100:101], v12 offset:0
    ds_read_b64_tr_b16 v[102:103], v12 offset:2048
    ds_read_b64_tr_b16 v[104:105], v13 offset:0
    ds_read_b64_tr_b16 v[106:107], v13 offset:2048
    ds_read_b64_tr_b16 v[108:109], v14 offset:0
    ds_read_b64_tr_b16 v[110:111], v14 offset:2048
    ds_read_b64_tr_b16 v[112:113], v11 offset:4096
    ds_read_b64_tr_b16 v[114:115], v11 offset:6144
    ds_read_b64_tr_b16 v[116:117], v12 offset:4096
    ds_read_b64_tr_b16 v[118:119], v12 offset:6144
    v_fma_f32 v208, v208, s37, -v17
    v_fma_f32 v209, v209, s37, -v17
    v_fma_f32 v210, v210, s37, -v17
    v_fma_f32 v211, v211, s37, -v17
    v_fma_f32 v212, v212, s37, -v17
    v_fma_f32 v213, v213, s37, -v17
    v_fma_f32 v214, v214, s37, -v17
    v_fma_f32 v215, v215, s37, -v17
    v_exp_f32 v208, v208
    v_exp_f32 v209, v209
    v_exp_f32 v210, v210
    v_exp_f32 v211, v211
    v_exp_f32 v212, v212
    v_exp_f32 v213, v213
    v_exp_f32 v214, v214
    v_exp_f32 v215, v215
    v_cvt_pk_bf16_f32 v208, v208, v209
    v_cvt_pk_bf16_f32 v209, v210, v211
    v_cvt_pk_bf16_f32 v210, v212, v213
    v_cvt_pk_bf16_f32 v211, v214, v215
    v_fma_f32 v216, v216, s37, -v18
    v_fma_f32 v217, v217, s37, -v18
    v_fma_f32 v218, v218, s37, -v18
    v_fma_f32 v219, v219, s37, -v18
    v_fma_f32 v220, v220, s37, -v18
    v_fma_f32 v221, v221, s37, -v18
    v_fma_f32 v222, v222, s37, -v18
    v_fma_f32 v223, v223, s37, -v18
    v_exp_f32 v216, v216
    v_exp_f32 v217, v217
    v_exp_f32 v218, v218
    v_exp_f32 v219, v219
    v_exp_f32 v220, v220
    v_exp_f32 v221, v221
    v_exp_f32 v222, v222
    v_exp_f32 v223, v223
    v_cvt_pk_bf16_f32 v216, v216, v217
    v_cvt_pk_bf16_f32 v217, v218, v219
    v_cvt_pk_bf16_f32 v218, v220, v221
    v_cvt_pk_bf16_f32 v219, v222, v223
    s_waitcnt lgkmcnt(10)
    v_mfma_f32_16x16x32_bf16 v[32:35], v[96:99], v[128:131], 0
    v_fma_f32 v224, v224, s37, -v17
    v_fma_f32 v225, v225, s37, -v17
    v_mfma_f32_16x16x32_bf16 v[36:39], v[96:99], v[136:139], 0
    ds_read_b64_tr_b16 v[120:121], v13 offset:4096
    ds_read_b64_tr_b16 v[122:123], v13 offset:6144
    s_mov_b32 m0, s40
    s_add_u32 s40, s40, 32768
    s_cmp_eq_u32 s40, s41
    s_cselect_b32 s40, s35, s40
    buffer_load_dwordx4 v1, s[12:15], s33 offen offset:0 nt lds
    s_add_u32 m0, m0, 1024
    v_fma_f32 v226, v226, s37, -v17
    s_waitcnt lgkmcnt(10)
    v_mfma_f32_16x16x32_bf16 v[40:43], v[100:103], v[128:131], 0
    v_fma_f32 v227, v227, s37, -v17
    v_fma_f32 v228, v228, s37, -v17
    v_mfma_f32_16x16x32_bf16 v[44:47], v[100:103], v[136:139], 0
    v_mfma_f32_16x16x32_bf16 v[132:135], v[26:29], v[128:131], 0
    ds_read_b64_tr_b16 v[124:125], v14 offset:4096
    ds_read_b64_tr_b16 v[126:127], v14 offset:6144
    v_fma_f32 v229, v229, s37, -v17
    s_waitcnt lgkmcnt(10)
    v_mfma_f32_16x16x32_bf16 v[48:51], v[104:107], v[128:131], 0
    v_fma_f32 v230, v230, s37, -v17
    v_fma_f32 v231, v231, s37, -v17
    v_mfma_f32_16x16x32_bf16 v[52:55], v[104:107], v[136:139], 0
    ds_read_b64_tr_b16 v[96:97], v11 offset:8192
    ds_read_b64_tr_b16 v[98:99], v11 offset:10240
    v_exp_f32 v224, v224
    s_waitcnt lgkmcnt(10)
    v_mfma_f32_16x16x32_bf16 v[56:59], v[108:111], v[128:131], 0
    v_exp_f32 v225, v225
    v_mfma_f32_16x16x32_bf16 v[60:63], v[108:111], v[136:139], 0
    v_mfma_f32_16x16x32_bf16 v[140:143], v[26:29], v[136:139], 0
    ds_read_b64_tr_b16 v[100:101], v12 offset:8192
    ds_read_b64_tr_b16 v[102:103], v12 offset:10240
    v_exp_f32 v226, v226
    v_exp_f32 v227, v227
    s_waitcnt lgkmcnt(10)
    v_mfma_f32_16x16x32_bf16 v[32:35], v[112:115], v[144:147], v[32:35]
    v_exp_f32 v228, v228
    v_mfma_f32_16x16x32_bf16 v[36:39], v[112:115], v[152:155], v[36:39]
    ds_read_b64_tr_b16 v[104:105], v13 offset:8192
    ds_read_b64_tr_b16 v[106:107], v13 offset:10240
    buffer_load_dwordx4 v2, s[12:15], s33 offen offset:0 nt lds
    s_add_u32 m0, m0, 1024
    v_exp_f32 v229, v229
    v_exp_f32 v230, v230
    s_waitcnt lgkmcnt(10)
    v_mfma_f32_16x16x32_bf16 v[40:43], v[116:119], v[144:147], v[40:43]
    v_exp_f32 v231, v231
    v_mfma_f32_16x16x32_bf16 v[44:47], v[116:119], v[152:155], v[44:47]
    v_mfma_f32_16x16x32_bf16 v[132:135], v[26:29], v[144:147], v[132:135]
    ds_read_b64_tr_b16 v[108:109], v14 offset:8192
    ds_read_b64_tr_b16 v[110:111], v14 offset:10240
    v_cvt_pk_bf16_f32 v224, v224, v225
    v_cvt_pk_bf16_f32 v225, v226, v227
    s_waitcnt lgkmcnt(10)
    v_mfma_f32_16x16x32_bf16 v[48:51], v[120:123], v[144:147], v[48:51]
    v_cvt_pk_bf16_f32 v226, v228, v229
    v_mfma_f32_16x16x32_bf16 v[52:55], v[120:123], v[152:155], v[52:55]
    ds_read_b64_tr_b16 v[112:113], v11 offset:12288
    ds_read_b64_tr_b16 v[114:115], v11 offset:14336
    v_cvt_pk_bf16_f32 v227, v230, v231
    s_waitcnt lgkmcnt(10)
    v_mfma_f32_16x16x32_bf16 v[56:59], v[124:127], v[144:147], v[56:59]
    v_fma_f32 v232, v232, s37, -v18
    v_fma_f32 v233, v233, s37, -v18
    v_mfma_f32_16x16x32_bf16 v[60:63], v[124:127], v[152:155], v[60:63]
    v_mfma_f32_16x16x32_bf16 v[140:143], v[26:29], v[152:155], v[140:143]
    ds_read_b64_tr_b16 v[116:117], v12 offset:12288
    ds_read_b64_tr_b16 v[118:119], v12 offset:14336
    v_fma_f32 v234, v234, s37, -v18
    s_waitcnt lgkmcnt(10)
    v_mfma_f32_16x16x32_bf16 v[32:35], v[96:99], v[160:163], v[32:35]
    v_fma_f32 v235, v235, s37, -v18
    v_fma_f32 v236, v236, s37, -v18
    v_mfma_f32_16x16x32_bf16 v[36:39], v[96:99], v[168:171], v[36:39]
    ds_read_b64_tr_b16 v[120:121], v13 offset:12288
    ds_read_b64_tr_b16 v[122:123], v13 offset:14336
    buffer_load_dwordx4 v3, s[12:15], s33 offen offset:0 nt lds
    s_add_u32 m0, m0, 1024
    v_fma_f32 v237, v237, s37, -v18
    s_waitcnt lgkmcnt(10)
    v_mfma_f32_16x16x32_bf16 v[40:43], v[100:103], v[160:163], v[40:43]
    v_fma_f32 v238, v238, s37, -v18
    v_fma_f32 v239, v239, s37, -v18
    v_mfma_f32_16x16x32_bf16 v[44:47], v[100:103], v[168:171], v[44:47]
    v_mfma_f32_16x16x32_bf16 v[132:135], v[26:29], v[160:163], v[132:135]
    ds_read_b64_tr_b16 v[124:125], v14 offset:12288
    ds_read_b64_tr_b16 v[126:127], v14 offset:14336
    v_exp_f32 v232, v232
    s_waitcnt lgkmcnt(10)
    v_mfma_f32_16x16x32_bf16 v[48:51], v[104:107], v[160:163], v[48:51]
    v_exp_f32 v233, v233
    v_mfma_f32_16x16x32_bf16 v[52:55], v[104:107], v[168:171], v[52:55]
    ds_read_b64_tr_b16 v[96:97], v11 offset:16384
    ds_read_b64_tr_b16 v[98:99], v11 offset:18432
    v_exp_f32 v234, v234
    v_exp_f32 v235, v235
    s_waitcnt lgkmcnt(10)
    v_mfma_f32_16x16x32_bf16 v[56:59], v[108:111], v[160:163], v[56:59]
    v_exp_f32 v236, v236
    v_mfma_f32_16x16x32_bf16 v[60:63], v[108:111], v[168:171], v[60:63]
    v_mfma_f32_16x16x32_bf16 v[140:143], v[26:29], v[168:171], v[140:143]
    ds_read_b64_tr_b16 v[100:101], v12 offset:16384
    ds_read_b64_tr_b16 v[102:103], v12 offset:18432
    v_exp_f32 v237, v237
    v_exp_f32 v238, v238
    s_waitcnt lgkmcnt(10)
    v_mfma_f32_16x16x32_bf16 v[32:35], v[112:115], v[176:179], v[32:35]
    v_exp_f32 v239, v239
    v_mfma_f32_16x16x32_bf16 v[36:39], v[112:115], v[184:187], v[36:39]
    ds_read_b64_tr_b16 v[104:105], v13 offset:16384
    ds_read_b64_tr_b16 v[106:107], v13 offset:18432
    v_cvt_pk_bf16_f32 v232, v232, v233
    v_cvt_pk_bf16_f32 v233, v234, v235
    s_waitcnt lgkmcnt(10)
    v_mfma_f32_16x16x32_bf16 v[40:43], v[116:119], v[176:179], v[40:43]
    buffer_load_dwordx4 v4, s[12:15], s33 offen offset:0 nt lds
    v_cvt_pk_bf16_f32 v234, v236, v237
    v_mfma_f32_16x16x32_bf16 v[44:47], v[116:119], v[184:187], v[44:47]
    v_mfma_f32_16x16x32_bf16 v[132:135], v[26:29], v[176:179], v[132:135]
    ds_read_b64_tr_b16 v[108:109], v14 offset:16384
    ds_read_b64_tr_b16 v[110:111], v14 offset:18432
    v_cvt_pk_bf16_f32 v235, v238, v239
    s_waitcnt lgkmcnt(10)
    v_mfma_f32_16x16x32_bf16 v[48:51], v[120:123], v[176:179], v[48:51]
    v_fma_f32 v240, v240, s37, -v17
    v_fma_f32 v241, v241, s37, -v17
    v_mfma_f32_16x16x32_bf16 v[52:55], v[120:123], v[184:187], v[52:55]
    ds_read_b64_tr_b16 v[112:113], v11 offset:20480
    ds_read_b64_tr_b16 v[114:115], v11 offset:22528
    v_fma_f32 v242, v242, s37, -v17
    s_waitcnt lgkmcnt(10)
    v_mfma_f32_16x16x32_bf16 v[56:59], v[124:127], v[176:179], v[56:59]
    v_fma_f32 v243, v243, s37, -v17
    v_fma_f32 v244, v244, s37, -v17
    v_mfma_f32_16x16x32_bf16 v[60:63], v[124:127], v[184:187], v[60:63]
    v_mfma_f32_16x16x32_bf16 v[140:143], v[26:29], v[184:187], v[140:143]
    ds_read_b64_tr_b16 v[116:117], v12 offset:20480
    ds_read_b64_tr_b16 v[118:119], v12 offset:22528
    v_fma_f32 v245, v245, s37, -v17
    s_waitcnt lgkmcnt(10)
    v_mfma_f32_16x16x32_bf16 v[32:35], v[96:99], v[192:195], v[32:35]
    v_fma_f32 v246, v246, s37, -v17
    v_fma_f32 v247, v247, s37, -v17
    v_mfma_f32_16x16x32_bf16 v[36:39], v[96:99], v[200:203], v[36:39]
    ds_read_b64_tr_b16 v[120:121], v13 offset:20480
    ds_read_b64_tr_b16 v[122:123], v13 offset:22528
    v_exp_f32 v240, v240
    s_waitcnt lgkmcnt(10)
    v_mfma_f32_16x16x32_bf16 v[40:43], v[100:103], v[192:195], v[40:43]
    s_mov_b32 m0, s40
    s_add_u32 s40, s40, 32768
    s_cmp_eq_u32 s40, s41
    s_cselect_b32 s40, s35, s40
    buffer_load_dwordx4 v1, s[16:19], s33 offen offset:0 nt lds
    s_add_u32 m0, m0, 1024
    v_exp_f32 v241, v241
    v_mfma_f32_16x16x32_bf16 v[44:47], v[100:103], v[200:203], v[44:47]
    v_mfma_f32_16x16x32_bf16 v[132:135], v[26:29], v[192:195], v[132:135]
    ds_read_b64_tr_b16 v[124:125], v14 offset:20480
    ds_read_b64_tr_b16 v[126:127], v14 offset:22528
    v_exp_f32 v242, v242
    v_exp_f32 v243, v243
    s_waitcnt lgkmcnt(10)
    v_mfma_f32_16x16x32_bf16 v[48:51], v[104:107], v[192:195], v[48:51]
    v_exp_f32 v244, v244
    v_mfma_f32_16x16x32_bf16 v[52:55], v[104:107], v[200:203], v[52:55]
    ds_read_b64_tr_b16 v[96:97], v11 offset:24576
    ds_read_b64_tr_b16 v[98:99], v11 offset:26624
    v_exp_f32 v245, v245
    v_exp_f32 v246, v246
    s_waitcnt lgkmcnt(10)
    v_mfma_f32_16x16x32_bf16 v[56:59], v[108:111], v[192:195], v[56:59]
    v_exp_f32 v247, v247
    v_mfma_f32_16x16x32_bf16 v[60:63], v[108:111], v[200:203], v[60:63]
    v_mfma_f32_16x16x32_bf16 v[140:143], v[26:29], v[200:203], v[140:143]
    ds_read_b64_tr_b16 v[100:101], v12 offset:24576
    ds_read_b64_tr_b16 v[102:103], v12 offset:26624
    v_cvt_pk_bf16_f32 v240, v240, v241
    v_cvt_pk_bf16_f32 v241, v242, v243
    s_waitcnt lgkmcnt(10)
    v_mfma_f32_16x16x32_bf16 v[32:35], v[112:115], v[208:211], v[32:35]
    v_cvt_pk_bf16_f32 v242, v244, v245
    v_mfma_f32_16x16x32_bf16 v[36:39], v[112:115], v[216:219], v[36:39]
    ds_read_b64_tr_b16 v[104:105], v13 offset:24576
    ds_read_b64_tr_b16 v[106:107], v13 offset:26624
    v_cvt_pk_bf16_f32 v243, v246, v247
    s_waitcnt lgkmcnt(10)
    v_mfma_f32_16x16x32_bf16 v[40:43], v[116:119], v[208:211], v[40:43]
    v_fma_f32 v248, v248, s37, -v18
    v_fma_f32 v249, v249, s37, -v18
    v_mfma_f32_16x16x32_bf16 v[44:47], v[116:119], v[216:219], v[44:47]
    v_mfma_f32_16x16x32_bf16 v[132:135], v[26:29], v[208:211], v[132:135]
    ds_read_b64_tr_b16 v[108:109], v14 offset:24576
    ds_read_b64_tr_b16 v[110:111], v14 offset:26624
    buffer_load_dwordx4 v2, s[16:19], s33 offen offset:0 nt lds
    s_add_u32 m0, m0, 1024
    v_fma_f32 v250, v250, s37, -v18
    s_waitcnt lgkmcnt(10)
    v_mfma_f32_16x16x32_bf16 v[48:51], v[120:123], v[208:211], v[48:51]
    v_fma_f32 v251, v251, s37, -v18
    v_fma_f32 v252, v252, s37, -v18
    v_mfma_f32_16x16x32_bf16 v[52:55], v[120:123], v[216:219], v[52:55]
    ds_read_b64_tr_b16 v[112:113], v11 offset:28672
    ds_read_b64_tr_b16 v[114:115], v11 offset:30720
    v_fma_f32 v253, v253, s37, -v18
    s_waitcnt lgkmcnt(10)
    v_mfma_f32_16x16x32_bf16 v[56:59], v[124:127], v[208:211], v[56:59]
    v_fma_f32 v254, v254, s37, -v18
    v_fma_f32 v255, v255, s37, -v18
    v_mfma_f32_16x16x32_bf16 v[60:63], v[124:127], v[216:219], v[60:63]
    v_mfma_f32_16x16x32_bf16 v[140:143], v[26:29], v[216:219], v[140:143]
    ds_read_b64_tr_b16 v[116:117], v12 offset:28672
    ds_read_b64_tr_b16 v[118:119], v12 offset:30720
    v_exp_f32 v248, v248
    s_waitcnt lgkmcnt(10)
    v_mfma_f32_16x16x32_bf16 v[32:35], v[96:99], v[224:227], v[32:35]
    v_exp_f32 v249, v249
    v_mfma_f32_16x16x32_bf16 v[36:39], v[96:99], v[232:235], v[36:39]
    ds_read_b64_tr_b16 v[120:121], v13 offset:28672
    ds_read_b64_tr_b16 v[122:123], v13 offset:30720
    v_exp_f32 v250, v250
    v_exp_f32 v251, v251
    s_waitcnt lgkmcnt(10)
    v_mfma_f32_16x16x32_bf16 v[40:43], v[100:103], v[224:227], v[40:43]
    v_exp_f32 v252, v252
    v_mfma_f32_16x16x32_bf16 v[44:47], v[100:103], v[232:235], v[44:47]
    v_mfma_f32_16x16x32_bf16 v[132:135], v[26:29], v[224:227], v[132:135]
    ds_read_b64_tr_b16 v[124:125], v14 offset:28672
    ds_read_b64_tr_b16 v[126:127], v14 offset:30720
    buffer_load_dwordx4 v3, s[16:19], s33 offen offset:0 nt lds
    s_add_u32 m0, m0, 1024
    v_exp_f32 v253, v253
    v_exp_f32 v254, v254
    s_waitcnt lgkmcnt(10)
    v_mfma_f32_16x16x32_bf16 v[48:51], v[104:107], v[224:227], v[48:51]
    v_exp_f32 v255, v255
    v_mfma_f32_16x16x32_bf16 v[52:55], v[104:107], v[232:235], v[52:55]
    v_cvt_pk_bf16_f32 v248, v248, v249
    v_cvt_pk_bf16_f32 v249, v250, v251
    s_waitcnt lgkmcnt(8)
    v_mfma_f32_16x16x32_bf16 v[56:59], v[108:111], v[224:227], v[56:59]
    v_cvt_pk_bf16_f32 v250, v252, v253
    v_mfma_f32_16x16x32_bf16 v[60:63], v[108:111], v[232:235], v[60:63]
    v_mfma_f32_16x16x32_bf16 v[140:143], v[26:29], v[232:235], v[140:143]
    v_cvt_pk_bf16_f32 v251, v254, v255
    s_waitcnt lgkmcnt(6)
    v_mfma_f32_16x16x32_bf16 v[32:35], v[112:115], v[240:243], v[32:35]
    v_mfma_f32_16x16x32_bf16 v[36:39], v[112:115], v[248:251], v[36:39]
    s_waitcnt lgkmcnt(4)
    v_mfma_f32_16x16x32_bf16 v[40:43], v[116:119], v[240:243], v[40:43]
    v_mfma_f32_16x16x32_bf16 v[44:47], v[116:119], v[248:251], v[44:47]
    v_mfma_f32_16x16x32_bf16 v[132:135], v[26:29], v[240:243], v[132:135]
    s_waitcnt lgkmcnt(2)
    v_mfma_f32_16x16x32_bf16 v[48:51], v[120:123], v[240:243], v[48:51]
    buffer_load_dwordx4 v4, s[16:19], s33 offen offset:0 nt lds
    v_mfma_f32_16x16x32_bf16 v[52:55], v[120:123], v[248:251], v[52:55]
    s_waitcnt lgkmcnt(0)
    v_mfma_f32_16x16x32_bf16 v[56:59], v[124:127], v[240:243], v[56:59]
    v_mfma_f32_16x16x32_bf16 v[60:63], v[124:127], v[248:251], v[60:63]
    v_mfma_f32_16x16x32_bf16 v[140:143], v[26:29], v[248:251], v[140:143]
    v_add_u32 v11, s42, v7
    v_add_u32 v12, s42, v8
    v_add_u32 v13, s42, v9
    v_add_u32 v14, s42, v10
    s_add_u32 s42, s42, 32768
    s_cmp_eq_u32 s42, 163840
    s_cselect_b32 s42, 0, s42
    s_waitcnt vmcnt(12)
    s_barrier
    ds_read_b64_tr_b16 v[96:97], v11 offset:0
    ds_read_b64_tr_b16 v[98:99], v11 offset:2048
    ds_read_b64_tr_b16 v[100:101], v12 offset:0
    ds_read_b64_tr_b16 v[102:103], v12 offset:2048
    ds_read_b64_tr_b16 v[104:105], v13 offset:0
    ds_read_b64_tr_b16 v[106:107], v13 offset:2048
    ds_read_b64_tr_b16 v[108:109], v14 offset:0
    ds_read_b64_tr_b16 v[110:111], v14 offset:2048
    ds_read_b64_tr_b16 v[112:113], v11 offset:4096
    ds_read_b64_tr_b16 v[114:115], v11 offset:6144
    ds_read_b64_tr_b16 v[116:117], v12 offset:4096
    ds_read_b64_tr_b16 v[118:119], v12 offset:6144
    v_rcp_f32 v19, v132
    v_rcp_f32 v20, v140
    s_waitcnt lgkmcnt(10)
    v_mfma_f32_16x16x32_bf16 v[64:67], v[96:99], v[128:131], 0
    v_add_u32 v21, s40, v15
    v_add_u32 v25, s40, v16
    v_xor_b32 v22, 32, v21
    v_xor_b32 v23, 64, v21
    v_xor_b32 v24, 96, v21
    v_mfma_f32_16x16x32_bf16 v[68:71], v[96:99], v[136:139], 0
    ds_read_b64_tr_b16 v[120:121], v13 offset:4096
    ds_read_b64_tr_b16 v[122:123], v13 offset:6144
    v_mul_f32 v32, v32, v19
    v_mul_f32 v33, v33, v19
    v_mul_f32 v34, v34, v19
    v_mul_f32 v35, v35, v19
    v_cvt_pk_bf16_f32 v32, v32, v33
    s_waitcnt lgkmcnt(10)
    v_mfma_f32_16x16x32_bf16 v[72:75], v[100:103], v[128:131], 0
    v_cvt_pk_bf16_f32 v33, v34, v35
    ds_write_b64 v21, v[32:33] offset:0
    v_mul_f32 v36, v36, v20
    v_mul_f32 v37, v37, v20
    v_mul_f32 v38, v38, v20
    v_mfma_f32_16x16x32_bf16 v[76:79], v[100:103], v[136:139], 0
    ds_read_b64_tr_b16 v[124:125], v14 offset:4096
    ds_read_b64_tr_b16 v[126:127], v14 offset:6144
    v_mul_f32 v39, v39, v20
    v_cvt_pk_bf16_f32 v36, v36, v37
    v_cvt_pk_bf16_f32 v37, v38, v39
    ds_write_b64 v21, v[36:37] offset:2048
    v_mul_f32 v40, v40, v19
    s_waitcnt lgkmcnt(12)
    v_mfma_f32_16x16x32_bf16 v[80:83], v[104:107], v[128:131], 0
    v_mul_f32 v41, v41, v19
    v_mul_f32 v42, v42, v19
    v_mul_f32 v43, v43, v19
    v_cvt_pk_bf16_f32 v40, v40, v41
    v_cvt_pk_bf16_f32 v41, v42, v43
    v_mfma_f32_16x16x32_bf16 v[84:87], v[104:107], v[136:139], 0
    ds_read_b64_tr_b16 v[96:97], v11 offset:8192
    ds_read_b64_tr_b16 v[98:99], v11 offset:10240
    ds_write_b64 v22, v[40:41] offset:0
    v_mul_f32 v44, v44, v20
    v_mul_f32 v45, v45, v20
    v_mul_f32 v46, v46, v20
    v_mul_f32 v47, v47, v20
    s_waitcnt lgkmcnt(13)
    v_mfma_f32_16x16x32_bf16 v[88:91], v[108:111], v[128:131], 0
    v_cvt_pk_bf16_f32 v44, v44, v45
    v_cvt_pk_bf16_f32 v45, v46, v47
    ds_write_b64 v22, v[44:45] offset:2048
    v_mul_f32 v48, v48, v19
    v_mul_f32 v49, v49, v19
    v_mfma_f32_16x16x32_bf16 v[92:95], v[108:111], v[136:139], 0
    ds_read_b64_tr_b16 v[100:101], v12 offset:8192
    s_waitcnt lgkmcnt(14)
    ds_read_b64_tr_b16 v[102:103], v12 offset:10240
    v_mul_f32 v50, v50, v19
    v_mul_f32 v51, v51, v19
    v_cvt_pk_bf16_f32 v48, v48, v49
    v_cvt_pk_bf16_f32 v49, v50, v51
    s_waitcnt lgkmcnt(14)
    ds_write_b64 v23, v[48:49] offset:0
    v_mfma_f32_16x16x32_bf16 v[64:67], v[112:115], v[144:147], v[64:67]
    v_mul_f32 v52, v52, v20
    v_mul_f32 v53, v53, v20
    v_mul_f32 v54, v54, v20
    v_mul_f32 v55, v55, v20
    v_cvt_pk_bf16_f32 v52, v52, v53
    v_mfma_f32_16x16x32_bf16 v[68:71], v[112:115], v[152:155], v[68:71]
    s_waitcnt lgkmcnt(14)
    ds_read_b64_tr_b16 v[104:105], v13 offset:8192
    s_waitcnt lgkmcnt(14)
    ds_read_b64_tr_b16 v[106:107], v13 offset:10240
    v_cvt_pk_bf16_f32 v53, v54, v55
    s_waitcnt lgkmcnt(14)
    ds_write_b64 v23, v[52:53] offset:2048
    v_mul_f32 v56, v56, v19
    v_mul_f32 v57, v57, v19
    v_mul_f32 v58, v58, v19
    v_mfma_f32_16x16x32_bf16 v[72:75], v[116:119], v[144:147], v[72:75]
    v_mul_f32 v59, v59, v19
    v_cvt_pk_bf16_f32 v56, v56, v57
    v_cvt_pk_bf16_f32 v57, v58, v59
    s_waitcnt lgkmcnt(14)
    ds_write_b64 v24, v[56:57] offset:0
    v_mul_f32 v60, v60, v20
    v_mfma_f32_16x16x32_bf16 v[76:79], v[116:119], v[152:155], v[76:79]
    s_waitcnt lgkmcnt(14)
    ds_read_b64_tr_b16 v[108:109], v14 offset:8192
    s_waitcnt lgkmcnt(14)
    ds_read_b64_tr_b16 v[110:111], v14 offset:10240
    v_mul_f32 v61, v61, v20
    v_mul_f32 v62, v62, v20
    v_mul_f32 v63, v63, v20
    v_cvt_pk_bf16_f32 v60, v60, v61
    v_cvt_pk_bf16_f32 v61, v62, v63
    v_mfma_f32_16x16x32_bf16 v[80:83], v[120:123], v[144:147], v[80:83]
    s_waitcnt lgkmcnt(14)
    ds_write_b64 v24, v[60:61] offset:2048
    v_mfma_f32_16x16x32_bf16 v[84:87], v[120:123], v[152:155], v[84:87]
    s_waitcnt lgkmcnt(14)
    ds_read_b64_tr_b16 v[112:113], v11 offset:12288
    s_waitcnt lgkmcnt(14)
    ds_read_b64_tr_b16 v[114:115], v11 offset:14336
    s_waitcnt lgkmcnt(14)
    ds_read_b128 v[48:51], v25 offset:0
    s_waitcnt lgkmcnt(14)
    ds_read_b128 v[52:55], v25 offset:1024
    s_waitcnt lgkmcnt(14)
    ds_read_b128 v[56:59], v25 offset:2048
    s_waitcnt lgkmcnt(14)
    ds_read_b128 v[60:63], v25 offset:3072
    v_mfma_f32_16x16x32_bf16 v[88:91], v[124:127], v[144:147], v[88:91]
    v_mfma_f32_16x16x32_bf16 v[92:95], v[124:127], v[152:155], v[92:95]
    s_waitcnt lgkmcnt(14)
    ds_read_b64_tr_b16 v[116:117], v12 offset:12288
    s_waitcnt lgkmcnt(14)
    ds_read_b64_tr_b16 v[118:119], v12 offset:14336
    v_mfma_f32_16x16x32_bf16 v[64:67], v[96:99], v[160:163], v[64:67]
    s_waitcnt lgkmcnt(5)
    buffer_store_dwordx4 v[48:51], v1, s[24:27], s32 offen offset:0 sc1
    v_mfma_f32_16x16x32_bf16 v[68:71], v[96:99], v[168:171], v[68:71]
    ds_read_b64_tr_b16 v[120:121], v13 offset:12288
    ds_read_b64_tr_b16 v[122:123], v13 offset:14336
    v_mfma_f32_16x16x32_bf16 v[72:75], v[100:103], v[160:163], v[72:75]
    v_mfma_f32_16x16x32_bf16 v[76:79], v[100:103], v[168:171], v[76:79]
    ds_read_b64_tr_b16 v[124:125], v14 offset:12288
    ds_read_b64_tr_b16 v[126:127], v14 offset:14336
    v_mfma_f32_16x16x32_bf16 v[80:83], v[104:107], v[160:163], v[80:83]
    v_mfma_f32_16x16x32_bf16 v[84:87], v[104:107], v[168:171], v[84:87]
    ds_read_b64_tr_b16 v[96:97], v11 offset:16384
    ds_read_b64_tr_b16 v[98:99], v11 offset:18432
    v_mfma_f32_16x16x32_bf16 v[88:91], v[108:111], v[160:163], v[88:91]
    s_waitcnt lgkmcnt(10)
    buffer_store_dwordx4 v[52:55], v2, s[24:27], s32 offen offset:0 sc1
    v_mfma_f32_16x16x32_bf16 v[92:95], v[108:111], v[168:171], v[92:95]
    ds_read_b64_tr_b16 v[100:101], v12 offset:16384
    ds_read_b64_tr_b16 v[102:103], v12 offset:18432
    v_mfma_f32_16x16x32_bf16 v[64:67], v[112:115], v[176:179], v[64:67]
    v_mfma_f32_16x16x32_bf16 v[68:71], v[112:115], v[184:187], v[68:71]
    ds_read_b64_tr_b16 v[104:105], v13 offset:16384
    ds_read_b64_tr_b16 v[106:107], v13 offset:18432
    s_waitcnt lgkmcnt(10)
    v_mfma_f32_16x16x32_bf16 v[72:75], v[116:119], v[176:179], v[72:75]
    v_mfma_f32_16x16x32_bf16 v[76:79], v[116:119], v[184:187], v[76:79]
    ds_read_b64_tr_b16 v[108:109], v14 offset:16384
    ds_read_b64_tr_b16 v[110:111], v14 offset:18432
    s_waitcnt lgkmcnt(10)
    v_mfma_f32_16x16x32_bf16 v[80:83], v[120:123], v[176:179], v[80:83]
    buffer_store_dwordx4 v[56:59], v3, s[24:27], s32 offen offset:0 sc1
    v_mfma_f32_16x16x32_bf16 v[84:87], v[120:123], v[184:187], v[84:87]
    ds_read_b64_tr_b16 v[112:113], v11 offset:20480
    ds_read_b64_tr_b16 v[114:115], v11 offset:22528
    s_waitcnt lgkmcnt(10)
    v_mfma_f32_16x16x32_bf16 v[88:91], v[124:127], v[176:179], v[88:91]
    v_mfma_f32_16x16x32_bf16 v[92:95], v[124:127], v[184:187], v[92:95]
    ds_read_b64_tr_b16 v[116:117], v12 offset:20480
    ds_read_b64_tr_b16 v[118:119], v12 offset:22528
    s_waitcnt lgkmcnt(10)
    v_mfma_f32_16x16x32_bf16 v[64:67], v[96:99], v[192:195], v[64:67]
    v_mfma_f32_16x16x32_bf16 v[68:71], v[96:99], v[200:203], v[68:71]
    ds_read_b64_tr_b16 v[120:121], v13 offset:20480
    ds_read_b64_tr_b16 v[122:123], v13 offset:22528
    s_waitcnt lgkmcnt(10)
    v_mfma_f32_16x16x32_bf16 v[72:75], v[100:103], v[192:195], v[72:75]
    buffer_store_dwordx4 v[60:63], v4, s[24:27], s32 offen offset:0 sc1
    v_mfma_f32_16x16x32_bf16 v[76:79], v[100:103], v[200:203], v[76:79]
    ds_read_b64_tr_b16 v[124:125], v14 offset:20480
    ds_read_b64_tr_b16 v[126:127], v14 offset:22528
    s_waitcnt lgkmcnt(10)
    v_mfma_f32_16x16x32_bf16 v[80:83], v[104:107], v[192:195], v[80:83]
    v_mfma_f32_16x16x32_bf16 v[84:87], v[104:107], v[200:203], v[84:87]
    ds_read_b64_tr_b16 v[96:97], v11 offset:24576
    ds_read_b64_tr_b16 v[98:99], v11 offset:26624
    s_waitcnt lgkmcnt(10)
    v_mfma_f32_16x16x32_bf16 v[88:91], v[108:111], v[192:195], v[88:91]
    v_mfma_f32_16x16x32_bf16 v[92:95], v[108:111], v[200:203], v[92:95]
    ds_read_b64_tr_b16 v[100:101], v12 offset:24576
    ds_read_b64_tr_b16 v[102:103], v12 offset:26624
    s_waitcnt lgkmcnt(10)
    v_mfma_f32_16x16x32_bf16 v[64:67], v[112:115], v[208:211], v[64:67]
    v_mfma_f32_16x16x32_bf16 v[68:71], v[112:115], v[216:219], v[68:71]
    ds_read_b64_tr_b16 v[104:105], v13 offset:24576
    ds_read_b64_tr_b16 v[106:107], v13 offset:26624
    s_add_u32 s39, s33, 128
    s_mov_b32 m0, s40
    s_add_u32 s40, s40, 32768
    s_cmp_eq_u32 s40, s41
    s_cselect_b32 s40, s35, s40
    buffer_load_dwordx4 v1, s[12:15], s39 offen offset:0 nt lds
    s_add_u32 m0, m0, 1024
    s_waitcnt lgkmcnt(10)
    v_mfma_f32_16x16x32_bf16 v[72:75], v[116:119], v[208:211], v[72:75]
    v_mfma_f32_16x16x32_bf16 v[76:79], v[116:119], v[216:219], v[76:79]
    ds_read_b64_tr_b16 v[108:109], v14 offset:24576
    ds_read_b64_tr_b16 v[110:111], v14 offset:26624
    s_waitcnt lgkmcnt(10)
    v_mfma_f32_16x16x32_bf16 v[80:83], v[120:123], v[208:211], v[80:83]
    v_mfma_f32_16x16x32_bf16 v[84:87], v[120:123], v[216:219], v[84:87]
    ds_read_b64_tr_b16 v[112:113], v11 offset:28672
    ds_read_b64_tr_b16 v[114:115], v11 offset:30720
    s_waitcnt lgkmcnt(10)
    v_mfma_f32_16x16x32_bf16 v[88:91], v[124:127], v[208:211], v[88:91]
    v_mfma_f32_16x16x32_bf16 v[92:95], v[124:127], v[216:219], v[92:95]
    ds_read_b64_tr_b16 v[116:117], v12 offset:28672
    ds_read_b64_tr_b16 v[118:119], v12 offset:30720
    buffer_load_dwordx4 v2, s[12:15], s39 offen offset:0 nt lds
    s_add_u32 m0, m0, 1024
    s_waitcnt lgkmcnt(10)
    v_mfma_f32_16x16x32_bf16 v[64:67], v[96:99], v[224:227], v[64:67]
    v_mfma_f32_16x16x32_bf16 v[68:71], v[96:99], v[232:235], v[68:71]
    ds_read_b64_tr_b16 v[120:121], v13 offset:28672
    ds_read_b64_tr_b16 v[122:123], v13 offset:30720
    s_waitcnt lgkmcnt(10)
    v_mfma_f32_16x16x32_bf16 v[72:75], v[100:103], v[224:227], v[72:75]
    v_mfma_f32_16x16x32_bf16 v[76:79], v[100:103], v[232:235], v[76:79]
    ds_read_b64_tr_b16 v[124:125], v14 offset:28672
    ds_read_b64_tr_b16 v[126:127], v14 offset:30720
    s_waitcnt lgkmcnt(10)
    v_mfma_f32_16x16x32_bf16 v[80:83], v[104:107], v[224:227], v[80:83]
    v_mfma_f32_16x16x32_bf16 v[84:87], v[104:107], v[232:235], v[84:87]
    buffer_load_dwordx4 v3, s[12:15], s39 offen offset:0 nt lds
    s_add_u32 m0, m0, 1024
    s_waitcnt lgkmcnt(8)
    v_mfma_f32_16x16x32_bf16 v[88:91], v[108:111], v[224:227], v[88:91]
    v_mfma_f32_16x16x32_bf16 v[92:95], v[108:111], v[232:235], v[92:95]
    s_waitcnt lgkmcnt(6)
    v_mfma_f32_16x16x32_bf16 v[64:67], v[112:115], v[240:243], v[64:67]
    v_mfma_f32_16x16x32_bf16 v[68:71], v[112:115], v[248:251], v[68:71]
    s_waitcnt lgkmcnt(4)
    v_mfma_f32_16x16x32_bf16 v[72:75], v[116:119], v[240:243], v[72:75]
    v_mfma_f32_16x16x32_bf16 v[76:79], v[116:119], v[248:251], v[76:79]
    s_waitcnt lgkmcnt(2)
    v_mfma_f32_16x16x32_bf16 v[80:83], v[120:123], v[240:243], v[80:83]
    buffer_load_dwordx4 v4, s[12:15], s39 offen offset:0 nt lds
    v_mfma_f32_16x16x32_bf16 v[84:87], v[120:123], v[248:251], v[84:87]
    s_waitcnt lgkmcnt(0)
    v_mfma_f32_16x16x32_bf16 v[88:91], v[124:127], v[240:243], v[88:91]
    v_mfma_f32_16x16x32_bf16 v[92:95], v[124:127], v[248:251], v[92:95]
    v_add_u32 v11, s42, v7
    v_add_u32 v12, s42, v8
    v_add_u32 v13, s42, v9
    v_add_u32 v14, s42, v10
    s_add_u32 s42, s42, 32768
    s_cmp_eq_u32 s42, 163840
    s_cselect_b32 s42, 0, s42
    s_waitcnt vmcnt(16)
    s_barrier
    ds_read_b64_tr_b16 v[96:97], v11 offset:0
    ds_read_b64_tr_b16 v[98:99], v11 offset:2048
    ds_read_b64_tr_b16 v[100:101], v12 offset:0
    ds_read_b64_tr_b16 v[102:103], v12 offset:2048
    ds_read_b64_tr_b16 v[104:105], v13 offset:0
    ds_read_b64_tr_b16 v[106:107], v13 offset:2048
    ds_read_b64_tr_b16 v[108:109], v14 offset:0
    ds_read_b64_tr_b16 v[110:111], v14 offset:2048
    ds_read_b64_tr_b16 v[112:113], v11 offset:4096
    ds_read_b64_tr_b16 v[114:115], v11 offset:6144
    ds_read_b64_tr_b16 v[116:117], v12 offset:4096
    ds_read_b64_tr_b16 v[118:119], v12 offset:6144
    s_waitcnt lgkmcnt(10)
    v_mfma_f32_16x16x32_bf16 v[32:35], v[96:99], v[128:131], 0
    v_add_u32 v21, s40, v15
    v_add_u32 v25, s40, v16
    v_xor_b32 v22, 32, v21
    v_xor_b32 v23, 64, v21
    v_xor_b32 v24, 96, v21
    v_mfma_f32_16x16x32_bf16 v[36:39], v[96:99], v[136:139], 0
    ds_read_b64_tr_b16 v[120:121], v13 offset:4096
    ds_read_b64_tr_b16 v[122:123], v13 offset:6144
    v_mul_f32 v64, v64, v19
    v_mul_f32 v65, v65, v19
    v_mul_f32 v66, v66, v19
    v_mul_f32 v67, v67, v19
    v_cvt_pk_bf16_f32 v64, v64, v65
    s_waitcnt lgkmcnt(10)
    v_mfma_f32_16x16x32_bf16 v[40:43], v[100:103], v[128:131], 0
    v_cvt_pk_bf16_f32 v65, v66, v67
    ds_write_b64 v21, v[64:65] offset:0
    v_mul_f32 v68, v68, v20
    v_mul_f32 v69, v69, v20
    v_mul_f32 v70, v70, v20
    v_mfma_f32_16x16x32_bf16 v[44:47], v[100:103], v[136:139], 0
    ds_read_b64_tr_b16 v[124:125], v14 offset:4096
    ds_read_b64_tr_b16 v[126:127], v14 offset:6144
    v_mul_f32 v71, v71, v20
    v_cvt_pk_bf16_f32 v68, v68, v69
    v_cvt_pk_bf16_f32 v69, v70, v71
    ds_write_b64 v21, v[68:69] offset:2048
    v_mul_f32 v72, v72, v19
    s_waitcnt lgkmcnt(12)
    v_mfma_f32_16x16x32_bf16 v[48:51], v[104:107], v[128:131], 0
    v_mul_f32 v73, v73, v19
    v_mul_f32 v74, v74, v19
    v_mul_f32 v75, v75, v19
    v_cvt_pk_bf16_f32 v72, v72, v73
    v_cvt_pk_bf16_f32 v73, v74, v75
    v_mfma_f32_16x16x32_bf16 v[52:55], v[104:107], v[136:139], 0
    ds_read_b64_tr_b16 v[96:97], v11 offset:8192
    ds_read_b64_tr_b16 v[98:99], v11 offset:10240
    ds_write_b64 v22, v[72:73] offset:0
    v_mul_f32 v76, v76, v20
    v_mul_f32 v77, v77, v20
    v_mul_f32 v78, v78, v20
    v_mul_f32 v79, v79, v20
    s_waitcnt lgkmcnt(13)
    v_mfma_f32_16x16x32_bf16 v[56:59], v[108:111], v[128:131], 0
    v_cvt_pk_bf16_f32 v76, v76, v77
    v_cvt_pk_bf16_f32 v77, v78, v79
    ds_write_b64 v22, v[76:77] offset:2048
    v_mul_f32 v80, v80, v19
    v_mul_f32 v81, v81, v19
    v_mfma_f32_16x16x32_bf16 v[60:63], v[108:111], v[136:139], 0
    ds_read_b64_tr_b16 v[100:101], v12 offset:8192
    s_waitcnt lgkmcnt(14)
    ds_read_b64_tr_b16 v[102:103], v12 offset:10240
    v_mul_f32 v82, v82, v19
    v_mul_f32 v83, v83, v19
    v_cvt_pk_bf16_f32 v80, v80, v81
    v_cvt_pk_bf16_f32 v81, v82, v83
    s_waitcnt lgkmcnt(14)
    ds_write_b64 v23, v[80:81] offset:0
    v_mfma_f32_16x16x32_bf16 v[32:35], v[112:115], v[144:147], v[32:35]
    v_mul_f32 v84, v84, v20
    v_mul_f32 v85, v85, v20
    v_mul_f32 v86, v86, v20
    v_mul_f32 v87, v87, v20
    v_cvt_pk_bf16_f32 v84, v84, v85
    v_mfma_f32_16x16x32_bf16 v[36:39], v[112:115], v[152:155], v[36:39]
    s_waitcnt lgkmcnt(14)
    ds_read_b64_tr_b16 v[104:105], v13 offset:8192
    s_waitcnt lgkmcnt(14)
    ds_read_b64_tr_b16 v[106:107], v13 offset:10240
    v_cvt_pk_bf16_f32 v85, v86, v87
    s_waitcnt lgkmcnt(14)
    ds_write_b64 v23, v[84:85] offset:2048
    v_mul_f32 v88, v88, v19
    v_mul_f32 v89, v89, v19
    v_mul_f32 v90, v90, v19
    v_mfma_f32_16x16x32_bf16 v[40:43], v[116:119], v[144:147], v[40:43]
    v_mul_f32 v91, v91, v19
    v_cvt_pk_bf16_f32 v88, v88, v89
    v_cvt_pk_bf16_f32 v89, v90, v91
    s_waitcnt lgkmcnt(14)
    ds_write_b64 v24, v[88:89] offset:0
    v_mul_f32 v92, v92, v20
    v_mfma_f32_16x16x32_bf16 v[44:47], v[116:119], v[152:155], v[44:47]
    s_waitcnt lgkmcnt(14)
    ds_read_b64_tr_b16 v[108:109], v14 offset:8192
    s_waitcnt lgkmcnt(14)
    ds_read_b64_tr_b16 v[110:111], v14 offset:10240
    v_mul_f32 v93, v93, v20
    v_mul_f32 v94, v94, v20
    v_mul_f32 v95, v95, v20
    v_cvt_pk_bf16_f32 v92, v92, v93
    v_cvt_pk_bf16_f32 v93, v94, v95
    v_mfma_f32_16x16x32_bf16 v[48:51], v[120:123], v[144:147], v[48:51]
    s_waitcnt lgkmcnt(14)
    ds_write_b64 v24, v[92:93] offset:2048
    v_mfma_f32_16x16x32_bf16 v[52:55], v[120:123], v[152:155], v[52:55]
    s_waitcnt lgkmcnt(14)
    ds_read_b64_tr_b16 v[112:113], v11 offset:12288
    s_waitcnt lgkmcnt(14)
    ds_read_b64_tr_b16 v[114:115], v11 offset:14336
    s_waitcnt lgkmcnt(14)
    ds_read_b128 v[80:83], v25 offset:0
    s_waitcnt lgkmcnt(14)
    ds_read_b128 v[84:87], v25 offset:1024
    s_waitcnt lgkmcnt(14)
    ds_read_b128 v[88:91], v25 offset:2048
    s_waitcnt lgkmcnt(14)
    ds_read_b128 v[92:95], v25 offset:3072
    v_mfma_f32_16x16x32_bf16 v[56:59], v[124:127], v[144:147], v[56:59]
    v_mfma_f32_16x16x32_bf16 v[60:63], v[124:127], v[152:155], v[60:63]
    s_waitcnt lgkmcnt(14)
    ds_read_b64_tr_b16 v[116:117], v12 offset:12288
    s_waitcnt lgkmcnt(14)
    ds_read_b64_tr_b16 v[118:119], v12 offset:14336
    v_mfma_f32_16x16x32_bf16 v[32:35], v[96:99], v[160:163], v[32:35]
    s_waitcnt lgkmcnt(5)
    buffer_store_dwordx4 v[80:83], v1, s[24:27], s32 offen offset:128 sc1
    v_mfma_f32_16x16x32_bf16 v[36:39], v[96:99], v[168:171], v[36:39]
    ds_read_b64_tr_b16 v[120:121], v13 offset:12288
    ds_read_b64_tr_b16 v[122:123], v13 offset:14336
    v_mfma_f32_16x16x32_bf16 v[40:43], v[100:103], v[160:163], v[40:43]
    v_mfma_f32_16x16x32_bf16 v[44:47], v[100:103], v[168:171], v[44:47]
    ds_read_b64_tr_b16 v[124:125], v14 offset:12288
    ds_read_b64_tr_b16 v[126:127], v14 offset:14336
    v_mfma_f32_16x16x32_bf16 v[48:51], v[104:107], v[160:163], v[48:51]
    v_mfma_f32_16x16x32_bf16 v[52:55], v[104:107], v[168:171], v[52:55]
    ds_read_b64_tr_b16 v[96:97], v11 offset:16384
    ds_read_b64_tr_b16 v[98:99], v11 offset:18432
    v_mfma_f32_16x16x32_bf16 v[56:59], v[108:111], v[160:163], v[56:59]
    s_waitcnt lgkmcnt(10)
    buffer_store_dwordx4 v[84:87], v2, s[24:27], s32 offen offset:128 sc1
    v_mfma_f32_16x16x32_bf16 v[60:63], v[108:111], v[168:171], v[60:63]
    ds_read_b64_tr_b16 v[100:101], v12 offset:16384
    ds_read_b64_tr_b16 v[102:103], v12 offset:18432
    v_mfma_f32_16x16x32_bf16 v[32:35], v[112:115], v[176:179], v[32:35]
    v_mfma_f32_16x16x32_bf16 v[36:39], v[112:115], v[184:187], v[36:39]
    ds_read_b64_tr_b16 v[104:105], v13 offset:16384
    ds_read_b64_tr_b16 v[106:107], v13 offset:18432
    s_waitcnt lgkmcnt(10)
    v_mfma_f32_16x16x32_bf16 v[40:43], v[116:119], v[176:179], v[40:43]
    v_mfma_f32_16x16x32_bf16 v[44:47], v[116:119], v[184:187], v[44:47]
    ds_read_b64_tr_b16 v[108:109], v14 offset:16384
    ds_read_b64_tr_b16 v[110:111], v14 offset:18432
    s_waitcnt lgkmcnt(10)
    v_mfma_f32_16x16x32_bf16 v[48:51], v[120:123], v[176:179], v[48:51]
    buffer_store_dwordx4 v[88:91], v3, s[24:27], s32 offen offset:128 sc1
    v_mfma_f32_16x16x32_bf16 v[52:55], v[120:123], v[184:187], v[52:55]
    ds_read_b64_tr_b16 v[112:113], v11 offset:20480
    ds_read_b64_tr_b16 v[114:115], v11 offset:22528
    s_waitcnt lgkmcnt(10)
    v_mfma_f32_16x16x32_bf16 v[56:59], v[124:127], v[176:179], v[56:59]
    v_mfma_f32_16x16x32_bf16 v[60:63], v[124:127], v[184:187], v[60:63]
    ds_read_b64_tr_b16 v[116:117], v12 offset:20480
    ds_read_b64_tr_b16 v[118:119], v12 offset:22528
    s_waitcnt lgkmcnt(10)
    v_mfma_f32_16x16x32_bf16 v[32:35], v[96:99], v[192:195], v[32:35]
    v_mfma_f32_16x16x32_bf16 v[36:39], v[96:99], v[200:203], v[36:39]
    ds_read_b64_tr_b16 v[120:121], v13 offset:20480
    ds_read_b64_tr_b16 v[122:123], v13 offset:22528
    s_waitcnt lgkmcnt(10)
    v_mfma_f32_16x16x32_bf16 v[40:43], v[100:103], v[192:195], v[40:43]
    buffer_store_dwordx4 v[92:95], v4, s[24:27], s32 offen offset:128 sc1
    v_mfma_f32_16x16x32_bf16 v[44:47], v[100:103], v[200:203], v[44:47]
    ds_read_b64_tr_b16 v[124:125], v14 offset:20480
    ds_read_b64_tr_b16 v[126:127], v14 offset:22528
    s_waitcnt lgkmcnt(10)
    v_mfma_f32_16x16x32_bf16 v[48:51], v[104:107], v[192:195], v[48:51]
    v_mfma_f32_16x16x32_bf16 v[52:55], v[104:107], v[200:203], v[52:55]
    ds_read_b64_tr_b16 v[96:97], v11 offset:24576
    ds_read_b64_tr_b16 v[98:99], v11 offset:26624
    s_waitcnt lgkmcnt(10)
    v_mfma_f32_16x16x32_bf16 v[56:59], v[108:111], v[192:195], v[56:59]
    v_mfma_f32_16x16x32_bf16 v[60:63], v[108:111], v[200:203], v[60:63]
    ds_read_b64_tr_b16 v[100:101], v12 offset:24576
    ds_read_b64_tr_b16 v[102:103], v12 offset:26624
    s_waitcnt lgkmcnt(10)
    v_mfma_f32_16x16x32_bf16 v[32:35], v[112:115], v[208:211], v[32:35]
    v_mfma_f32_16x16x32_bf16 v[36:39], v[112:115], v[216:219], v[36:39]
    ds_read_b64_tr_b16 v[104:105], v13 offset:24576
    ds_read_b64_tr_b16 v[106:107], v13 offset:26624
    s_add_u32 s39, s33, 128
    s_mov_b32 m0, s40
    s_add_u32 s40, s40, 32768
    s_cmp_eq_u32 s40, s41
    s_cselect_b32 s40, s35, s40
    buffer_load_dwordx4 v1, s[16:19], s39 offen offset:0 nt lds
    s_add_u32 m0, m0, 1024
    s_waitcnt lgkmcnt(10)
    v_mfma_f32_16x16x32_bf16 v[40:43], v[116:119], v[208:211], v[40:43]
    v_mfma_f32_16x16x32_bf16 v[44:47], v[116:119], v[216:219], v[44:47]
    ds_read_b64_tr_b16 v[108:109], v14 offset:24576
    ds_read_b64_tr_b16 v[110:111], v14 offset:26624
    s_waitcnt lgkmcnt(10)
    v_mfma_f32_16x16x32_bf16 v[48:51], v[120:123], v[208:211], v[48:51]
    v_mfma_f32_16x16x32_bf16 v[52:55], v[120:123], v[216:219], v[52:55]
    ds_read_b64_tr_b16 v[112:113], v11 offset:28672
    ds_read_b64_tr_b16 v[114:115], v11 offset:30720
    s_waitcnt lgkmcnt(10)
    v_mfma_f32_16x16x32_bf16 v[56:59], v[124:127], v[208:211], v[56:59]
    v_mfma_f32_16x16x32_bf16 v[60:63], v[124:127], v[216:219], v[60:63]
    ds_read_b64_tr_b16 v[116:117], v12 offset:28672
    ds_read_b64_tr_b16 v[118:119], v12 offset:30720
    buffer_load_dwordx4 v2, s[16:19], s39 offen offset:0 nt lds
    s_add_u32 m0, m0, 1024
    s_waitcnt lgkmcnt(10)
    v_mfma_f32_16x16x32_bf16 v[32:35], v[96:99], v[224:227], v[32:35]
    v_mfma_f32_16x16x32_bf16 v[36:39], v[96:99], v[232:235], v[36:39]
    ds_read_b64_tr_b16 v[120:121], v13 offset:28672
    ds_read_b64_tr_b16 v[122:123], v13 offset:30720
    s_waitcnt lgkmcnt(10)
    v_mfma_f32_16x16x32_bf16 v[40:43], v[100:103], v[224:227], v[40:43]
    v_mfma_f32_16x16x32_bf16 v[44:47], v[100:103], v[232:235], v[44:47]
    ds_read_b64_tr_b16 v[124:125], v14 offset:28672
    ds_read_b64_tr_b16 v[126:127], v14 offset:30720
    s_waitcnt lgkmcnt(10)
    v_mfma_f32_16x16x32_bf16 v[48:51], v[104:107], v[224:227], v[48:51]
    v_mfma_f32_16x16x32_bf16 v[52:55], v[104:107], v[232:235], v[52:55]
    buffer_load_dwordx4 v3, s[16:19], s39 offen offset:0 nt lds
    s_add_u32 m0, m0, 1024
    s_waitcnt lgkmcnt(8)
    v_mfma_f32_16x16x32_bf16 v[56:59], v[108:111], v[224:227], v[56:59]
    v_mfma_f32_16x16x32_bf16 v[60:63], v[108:111], v[232:235], v[60:63]
    s_waitcnt lgkmcnt(6)
    v_mfma_f32_16x16x32_bf16 v[32:35], v[112:115], v[240:243], v[32:35]
    v_mfma_f32_16x16x32_bf16 v[36:39], v[112:115], v[248:251], v[36:39]
    s_waitcnt lgkmcnt(4)
    v_mfma_f32_16x16x32_bf16 v[40:43], v[116:119], v[240:243], v[40:43]
    v_mfma_f32_16x16x32_bf16 v[44:47], v[116:119], v[248:251], v[44:47]
    s_waitcnt lgkmcnt(2)
    v_mfma_f32_16x16x32_bf16 v[48:51], v[120:123], v[240:243], v[48:51]
    buffer_load_dwordx4 v4, s[16:19], s39 offen offset:0 nt lds
    v_mfma_f32_16x16x32_bf16 v[52:55], v[120:123], v[248:251], v[52:55]
    s_waitcnt lgkmcnt(0)
    v_mfma_f32_16x16x32_bf16 v[56:59], v[124:127], v[240:243], v[56:59]
    v_mfma_f32_16x16x32_bf16 v[60:63], v[124:127], v[248:251], v[60:63]
    s_add_u32 s28, s42, s35
    s_add_u32 s42, s42, 32768
    s_cmp_eq_u32 s42, 163840
    s_cselect_b32 s42, 0, s42
    v_add_u32 v13, s28, v5
    v_add_u32 v11, s42, v5
    v_add_u32 v14, s28, v6
    v_add_u32 v12, s42, v6
    s_add_u32 s42, s42, 32768
    s_cmp_eq_u32 s42, 163840
    s_cselect_b32 s42, 0, s42
    s_waitcnt vmcnt(16)
    s_barrier
    ds_read_b128 v[96:99], v13 offset:0
    ds_read_b128 v[64:67], v11 offset:0
    ds_read_b128 v[100:103], v13 offset:2048
    ds_read_b128 v[68:71], v11 offset:2048
    ds_read_b128 v[72:75], v11 offset:4096
    ds_read_b128 v[76:79], v11 offset:6144
    ds_read_b128 v[80:83], v11 offset:8192
    ds_read_b128 v[84:87], v11 offset:10240
    ds_read_b128 v[88:91], v11 offset:12288
    ds_read_b128 v[92:95], v11 offset:14336
    ds_read_b128 v[104:107], v14 offset:0
    s_mov_b32 s34, s32
    s_mov_b32 s32, s33
    s_add_u32 s36, s36, 1
    s_branch L_head
    s_endpgm
.section .rodata,"a"
.p2align 6
.amdhsa_kernel standalone__mha_softmax__near_ridge_kernel
  .amdhsa_next_free_vgpr 256
  .amdhsa_next_free_sgpr 80
  .amdhsa_accum_offset 256
  .amdhsa_group_segment_fixed_size 0
  .amdhsa_kernarg_size 48
  .amdhsa_user_sgpr_count 2
  .amdhsa_user_sgpr_kernarg_segment_ptr 1
  .amdhsa_system_sgpr_workgroup_id_x 1
.end_amdhsa_kernel
```
